```python
import torch

def _softmax(x, axis=-1):
    return torch.softmax(x, dim=axis)
def _gelu(x):
    return torch.nn.functional.gelu(x, approximate="tanh")
def _silu(x):
    return torch.nn.functional.silu(x)
def _sigmoid(x):
    return torch.sigmoid(x)
def _layernorm(x, axis=-1, eps=1e-5):
    m = x.mean(dim=axis, keepdim=True)
    v = x.var(dim=axis, keepdim=True, unbiased=False)
    return (x - m) / torch.sqrt(v + eps)
def _scatter_add(tgt, idx, src, axis=0):
    return tgt.clone().index_add_(axis, idx, src)
def _segment_sum(src, seg, n):
    out = torch.zeros((n,) + src.shape[1:], dtype=src.dtype)
    return out.index_add_(0, seg, src)
def _pad(x, pw):
    flat = tuple(v for pair in reversed(pw) for v in pair)
    return torch.nn.functional.pad(x, flat)

kernel_name = 'interleave_layers__spectral_gfnet__glu_gated_swiglu__prompt'

def setup_inputs():

    _w = (lambda a: (lambda t: t.to(torch.bfloat16) if t.is_floating_point() else t)(torch.as_tensor(a)))
    def _A_setup():
        B, S, D = 1, 2048, 512
        Df = D // 2 + 1
        return {
            "x": _w((lambda *s: torch.randn(*s, dtype=torch.bfloat16) * 0.05)(B, S, D)),
            "w_r": _w((lambda *s: torch.randn(*s, dtype=torch.bfloat16) * 0.4)(S, Df) * 0.02),
            "w_i": _w((lambda *s: torch.randn(*s, dtype=torch.bfloat16) * 0.4)(S, Df) * 0.02),
        }
    _A_in = _A_setup()

    def _B_setup():
        B, S, D, F = 1, 2048, 512, 1792
        return {
            "x": _w((lambda *s: torch.randn(*s, dtype=torch.bfloat16) * 0.05)(B, S, D)),
            "w1": _w((lambda *s: torch.randn(*s, dtype=torch.bfloat16) * 0.2)(D, F) * (2.0 / D) ** 0.5),
            "w3": _w((lambda *s: torch.randn(*s, dtype=torch.bfloat16) * 0.2)(D, F) * (2.0 / D) ** 0.5),
            "w2": _w((lambda *s: torch.randn(*s, dtype=torch.bfloat16) * 0.2)(F, D) * (2.0 / F) ** 0.5),
        }
    _B_in = _B_setup()

    return {
        "A_x": _A_in["x"],
        "A_w_r": _A_in["w_r"],
        "A_w_i": _A_in["w_i"],
        "B_x": _B_in["x"],
        "B_w1": _B_in["w1"],
        "B_w3": _B_in["w3"],
        "B_w2": _B_in["w2"],
    }

def reference(A_x, A_w_r, A_w_i, B_x, B_w1, B_w3, B_w2):
    def _A_ref(x, w_r, w_i):
        B, S, D = x.shape
        X = (lambda x, axes=(-2,-1): torch.fft.rfft2(x.float(), dim=axes))(x, axes=(-2, -1))
        W = w_r + 1j * w_i
        X = X * W
        y = (lambda x, s, axes=(-2,-1): torch.fft.irfft2(x, s=s, dim=axes).to(torch.bfloat16))(X, (S, D), axes=(-2, -1))
        return y

    def _B_ref(x, w1, w3, w2):
        gate = torch.einsum("bsd,df->bsf", x, w1)
        up = torch.einsum("bsd,df->bsf", x, w3)
        h = _silu(gate) * up
        out = torch.einsum("bsf,fd->bsd", h, w2)
        return out

    x = A_x
    x = x + _A_ref(_layernorm(x, axis=-1), A_w_r, A_w_i)
    x = x + _B_ref(_layernorm(x, axis=-1), B_w1, B_w3, B_w2)
    x = x + _A_ref(_layernorm(x, axis=-1), A_w_r, A_w_i)
    x = x + _B_ref(_layernorm(x, axis=-1), B_w1, B_w3, B_w2)
    return x
```

```asm
; @launch kernel=k1_kernel grid=(256,1,1) block=(512,1,1) lds=114688
; @launch kernel=fft0_kernel grid=(256,1,1) block=(256,1,1) lds=16384
; @launch kernel=glu0_kernel grid=(256,1,1) block=(512,1,1) lds=131840
; @launch kernel=down0_kernel grid=(256,1,1) block=(256,1,1) lds=50176
; @launch kernel=fft1_kernel grid=(256,1,1) block=(256,1,1) lds=16384
; @launch kernel=glu1_kernel grid=(256,1,1) block=(512,1,1) lds=131840
; @launch kernel=down1_kernel grid=(256,1,1) block=(256,1,1) lds=50176
.amdgcn_target "amdgcn-amd-amdhsa--gfx950"
.text
.globl k1_kernel
.p2align 8
.type k1_kernel,@function
k1_kernel:
    s_cmp_ge_u32 s2, 256
    s_cbranch_scc1 k1_end2
    s_load_dwordx16 s[4:19], s[0:1], 0
    s_load_dwordx4 s[20:23], s[0:1], 64
    s_cmp_lt_u32 s2, 8
    s_cbranch_scc0 k1_nopf
    s_getpc_b64 s[62:63]
k1_pc:
    s_add_u32 s62, s62, k1_kernel-k1_pc
    s_addc_u32 s63, s63, -1
    v_lshlrev_b32 v24, 7, v0
    v_min_u32 v24, text_end-(k1_kernel)-4, v24
    global_load_dword v24, v24, s[62:63]
k1_nopf:
    v_lshrrev_b32 v1, 6, v0
    v_and_b32 v2, 63, v0
    v_readfirstlane_b32 s3, v1
    v_bfe_u32 v3, v0, 4, 2
    v_and_b32 v4, 15, v0
    s_and_b32 s40, s2, 7
    s_lshr_b32 s41, s2, 4
    s_lshl_b32 s41, s41, 3
    s_add_u32 s24, s40, s41
    s_bfe_u32 s25, s2, 0x10003
    s_lshr_b32 s27, s2, 2
    v_lshrrev_b32 v21, 3, v2
    v_and_b32 v22, 7, v2
    s_and_b32 s40, s3, 3
    s_mul_i32 s40, s40, 263168
    s_mul_i32 s41, s27, 514
    s_add_u32 s40, s40, s41
    s_and_b32 s41, s2, 3
    s_lshl_b32 s41, s41, 7
    s_add_u32 s40, s40, s41
    s_add_u32 s40, s40, 2
    v_mul_u32_u24 v23, 32896, v21
    v_lshl_add_u32 v23, v22, 4, v23
    v_add_u32 v23, s40, v23
    s_lshl_b32 s31, s3, 10
    s_waitcnt lgkmcnt(0)
    s_cmp_ge_u32 s3, 4
    s_cselect_b32 s38, s8, s6
    s_cselect_b32 s39, s9, s7
    global_load_dwordx4 v[24:27], v23, s[38:39]
    s_cmp_ge_u32 s24, 116
    s_cbranch_scc1 k1_helper
    s_cmp_ge_u32 s24, 60
    s_cbranch_scc1 k1_role_c
    v_and_b32 v23, 6, v21
    v_xor_b32 v23, v23, v22
    v_lshlrev_b32 v23, 4, v23
    s_mov_b32 s30, 128
    s_mov_b32 s32, 16
    s_cmp_ge_u32 s24, 32
    s_cbranch_scc1 k1_role_b
    s_mov_b32 s26, 0
    s_bfe_u32 s40, s3, 0x10001
    s_lshl_b32 s40, s40, 2
    s_bfe_u32 s41, s24, 0x20001
    s_lshl_b32 s41, s41, 3
    s_add_u32 s40, s40, s41
    s_bfe_u32 s41, s24, 0x10003
    s_lshl_b32 s41, s41, 5
    s_add_u32 s40, s40, s41
    s_lshl_b32 s40, s40, 15
    s_and_b32 s41, s3, 1
    s_lshl_b32 s41, s41, 1
    s_lshr_b32 s42, s3, 2
    s_lshl_b32 s42, s42, 2
    s_add_u32 s41, s41, s42
    s_and_b32 s42, s24, 1
    s_lshl_b32 s42, s42, 3
    s_add_u32 s41, s41, s42
    s_lshr_b32 s42, s24, 4
    s_lshl_b32 s42, s42, 4
    s_add_u32 s41, s41, s42
    s_lshl_b32 s41, s41, 10
    s_add_u32 s40, s40, s41
    v_bfe_u32 v5, v2, 3, 2
    v_lshl_add_u32 v5, v5, 15, v23
    v_lshrrev_b32 v22, 5, v2
    v_lshl_add_u32 v5, v22, 10, v5
    s_add_u32 s28, s4, s40
    s_addc_u32 s29, s5, 0
    s_branch k1_issue
k1_role_b:
    s_mov_b32 s26, 1
    s_sub_u32 s33, s24, 32
    s_lshl_b32 s40, s33, 3
    s_add_u32 s40, s40, s3
    s_lshl_b32 s40, s40, 13
    v_lshl_add_u32 v5, v21, 10, v23
    s_add_u32 s28, s16, s40
    s_addc_u32 s29, s17, 0
    s_branch k1_issue
k1_role_c:
    s_sub_u32 s33, s24, 60
    s_mov_b32 s26, 2
    s_and_b32 s40, s3, 1
    s_lshl_b32 s40, s40, 2
    v_and_b32 v23, 2, v21
    v_or_b32 v23, s40, v23
    v_xor_b32 v23, v23, v22
    v_lshlrev_b32 v23, 4, v23
    v_mul_u32_u24 v5, 3584, v21
    v_add_u32 v5, v5, v23
    s_bitcmp1_b32 s33, 0
    s_cselect_b32 s28, s14, s12
    s_cselect_b32 s29, s15, s13
    s_lshr_b32 s40, s33, 1
    s_lshl_b32 s40, s40, 7
    s_mul_i32 s41, s3, 28672
    s_add_u32 s40, s40, s41
    s_mov_b32 s30, 229376
    s_mov_b32 s32, 4
    s_add_u32 s28, s28, s40
    s_addc_u32 s29, s29, 0
k1_issue:
    s_add_u32 m0, s31, 0
    s_nop 0
    global_load_lds_dwordx4 v5, s[28:29]
    s_add_u32 s28, s28, s30
    s_addc_u32 s29, s29, 0
    v_lshrrev_b32 v144, 2, v4
    v_lshlrev_b32 v144, 3, v144
    v_and_b32 v145, 3, v4
    v_add_u32 v144, v144, v145
    s_cmp_eq_u32 s26, 2
    s_cselect_b32 s40, -1, 0
    v_mov_b32 v145, s40
    v_bfi_b32 v144, v145, v144, v4
    s_lshl_b32 s40, s25, 3
    s_add_u32 s40, s40, s3
    s_lshl_b32 s40, s40, 5
    v_add_u32 v144, s40, v144
    v_and_b32 v152, 1, v4
    v_cvt_f32_u32 v153, v3
    v_mul_f32 v153, 0x41000000, v153
    v_cvt_f32_u32 v154, v152
    v_mul_f32 v154, 0x3e800000, v154
    v_mov_b32 v155, 0x80008000
    v_lshrrev_b32 v145, 1, v144
    v_add_u32 v145, 1, v145
    v_and_b32 v156, v145, v152
    v_bfe_u32 v157, v145, 1, 1
    v_xor_b32 v156, v156, v157
    v_mul_lo_u32 v10, v156, v155
    v_and_b32 v156, 1, v145
    v_mul_lo_u32 v12, v156, v155
    v_xor_b32 v13, v10, v12
    v_cvt_f32_u32 v146, v145
    v_mul_f32 v146, 0x3b000000, v146
    v_fma_f32 v148, v146, v153, v154
    v_mul_f32 v150, 0x41c80000, v146
    v_add_u32 v144, s32, v144
    v_lshrrev_b32 v145, 1, v144
    v_add_u32 v145, 1, v145
    v_and_b32 v156, v145, v152
    v_bfe_u32 v157, v145, 1, 1
    v_xor_b32 v156, v156, v157
    v_mul_lo_u32 v11, v156, v155
    v_xor_b32 v14, v11, v12
    v_cvt_f32_u32 v147, v145
    v_mul_f32 v147, 0x3b000000, v147
    v_cmp_ne_u32 vcc, 511, v144
    s_nop 1
    v_cndmask_b32 v147, 0, v147, vcc
    v_cndmask_b32 v158, 0, v154, vcc
    v_fma_f32 v149, v147, v153, v158
    v_mul_f32 v151, 0x41c80000, v147
    v_mov_b32 v15, 0x3d800000
    v_mov_b32 v156, 0x3d3504f3
    v_cmp_le_u32 vcc, 510, v144
    s_nop 1
    v_cndmask_b32 v16, v15, v156, vcc
    v_cos_f32 v160, v148
    v_cos_f32 v168, v149
    v_add_f32 v148, v148, v146
    v_add_f32 v149, v149, v147
    v_cos_f32 v161, v148
    v_cos_f32 v169, v149
    v_add_f32 v148, v148, v146
    v_add_f32 v149, v149, v147
    v_cvt_pk_bf16_f32 v32, v160, v161
    v_cvt_pk_bf16_f32 v48, v168, v169
    v_cos_f32 v162, v148
    v_cos_f32 v170, v149
    v_add_f32 v148, v148, v146
    v_add_f32 v149, v149, v147
    v_cos_f32 v163, v148
    v_cos_f32 v171, v149
    v_add_f32 v148, v148, v146
    v_add_f32 v149, v149, v147
    v_cvt_pk_bf16_f32 v33, v162, v163
    v_cvt_pk_bf16_f32 v49, v170, v171
    v_cos_f32 v164, v148
    v_cos_f32 v172, v149
    v_add_f32 v148, v148, v146
    v_add_f32 v149, v149, v147
    v_cos_f32 v165, v148
    v_cos_f32 v173, v149
    v_add_f32 v148, v148, v146
    v_add_f32 v149, v149, v147
    v_cvt_pk_bf16_f32 v34, v164, v165
    v_cvt_pk_bf16_f32 v50, v172, v173
    s_add_u32 m0, s31, 8192
    s_nop 0
    global_load_lds_dwordx4 v5, s[28:29]
    s_add_u32 s28, s28, s30
    s_addc_u32 s29, s29, 0
    v_cos_f32 v166, v148
    v_cos_f32 v174, v149
    v_add_f32 v148, v148, v146
    v_add_f32 v149, v149, v147
    v_cos_f32 v167, v148
    v_cos_f32 v175, v149
    v_add_f32 v148, v148, v150
    v_add_f32 v149, v149, v151
    v_cvt_pk_bf16_f32 v35, v166, v167
    v_cvt_pk_bf16_f32 v51, v174, v175
    v_cos_f32 v160, v148
    v_cos_f32 v168, v149
    v_add_f32 v148, v148, v146
    v_add_f32 v149, v149, v147
    v_cos_f32 v161, v148
    v_cos_f32 v169, v149
    v_add_f32 v148, v148, v146
    v_add_f32 v149, v149, v147
    v_cvt_pk_bf16_f32 v36, v160, v161
    v_cvt_pk_bf16_f32 v52, v168, v169
    v_cos_f32 v162, v148
    v_cos_f32 v170, v149
    v_add_f32 v148, v148, v146
    v_add_f32 v149, v149, v147
    v_cos_f32 v163, v148
    v_cos_f32 v171, v149
    v_add_f32 v148, v148, v146
    v_add_f32 v149, v149, v147
    v_cvt_pk_bf16_f32 v37, v162, v163
    v_cvt_pk_bf16_f32 v53, v170, v171
    v_cos_f32 v164, v148
    v_cos_f32 v172, v149
    v_add_f32 v148, v148, v146
    v_add_f32 v149, v149, v147
    v_cos_f32 v165, v148
    v_cos_f32 v173, v149
    v_add_f32 v148, v148, v146
    v_add_f32 v149, v149, v147
    v_cvt_pk_bf16_f32 v38, v164, v165
    v_cvt_pk_bf16_f32 v54, v172, v173
    v_cos_f32 v166, v148
    v_cos_f32 v174, v149
    v_add_f32 v148, v148, v146
    v_add_f32 v149, v149, v147
    v_cos_f32 v167, v148
    v_cos_f32 v175, v149
    v_add_f32 v148, v148, v150
    v_add_f32 v149, v149, v151
    v_cvt_pk_bf16_f32 v39, v166, v167
    v_cvt_pk_bf16_f32 v55, v174, v175
    v_cos_f32 v160, v148
    v_cos_f32 v168, v149
    v_add_f32 v148, v148, v146
    v_add_f32 v149, v149, v147
    v_cos_f32 v161, v148
    v_cos_f32 v169, v149
    v_add_f32 v148, v148, v146
    v_add_f32 v149, v149, v147
    v_cvt_pk_bf16_f32 v40, v160, v161
    v_cvt_pk_bf16_f32 v56, v168, v169
    v_cos_f32 v162, v148
    v_cos_f32 v170, v149
    v_add_f32 v148, v148, v146
    v_add_f32 v149, v149, v147
    v_cos_f32 v163, v148
    v_cos_f32 v171, v149
    v_add_f32 v148, v148, v146
    v_add_f32 v149, v149, v147
    v_cvt_pk_bf16_f32 v41, v162, v163
    v_cvt_pk_bf16_f32 v57, v170, v171
    v_cos_f32 v164, v148
    v_cos_f32 v172, v149
    v_add_f32 v148, v148, v146
    v_add_f32 v149, v149, v147
    v_cos_f32 v165, v148
    v_cos_f32 v173, v149
    v_add_f32 v148, v148, v146
    v_add_f32 v149, v149, v147
    v_cvt_pk_bf16_f32 v42, v164, v165
    v_cvt_pk_bf16_f32 v58, v172, v173
    s_add_u32 m0, s31, 16384
    s_nop 0
    global_load_lds_dwordx4 v5, s[28:29]
    s_add_u32 s28, s28, s30
    s_addc_u32 s29, s29, 0
    v_cos_f32 v166, v148
    v_cos_f32 v174, v149
    v_add_f32 v148, v148, v146
    v_add_f32 v149, v149, v147
    v_cos_f32 v167, v148
    v_cos_f32 v175, v149
    v_add_f32 v148, v148, v150
    v_add_f32 v149, v149, v151
    v_cvt_pk_bf16_f32 v43, v166, v167
    v_cvt_pk_bf16_f32 v59, v174, v175
    v_cos_f32 v160, v148
    v_cos_f32 v168, v149
    v_add_f32 v148, v148, v146
    v_add_f32 v149, v149, v147
    v_cos_f32 v161, v148
    v_cos_f32 v169, v149
    v_add_f32 v148, v148, v146
    v_add_f32 v149, v149, v147
    v_cvt_pk_bf16_f32 v44, v160, v161
    v_cvt_pk_bf16_f32 v60, v168, v169
    v_cos_f32 v162, v148
    v_cos_f32 v170, v149
    v_add_f32 v148, v148, v146
    v_add_f32 v149, v149, v147
    v_cos_f32 v163, v148
    v_cos_f32 v171, v149
    v_add_f32 v148, v148, v146
    v_add_f32 v149, v149, v147
    v_cvt_pk_bf16_f32 v45, v162, v163
    v_cvt_pk_bf16_f32 v61, v170, v171
    v_cos_f32 v164, v148
    v_cos_f32 v172, v149
    v_add_f32 v148, v148, v146
    v_add_f32 v149, v149, v147
    v_cos_f32 v165, v148
    v_cos_f32 v173, v149
    v_add_f32 v148, v148, v146
    v_add_f32 v149, v149, v147
    v_cvt_pk_bf16_f32 v46, v164, v165
    v_cvt_pk_bf16_f32 v62, v172, v173
    v_cos_f32 v166, v148
    v_cos_f32 v174, v149
    v_add_f32 v148, v148, v146
    v_add_f32 v149, v149, v147
    v_cos_f32 v167, v148
    v_cos_f32 v175, v149
    v_cvt_pk_bf16_f32 v47, v166, v167
    v_cvt_pk_bf16_f32 v63, v174, v175
    v_lshrrev_b32 v21, 3, v2
    v_and_b32 v22, 7, v2
    v_bfe_u32 v23, v2, 4, 1
    v_lshlrev_b32 v23, 2, v23
    v_xor_b32 v23, v23, v22
    v_lshlrev_b32 v23, 4, v23
    v_lshl_add_u32 v23, v21, 7, v23
    s_add_u32 s40, s31, 65536
    v_add_u32 v17, s40, v23
    v_bfe_u32 v21, v2, 2, 2
    v_and_b32 v22, 3, v2
    s_lshr_b32 s40, s3, 2
    s_lshl_b32 s40, s40, 5
    s_and_b32 s41, s3, 3
    s_lshl_b32 s41, s41, 2
    s_add_u32 s40, s40, s41
    s_lshl_b32 s40, s40, 7
    s_add_u32 s40, s40, 65536
    v_lshrrev_b32 v23, 1, v22
    v_lshl_add_u32 v23, v3, 1, v23
    v_lshrrev_b32 v18, 1, v21
    v_lshlrev_b32 v18, 2, v18
    v_xor_b32 v23, v23, v18
    v_lshlrev_b32 v23, 4, v23
    v_lshl_add_u32 v23, v21, 7, v23
    v_and_b32 v22, 1, v22
    v_lshl_add_u32 v23, v22, 3, v23
    v_add_u32 v18, s40, v23
    s_and_b32 s40, s3, 3
    s_lshl_b32 s40, s40, 1
    s_lshr_b32 s41, s3, 2
    s_add_u32 s40, s40, s41
    v_and_b32 v22, 7, v2
    v_xor_b32 v22, s40, v22
    v_lshlrev_b32 v22, 4, v22
    v_lshl_add_u32 v22, v2, 7, v22
    v_add_u32 v19, 73728, v22
    v_lshrrev_b32 v21, 3, v2
    v_and_b32 v22, 7, v2
    v_xor_b32 v22, v22, v21
    v_lshlrev_b32 v22, 4, v22
    v_lshl_add_u32 v22, v21, 13, v22
    s_and_b32 s40, s2, 3
    s_lshl_b32 s40, s40, 3
    s_add_u32 s40, s40, s3
    s_lshl_b32 s40, s40, 16
    s_lshl_b32 s41, s27, 7
    s_add_u32 s40, s40, s41
    s_add_u32 s40, s40, 20971520
    v_add_u32 v20, s40, v22
    s_cmp_eq_u32 s26, 2
    s_cbranch_scc1 k1_pre_c
    v_and_b32 v21, 6, v4
    v_xor_b32 v21, v21, v3
    v_lshlrev_b32 v21, 4, v21
    v_lshl_add_u32 v6, v4, 7, v21
    v_xor_b32 v7, 64, v6
    s_cmp_eq_u32 s26, 0
    s_cselect_b32 s40, s25, 0
    s_cmp_eq_u32 s40, 1
    s_cbranch_scc0 k1_plain
    s_and_b32 s40, s3, 3
    s_lshl_b32 s40, s40, 11
    v_add_u32 v188, s40, v6
    v_add_u32 v189, s40, v7
    s_cmp_ge_u32 s3, 4
    s_cselect_b64 vcc, -1, 0
    v_mov_b32 v184, 0
    v_mov_b32 v185, 0
    v_mov_b32 v186, 0
    v_mov_b32 v187, 0
    s_waitcnt vmcnt(3)
    ds_write_b128 v17, v[24:27]
    s_waitcnt vmcnt(2) lgkmcnt(0)
    s_barrier
    ds_read_b128 v[80:83], v6 offset:0
    ds_read_b128 v[84:87], v6 offset:2048
    ds_read_b128 v[88:91], v6 offset:4096
    ds_read_b128 v[92:95], v6 offset:6144
    ds_read_b64_tr_b16 v[24:25], v18
    ds_read_b64_tr_b16 v[26:27], v18 offset:2048
    ds_read_b128 v[176:179], v188
    s_add_u32 m0, s31, 24576
    s_nop 0
    global_load_lds_dwordx4 v5, s[28:29]
    s_add_u32 s28, s28, s30
    s_addc_u32 s29, s29, 0
    s_waitcnt lgkmcnt(0)
    v_mfma_f32_16x16x32_bf16 v[112:115], v[80:83], v[32:35], 0
    ds_write_b128 v19, v[24:27]
    v_mfma_f32_16x16x32_bf16 v[116:119], v[80:83], v[48:51], 0
    v_mfma_f32_16x16x32_bf16 v[120:123], v[84:87], v[32:35], 0
    ds_read_b128 v[96:99], v7 offset:0
    s_cbranch_vccnz k1_st0
    v_mfma_f32_16x16x32_bf16 v[184:187], v[176:179], v[176:179], v[184:187]
k1_st0:
    v_mfma_f32_16x16x32_bf16 v[124:127], v[84:87], v[48:51], 0
    ds_read_b128 v[100:103], v7 offset:2048
    v_mfma_f32_16x16x32_bf16 v[128:131], v[88:91], v[32:35], 0
    ds_read_b128 v[104:107], v7 offset:4096
    v_mfma_f32_16x16x32_bf16 v[132:135], v[88:91], v[48:51], 0
    ds_read_b128 v[108:111], v7 offset:6144
    v_mfma_f32_16x16x32_bf16 v[136:139], v[92:95], v[32:35], 0
    ds_read_b128 v[180:183], v189 offset:0
    v_mfma_f32_16x16x32_bf16 v[140:143], v[92:95], v[48:51], 0
    s_waitcnt lgkmcnt(0)
    v_mfma_f32_16x16x32_bf16 v[112:115], v[96:99], v[36:39], v[112:115]
    v_mfma_f32_16x16x32_bf16 v[116:119], v[96:99], v[52:55], v[116:119]
    s_waitcnt vmcnt(2) lgkmcnt(0)
    s_barrier
    v_mfma_f32_16x16x32_bf16 v[120:123], v[100:103], v[36:39], v[120:123]
    s_add_u32 m0, s31, 32768
    ds_read_b128 v[80:83], v6 offset:8192
    ds_read_b128 v[84:87], v6 offset:10240
    s_cbranch_vccz k1_st1
    v_mfma_f32_16x16x32_bf16 v[184:187], v[180:183], v[180:183], v[184:187]
k1_st1:
    v_mfma_f32_16x16x32_bf16 v[124:127], v[100:103], v[52:55], v[124:127]
    global_load_lds_dwordx4 v5, s[28:29]
    s_add_u32 s28, s28, s30
    s_addc_u32 s29, s29, 0
    ds_read_b128 v[88:91], v6 offset:12288
    v_mfma_f32_16x16x32_bf16 v[128:131], v[104:107], v[36:39], v[128:131]
    ds_read_b128 v[92:95], v6 offset:14336
    ds_read_b128 v[176:179], v188 offset:8192
    v_mfma_f32_16x16x32_bf16 v[132:135], v[104:107], v[52:55], v[132:135]
    v_lshlrev_b32 v21, 4, v2
    v_mfma_f32_16x16x32_bf16 v[136:139], v[108:111], v[36:39], v[136:139]
    s_add_u32 s40, s31, 73728
    v_add_u32 v21, s40, v21
    v_mfma_f32_16x16x32_bf16 v[140:143], v[108:111], v[52:55], v[140:143]
    ds_read_b128 v[24:27], v21
    s_waitcnt lgkmcnt(0)
    v_mfma_f32_16x16x32_bf16 v[112:115], v[80:83], v[40:43], v[112:115]
    v_mfma_f32_16x16x32_bf16 v[116:119], v[80:83], v[56:59], v[116:119]
    v_mfma_f32_16x16x32_bf16 v[120:123], v[84:87], v[40:43], v[120:123]
    ds_read_b128 v[96:99], v7 offset:8192
    s_cbranch_vccnz k1_st2
    v_mfma_f32_16x16x32_bf16 v[184:187], v[176:179], v[176:179], v[184:187]
k1_st2:
    v_mfma_f32_16x16x32_bf16 v[124:127], v[84:87], v[56:59], v[124:127]
    ds_read_b128 v[100:103], v7 offset:10240
    v_mfma_f32_16x16x32_bf16 v[128:131], v[88:91], v[40:43], v[128:131]
    ds_read_b128 v[104:107], v7 offset:12288
    v_mfma_f32_16x16x32_bf16 v[132:135], v[88:91], v[56:59], v[132:135]
    ds_read_b128 v[108:111], v7 offset:14336
    v_mfma_f32_16x16x32_bf16 v[136:139], v[92:95], v[40:43], v[136:139]
    ds_read_b128 v[180:183], v189 offset:8192
    v_mfma_f32_16x16x32_bf16 v[140:143], v[92:95], v[56:59], v[140:143]
    s_waitcnt lgkmcnt(0)
    v_mfma_f32_16x16x32_bf16 v[112:115], v[96:99], v[44:47], v[112:115]
    v_mfma_f32_16x16x32_bf16 v[116:119], v[96:99], v[60:63], v[116:119]
    s_waitcnt vmcnt(2)
    s_barrier
    v_mfma_f32_16x16x32_bf16 v[120:123], v[100:103], v[44:47], v[120:123]
    s_add_u32 m0, s31, 40960
    ds_read_b128 v[80:83], v6 offset:16384
    v_xor_b32_dpp v64, v32, v10 quad_perm:[1,0,2,3] row_mask:0xf bank_mask:0xf
    v_xor_b32_dpp v65, v33, v10 quad_perm:[1,0,2,3] row_mask:0xf bank_mask:0xf
    s_cbranch_vccz k1_st3
    v_mfma_f32_16x16x32_bf16 v[184:187], v[180:183], v[180:183], v[184:187]
k1_st3:
    v_mfma_f32_16x16x32_bf16 v[124:127], v[100:103], v[60:63], v[124:127]
    global_load_lds_dwordx4 v5, s[28:29]
    s_add_u32 s28, s28, s30
    s_addc_u32 s29, s29, 0
    ds_read_b128 v[84:87], v6 offset:18432
    v_xor_b32_dpp v66, v34, v10 quad_perm:[1,0,2,3] row_mask:0xf bank_mask:0xf
    v_mfma_f32_16x16x32_bf16 v[128:131], v[104:107], v[44:47], v[128:131]
    ds_read_b128 v[88:91], v6 offset:20480
    v_xor_b32_dpp v67, v35, v10 quad_perm:[1,0,2,3] row_mask:0xf bank_mask:0xf
    v_mfma_f32_16x16x32_bf16 v[132:135], v[104:107], v[60:63], v[132:135]
    ds_read_b128 v[92:95], v6 offset:22528
    v_xor_b32_dpp v68, v48, v11 quad_perm:[1,0,2,3] row_mask:0xf bank_mask:0xf
    v_xor_b32_dpp v69, v49, v11 quad_perm:[1,0,2,3] row_mask:0xf bank_mask:0xf
    v_mfma_f32_16x16x32_bf16 v[136:139], v[108:111], v[44:47], v[136:139]
    ds_read_b128 v[176:179], v188 offset:16384
    v_xor_b32_dpp v70, v50, v11 quad_perm:[1,0,2,3] row_mask:0xf bank_mask:0xf
    v_mfma_f32_16x16x32_bf16 v[140:143], v[108:111], v[60:63], v[140:143]
    v_xor_b32_dpp v71, v51, v11 quad_perm:[1,0,2,3] row_mask:0xf bank_mask:0xf
    s_waitcnt lgkmcnt(0)
    v_mfma_f32_16x16x32_bf16 v[112:115], v[80:83], v[64:67], v[112:115]
    v_mfma_f32_16x16x32_bf16 v[116:119], v[80:83], v[68:71], v[116:119]
    v_mfma_f32_16x16x32_bf16 v[120:123], v[84:87], v[64:67], v[120:123]
    ds_read_b128 v[96:99], v7 offset:16384
    v_xor_b32_dpp v72, v36, v10 quad_perm:[1,0,2,3] row_mask:0xf bank_mask:0xf
    v_xor_b32_dpp v73, v37, v10 quad_perm:[1,0,2,3] row_mask:0xf bank_mask:0xf
    s_cbranch_vccnz k1_st4
    v_mfma_f32_16x16x32_bf16 v[184:187], v[176:179], v[176:179], v[184:187]
k1_st4:
    v_mfma_f32_16x16x32_bf16 v[124:127], v[84:87], v[68:71], v[124:127]
    ds_read_b128 v[100:103], v7 offset:18432
    v_xor_b32_dpp v74, v38, v10 quad_perm:[1,0,2,3] row_mask:0xf bank_mask:0xf
    v_mfma_f32_16x16x32_bf16 v[128:131], v[88:91], v[64:67], v[128:131]
    ds_read_b128 v[104:107], v7 offset:20480
    v_xor_b32_dpp v75, v39, v10 quad_perm:[1,0,2,3] row_mask:0xf bank_mask:0xf
    v_mfma_f32_16x16x32_bf16 v[132:135], v[88:91], v[68:71], v[132:135]
    ds_read_b128 v[108:111], v7 offset:22528
    v_xor_b32_dpp v76, v52, v11 quad_perm:[1,0,2,3] row_mask:0xf bank_mask:0xf
    v_xor_b32_dpp v77, v53, v11 quad_perm:[1,0,2,3] row_mask:0xf bank_mask:0xf
    v_mfma_f32_16x16x32_bf16 v[136:139], v[92:95], v[64:67], v[136:139]
    ds_read_b128 v[180:183], v189 offset:16384
    v_xor_b32_dpp v78, v54, v11 quad_perm:[1,0,2,3] row_mask:0xf bank_mask:0xf
    v_mfma_f32_16x16x32_bf16 v[140:143], v[92:95], v[68:71], v[140:143]
    v_xor_b32_dpp v79, v55, v11 quad_perm:[1,0,2,3] row_mask:0xf bank_mask:0xf
    s_waitcnt lgkmcnt(0)
    v_mfma_f32_16x16x32_bf16 v[112:115], v[96:99], v[72:75], v[112:115]
    v_mfma_f32_16x16x32_bf16 v[116:119], v[96:99], v[76:79], v[116:119]
    s_waitcnt vmcnt(2)
    s_barrier
    v_mfma_f32_16x16x32_bf16 v[120:123], v[100:103], v[72:75], v[120:123]
    s_add_u32 m0, s31, 49152
    ds_read_b128 v[80:83], v6 offset:24576
    v_xor_b32_dpp v64, v40, v10 quad_perm:[1,0,2,3] row_mask:0xf bank_mask:0xf
    v_xor_b32_dpp v65, v41, v10 quad_perm:[1,0,2,3] row_mask:0xf bank_mask:0xf
    s_cbranch_vccz k1_st5
    v_mfma_f32_16x16x32_bf16 v[184:187], v[180:183], v[180:183], v[184:187]
k1_st5:
    v_mfma_f32_16x16x32_bf16 v[124:127], v[100:103], v[76:79], v[124:127]
    global_load_lds_dwordx4 v5, s[28:29]
    s_add_u32 s28, s28, s30
    s_addc_u32 s29, s29, 0
    ds_read_b128 v[84:87], v6 offset:26624
    v_xor_b32_dpp v66, v42, v10 quad_perm:[1,0,2,3] row_mask:0xf bank_mask:0xf
    v_mfma_f32_16x16x32_bf16 v[128:131], v[104:107], v[72:75], v[128:131]
    ds_read_b128 v[88:91], v6 offset:28672
    v_xor_b32_dpp v67, v43, v10 quad_perm:[1,0,2,3] row_mask:0xf bank_mask:0xf
    v_mfma_f32_16x16x32_bf16 v[132:135], v[104:107], v[76:79], v[132:135]
    ds_read_b128 v[92:95], v6 offset:30720
    v_xor_b32_dpp v68, v56, v11 quad_perm:[1,0,2,3] row_mask:0xf bank_mask:0xf
    v_xor_b32_dpp v69, v57, v11 quad_perm:[1,0,2,3] row_mask:0xf bank_mask:0xf
    v_mfma_f32_16x16x32_bf16 v[136:139], v[108:111], v[72:75], v[136:139]
    ds_read_b128 v[176:179], v188 offset:24576
    v_xor_b32_dpp v70, v58, v11 quad_perm:[1,0,2,3] row_mask:0xf bank_mask:0xf
    v_mfma_f32_16x16x32_bf16 v[140:143], v[108:111], v[76:79], v[140:143]
    v_xor_b32_dpp v71, v59, v11 quad_perm:[1,0,2,3] row_mask:0xf bank_mask:0xf
    s_waitcnt lgkmcnt(0)
    v_mfma_f32_16x16x32_bf16 v[112:115], v[80:83], v[64:67], v[112:115]
    v_mfma_f32_16x16x32_bf16 v[116:119], v[80:83], v[68:71], v[116:119]
    v_mfma_f32_16x16x32_bf16 v[120:123], v[84:87], v[64:67], v[120:123]
    ds_read_b128 v[96:99], v7 offset:24576
    v_xor_b32_dpp v72, v44, v10 quad_perm:[1,0,2,3] row_mask:0xf bank_mask:0xf
    v_xor_b32_dpp v73, v45, v10 quad_perm:[1,0,2,3] row_mask:0xf bank_mask:0xf
    s_cbranch_vccnz k1_st6
    v_mfma_f32_16x16x32_bf16 v[184:187], v[176:179], v[176:179], v[184:187]
k1_st6:
    v_mfma_f32_16x16x32_bf16 v[124:127], v[84:87], v[68:71], v[124:127]
    ds_read_b128 v[100:103], v7 offset:26624
    v_xor_b32_dpp v74, v46, v10 quad_perm:[1,0,2,3] row_mask:0xf bank_mask:0xf
    v_mfma_f32_16x16x32_bf16 v[128:131], v[88:91], v[64:67], v[128:131]
    ds_read_b128 v[104:107], v7 offset:28672
    v_xor_b32_dpp v75, v47, v10 quad_perm:[1,0,2,3] row_mask:0xf bank_mask:0xf
    v_mfma_f32_16x16x32_bf16 v[132:135], v[88:91], v[68:71], v[132:135]
    ds_read_b128 v[108:111], v7 offset:30720
    v_xor_b32_dpp v76, v60, v11 quad_perm:[1,0,2,3] row_mask:0xf bank_mask:0xf
    v_xor_b32_dpp v77, v61, v11 quad_perm:[1,0,2,3] row_mask:0xf bank_mask:0xf
    v_mfma_f32_16x16x32_bf16 v[136:139], v[92:95], v[64:67], v[136:139]
    ds_read_b128 v[180:183], v189 offset:24576
    v_xor_b32_dpp v78, v62, v11 quad_perm:[1,0,2,3] row_mask:0xf bank_mask:0xf
    v_mfma_f32_16x16x32_bf16 v[140:143], v[92:95], v[68:71], v[140:143]
    v_xor_b32_dpp v79, v63, v11 quad_perm:[1,0,2,3] row_mask:0xf bank_mask:0xf
    s_waitcnt lgkmcnt(0)
    v_mfma_f32_16x16x32_bf16 v[112:115], v[96:99], v[72:75], v[112:115]
    v_mfma_f32_16x16x32_bf16 v[116:119], v[96:99], v[76:79], v[116:119]
    s_waitcnt vmcnt(2)
    s_barrier
    v_mfma_f32_16x16x32_bf16 v[120:123], v[100:103], v[72:75], v[120:123]
    s_add_u32 m0, s31, 57344
    ds_read_b128 v[80:83], v6 offset:32768
    v_xor_b32 v64, v12, v32
    v_xor_b32 v65, v12, v33
    s_cbranch_vccz k1_st7
    v_mfma_f32_16x16x32_bf16 v[184:187], v[180:183], v[180:183], v[184:187]
k1_st7:
    v_mfma_f32_16x16x32_bf16 v[124:127], v[100:103], v[76:79], v[124:127]
    global_load_lds_dwordx4 v5, s[28:29]
    s_add_u32 s28, s28, s30
    s_addc_u32 s29, s29, 0
    ds_read_b128 v[84:87], v6 offset:34816
    v_xor_b32 v66, v12, v34
    v_mfma_f32_16x16x32_bf16 v[128:131], v[104:107], v[72:75], v[128:131]
    ds_read_b128 v[88:91], v6 offset:36864
    v_xor_b32 v67, v12, v35
    v_mfma_f32_16x16x32_bf16 v[132:135], v[104:107], v[76:79], v[132:135]
    ds_read_b128 v[92:95], v6 offset:38912
    v_xor_b32 v68, v12, v48
    v_xor_b32 v69, v12, v49
    v_mfma_f32_16x16x32_bf16 v[136:139], v[108:111], v[72:75], v[136:139]
    ds_read_b128 v[176:179], v188 offset:32768
    v_xor_b32 v70, v12, v50
    v_mfma_f32_16x16x32_bf16 v[140:143], v[108:111], v[76:79], v[140:143]
    v_xor_b32 v71, v12, v51
    s_waitcnt lgkmcnt(0)
    v_mfma_f32_16x16x32_bf16 v[112:115], v[80:83], v[64:67], v[112:115]
    v_mfma_f32_16x16x32_bf16 v[116:119], v[80:83], v[68:71], v[116:119]
    v_mfma_f32_16x16x32_bf16 v[120:123], v[84:87], v[64:67], v[120:123]
    ds_read_b128 v[96:99], v7 offset:32768
    v_xor_b32 v72, v12, v36
    v_xor_b32 v73, v12, v37
    s_cbranch_vccnz k1_st8
    v_mfma_f32_16x16x32_bf16 v[184:187], v[176:179], v[176:179], v[184:187]
k1_st8:
    v_mfma_f32_16x16x32_bf16 v[124:127], v[84:87], v[68:71], v[124:127]
    ds_read_b128 v[100:103], v7 offset:34816
    v_xor_b32 v74, v12, v38
    v_mfma_f32_16x16x32_bf16 v[128:131], v[88:91], v[64:67], v[128:131]
    ds_read_b128 v[104:107], v7 offset:36864
    v_xor_b32 v75, v12, v39
    v_mfma_f32_16x16x32_bf16 v[132:135], v[88:91], v[68:71], v[132:135]
    ds_read_b128 v[108:111], v7 offset:38912
    v_xor_b32 v76, v12, v52
    v_xor_b32 v77, v12, v53
    v_mfma_f32_16x16x32_bf16 v[136:139], v[92:95], v[64:67], v[136:139]
    ds_read_b128 v[180:183], v189 offset:32768
    v_xor_b32 v78, v12, v54
    v_mfma_f32_16x16x32_bf16 v[140:143], v[92:95], v[68:71], v[140:143]
    v_xor_b32 v79, v12, v55
    s_waitcnt lgkmcnt(0)
    v_mfma_f32_16x16x32_bf16 v[112:115], v[96:99], v[72:75], v[112:115]
    v_mfma_f32_16x16x32_bf16 v[116:119], v[96:99], v[76:79], v[116:119]
    s_waitcnt vmcnt(2)
    s_barrier
    v_mfma_f32_16x16x32_bf16 v[120:123], v[100:103], v[72:75], v[120:123]
    ds_read_b128 v[80:83], v6 offset:40960
    v_xor_b32 v64, v12, v40
    v_xor_b32 v65, v12, v41
    s_cbranch_vccz k1_st9
    v_mfma_f32_16x16x32_bf16 v[184:187], v[180:183], v[180:183], v[184:187]
k1_st9:
    v_mfma_f32_16x16x32_bf16 v[124:127], v[100:103], v[76:79], v[124:127]
    ds_read_b128 v[84:87], v6 offset:43008
    v_xor_b32 v66, v12, v42
    v_mfma_f32_16x16x32_bf16 v[128:131], v[104:107], v[72:75], v[128:131]
    ds_read_b128 v[88:91], v6 offset:45056
    v_xor_b32 v67, v12, v43
    v_mfma_f32_16x16x32_bf16 v[132:135], v[104:107], v[76:79], v[132:135]
    ds_read_b128 v[92:95], v6 offset:47104
    v_xor_b32 v68, v12, v56
    v_xor_b32 v69, v12, v57
    v_mfma_f32_16x16x32_bf16 v[136:139], v[108:111], v[72:75], v[136:139]
    ds_read_b128 v[176:179], v188 offset:40960
    v_xor_b32 v70, v12, v58
    v_mfma_f32_16x16x32_bf16 v[140:143], v[108:111], v[76:79], v[140:143]
    v_xor_b32 v71, v12, v59
    s_waitcnt lgkmcnt(0)
    v_mfma_f32_16x16x32_bf16 v[112:115], v[80:83], v[64:67], v[112:115]
    v_mfma_f32_16x16x32_bf16 v[116:119], v[80:83], v[68:71], v[116:119]
    v_mfma_f32_16x16x32_bf16 v[120:123], v[84:87], v[64:67], v[120:123]
    ds_read_b128 v[96:99], v7 offset:40960
    v_xor_b32 v72, v12, v44
    v_xor_b32 v73, v12, v45
    s_cbranch_vccnz k1_st10
    v_mfma_f32_16x16x32_bf16 v[184:187], v[176:179], v[176:179], v[184:187]
k1_st10:
    v_mfma_f32_16x16x32_bf16 v[124:127], v[84:87], v[68:71], v[124:127]
    ds_read_b128 v[100:103], v7 offset:43008
    v_xor_b32 v74, v12, v46
    v_mfma_f32_16x16x32_bf16 v[128:131], v[88:91], v[64:67], v[128:131]
    ds_read_b128 v[104:107], v7 offset:45056
    v_xor_b32 v75, v12, v47
    v_mfma_f32_16x16x32_bf16 v[132:135], v[88:91], v[68:71], v[132:135]
    ds_read_b128 v[108:111], v7 offset:47104
    v_xor_b32 v76, v12, v60
    v_xor_b32 v77, v12, v61
    v_mfma_f32_16x16x32_bf16 v[136:139], v[92:95], v[64:67], v[136:139]
    ds_read_b128 v[180:183], v189 offset:40960
    v_xor_b32 v78, v12, v62
    v_mfma_f32_16x16x32_bf16 v[140:143], v[92:95], v[68:71], v[140:143]
    v_xor_b32 v79, v12, v63
    s_waitcnt lgkmcnt(0)
    v_mfma_f32_16x16x32_bf16 v[112:115], v[96:99], v[72:75], v[112:115]
    v_mfma_f32_16x16x32_bf16 v[116:119], v[96:99], v[76:79], v[116:119]
    s_waitcnt vmcnt(1)
    s_barrier
    v_mfma_f32_16x16x32_bf16 v[120:123], v[100:103], v[72:75], v[120:123]
    ds_read_b128 v[80:83], v6 offset:49152
    v_xor_b32_dpp v64, v32, v13 quad_perm:[1,0,2,3] row_mask:0xf bank_mask:0xf
    v_xor_b32_dpp v65, v33, v13 quad_perm:[1,0,2,3] row_mask:0xf bank_mask:0xf
    s_cbranch_vccz k1_st11
    v_mfma_f32_16x16x32_bf16 v[184:187], v[180:183], v[180:183], v[184:187]
k1_st11:
    v_mfma_f32_16x16x32_bf16 v[124:127], v[100:103], v[76:79], v[124:127]
    ds_read_b128 v[84:87], v6 offset:51200
    v_xor_b32_dpp v66, v34, v13 quad_perm:[1,0,2,3] row_mask:0xf bank_mask:0xf
    v_mfma_f32_16x16x32_bf16 v[128:131], v[104:107], v[72:75], v[128:131]
    ds_read_b128 v[88:91], v6 offset:53248
    v_xor_b32_dpp v67, v35, v13 quad_perm:[1,0,2,3] row_mask:0xf bank_mask:0xf
    v_mfma_f32_16x16x32_bf16 v[132:135], v[104:107], v[76:79], v[132:135]
    ds_read_b128 v[92:95], v6 offset:55296
    v_xor_b32_dpp v68, v48, v14 quad_perm:[1,0,2,3] row_mask:0xf bank_mask:0xf
    v_xor_b32_dpp v69, v49, v14 quad_perm:[1,0,2,3] row_mask:0xf bank_mask:0xf
    v_mfma_f32_16x16x32_bf16 v[136:139], v[108:111], v[72:75], v[136:139]
    ds_read_b128 v[176:179], v188 offset:49152
    v_xor_b32_dpp v70, v50, v14 quad_perm:[1,0,2,3] row_mask:0xf bank_mask:0xf
    v_mfma_f32_16x16x32_bf16 v[140:143], v[108:111], v[76:79], v[140:143]
    v_xor_b32_dpp v71, v51, v14 quad_perm:[1,0,2,3] row_mask:0xf bank_mask:0xf
    s_waitcnt lgkmcnt(0)
    v_mfma_f32_16x16x32_bf16 v[112:115], v[80:83], v[64:67], v[112:115]
    v_mfma_f32_16x16x32_bf16 v[116:119], v[80:83], v[68:71], v[116:119]
    v_mfma_f32_16x16x32_bf16 v[120:123], v[84:87], v[64:67], v[120:123]
    ds_read_b128 v[96:99], v7 offset:49152
    v_xor_b32_dpp v72, v36, v13 quad_perm:[1,0,2,3] row_mask:0xf bank_mask:0xf
    v_xor_b32_dpp v73, v37, v13 quad_perm:[1,0,2,3] row_mask:0xf bank_mask:0xf
    s_cbranch_vccnz k1_st12
    v_mfma_f32_16x16x32_bf16 v[184:187], v[176:179], v[176:179], v[184:187]
k1_st12:
    v_mfma_f32_16x16x32_bf16 v[124:127], v[84:87], v[68:71], v[124:127]
    ds_read_b128 v[100:103], v7 offset:51200
    v_xor_b32_dpp v74, v38, v13 quad_perm:[1,0,2,3] row_mask:0xf bank_mask:0xf
    v_mfma_f32_16x16x32_bf16 v[128:131], v[88:91], v[64:67], v[128:131]
    ds_read_b128 v[104:107], v7 offset:53248
    v_xor_b32_dpp v75, v39, v13 quad_perm:[1,0,2,3] row_mask:0xf bank_mask:0xf
    v_mfma_f32_16x16x32_bf16 v[132:135], v[88:91], v[68:71], v[132:135]
    ds_read_b128 v[108:111], v7 offset:55296
    v_xor_b32_dpp v76, v52, v14 quad_perm:[1,0,2,3] row_mask:0xf bank_mask:0xf
    v_xor_b32_dpp v77, v53, v14 quad_perm:[1,0,2,3] row_mask:0xf bank_mask:0xf
    v_mfma_f32_16x16x32_bf16 v[136:139], v[92:95], v[64:67], v[136:139]
    ds_read_b128 v[180:183], v189 offset:49152
    v_xor_b32_dpp v78, v54, v14 quad_perm:[1,0,2,3] row_mask:0xf bank_mask:0xf
    v_mfma_f32_16x16x32_bf16 v[140:143], v[92:95], v[68:71], v[140:143]
    v_xor_b32_dpp v79, v55, v14 quad_perm:[1,0,2,3] row_mask:0xf bank_mask:0xf
    s_waitcnt lgkmcnt(0)
    v_mfma_f32_16x16x32_bf16 v[112:115], v[96:99], v[72:75], v[112:115]
    v_mfma_f32_16x16x32_bf16 v[116:119], v[96:99], v[76:79], v[116:119]
    s_waitcnt vmcnt(0)
    s_barrier
    v_mfma_f32_16x16x32_bf16 v[120:123], v[100:103], v[72:75], v[120:123]
    ds_read_b128 v[80:83], v6 offset:57344
    v_xor_b32_dpp v64, v40, v13 quad_perm:[1,0,2,3] row_mask:0xf bank_mask:0xf
    v_xor_b32_dpp v65, v41, v13 quad_perm:[1,0,2,3] row_mask:0xf bank_mask:0xf
    s_cbranch_vccz k1_st13
    v_mfma_f32_16x16x32_bf16 v[184:187], v[180:183], v[180:183], v[184:187]
k1_st13:
    v_mfma_f32_16x16x32_bf16 v[124:127], v[100:103], v[76:79], v[124:127]
    ds_read_b128 v[84:87], v6 offset:59392
    v_xor_b32_dpp v66, v42, v13 quad_perm:[1,0,2,3] row_mask:0xf bank_mask:0xf
    v_mfma_f32_16x16x32_bf16 v[128:131], v[104:107], v[72:75], v[128:131]
    ds_read_b128 v[88:91], v6 offset:61440
    v_xor_b32_dpp v67, v43, v13 quad_perm:[1,0,2,3] row_mask:0xf bank_mask:0xf
    v_mfma_f32_16x16x32_bf16 v[132:135], v[104:107], v[76:79], v[132:135]
    ds_read_b128 v[92:95], v6 offset:63488
    v_xor_b32_dpp v68, v56, v14 quad_perm:[1,0,2,3] row_mask:0xf bank_mask:0xf
    v_xor_b32_dpp v69, v57, v14 quad_perm:[1,0,2,3] row_mask:0xf bank_mask:0xf
    v_mfma_f32_16x16x32_bf16 v[136:139], v[108:111], v[72:75], v[136:139]
    ds_read_b128 v[176:179], v188 offset:57344
    v_xor_b32_dpp v70, v58, v14 quad_perm:[1,0,2,3] row_mask:0xf bank_mask:0xf
    v_mfma_f32_16x16x32_bf16 v[140:143], v[108:111], v[76:79], v[140:143]
    v_xor_b32_dpp v71, v59, v14 quad_perm:[1,0,2,3] row_mask:0xf bank_mask:0xf
    s_waitcnt lgkmcnt(0)
    v_mfma_f32_16x16x32_bf16 v[112:115], v[80:83], v[64:67], v[112:115]
    v_mfma_f32_16x16x32_bf16 v[116:119], v[80:83], v[68:71], v[116:119]
    v_mfma_f32_16x16x32_bf16 v[120:123], v[84:87], v[64:67], v[120:123]
    ds_read_b128 v[96:99], v7 offset:57344
    v_xor_b32_dpp v72, v44, v13 quad_perm:[1,0,2,3] row_mask:0xf bank_mask:0xf
    v_xor_b32_dpp v73, v45, v13 quad_perm:[1,0,2,3] row_mask:0xf bank_mask:0xf
    s_cbranch_vccnz k1_st14
    v_mfma_f32_16x16x32_bf16 v[184:187], v[176:179], v[176:179], v[184:187]
k1_st14:
    v_mfma_f32_16x16x32_bf16 v[124:127], v[84:87], v[68:71], v[124:127]
    ds_read_b128 v[100:103], v7 offset:59392
    v_xor_b32_dpp v74, v46, v13 quad_perm:[1,0,2,3] row_mask:0xf bank_mask:0xf
    v_mfma_f32_16x16x32_bf16 v[128:131], v[88:91], v[64:67], v[128:131]
    ds_read_b128 v[104:107], v7 offset:61440
    v_xor_b32_dpp v75, v47, v13 quad_perm:[1,0,2,3] row_mask:0xf bank_mask:0xf
    v_xor_b32_dpp v76, v60, v14 quad_perm:[1,0,2,3] row_mask:0xf bank_mask:0xf
    v_mfma_f32_16x16x32_bf16 v[132:135], v[88:91], v[68:71], v[132:135]
    ds_read_b128 v[108:111], v7 offset:63488
    v_xor_b32_dpp v77, v61, v14 quad_perm:[1,0,2,3] row_mask:0xf bank_mask:0xf
    v_mfma_f32_16x16x32_bf16 v[136:139], v[92:95], v[64:67], v[136:139]
    ds_read_b128 v[180:183], v189 offset:57344
    v_xor_b32_dpp v78, v62, v14 quad_perm:[1,0,2,3] row_mask:0xf bank_mask:0xf
    v_xor_b32_dpp v79, v63, v14 quad_perm:[1,0,2,3] row_mask:0xf bank_mask:0xf
    v_mfma_f32_16x16x32_bf16 v[140:143], v[92:95], v[68:71], v[140:143]
    global_store_dwordx4 v20, v[24:27], s[22:23] sc1
    s_waitcnt lgkmcnt(0)
    v_mfma_f32_16x16x32_bf16 v[112:115], v[96:99], v[72:75], v[112:115]
    v_mfma_f32_16x16x32_bf16 v[116:119], v[96:99], v[76:79], v[116:119]
    v_mfma_f32_16x16x32_bf16 v[120:123], v[100:103], v[72:75], v[120:123]
    s_cbranch_vccz k1_st15
    v_mfma_f32_16x16x32_bf16 v[184:187], v[180:183], v[180:183], v[184:187]
k1_st15:
    v_mfma_f32_16x16x32_bf16 v[124:127], v[100:103], v[76:79], v[124:127]
    v_mfma_f32_16x16x32_bf16 v[128:131], v[104:107], v[72:75], v[128:131]
    v_mfma_f32_16x16x32_bf16 v[132:135], v[104:107], v[76:79], v[132:135]
    v_mfma_f32_16x16x32_bf16 v[136:139], v[108:111], v[72:75], v[136:139]
    v_mfma_f32_16x16x32_bf16 v[140:143], v[108:111], v[76:79], v[140:143]
    v_and_b32 v22, 3, v4
    v_cmp_eq_u32 vcc, 1, v22
    s_nop 1
    v_cndmask_b32 v184, v184, v185, vcc
    v_cmp_eq_u32 vcc, 2, v22
    s_nop 1
    v_cndmask_b32 v184, v184, v186, vcc
    v_cmp_eq_u32 vcc, 3, v22
    s_nop 1
    v_cndmask_b32 v184, v184, v187, vcc
    s_lshl_b32 s40, s3, 6
    s_add_u32 s40, s40, 65536
    v_lshl_add_u32 v22, v4, 2, s40
    v_lshlrev_b32 v21, 2, v2
    v_add_u32 v21, 66560, v21
    v_lshrrev_b32 v23, 2, v4
    v_cmp_eq_u32 vcc, v23, v3
    s_nop 1
    v_cndmask_b32 v22, v21, v22, vcc
    ds_write_b32 v22, v184
    s_cmp_eq_u32 s3, 7
    s_cbranch_scc0 k1_epi_ab
    v_lshlrev_b32 v22, 4, v3
    v_add_u32 v22, 66048, v22
    v_lshlrev_b32 v21, 4, v2
    v_add_u32 v21, 67584, v21
    v_cmp_eq_u32 vcc, 15, v4
    s_nop 1
    v_cndmask_b32 v22, v21, v22, vcc
    ds_write_b128 v22, v[116:119] offset:0
    ds_write_b128 v22, v[124:127] offset:64
    ds_write_b128 v22, v[132:135] offset:128
    ds_write_b128 v22, v[140:143] offset:192
    s_branch k1_epi_ab
k1_plain:
    s_waitcnt vmcnt(3)
    ds_write_b128 v17, v[24:27]
    s_waitcnt vmcnt(2) lgkmcnt(0)
    s_barrier
    ds_read_b128 v[80:83], v6 offset:0
    ds_read_b128 v[84:87], v6 offset:2048
    ds_read_b128 v[88:91], v6 offset:4096
    ds_read_b128 v[92:95], v6 offset:6144
    ds_read_b64_tr_b16 v[24:25], v18
    ds_read_b64_tr_b16 v[26:27], v18 offset:2048
    s_add_u32 m0, s31, 24576
    s_nop 0
    global_load_lds_dwordx4 v5, s[28:29]
    s_add_u32 s28, s28, s30
    s_addc_u32 s29, s29, 0
    s_waitcnt lgkmcnt(0)
    v_mfma_f32_16x16x32_bf16 v[112:115], v[80:83], v[32:35], 0
    ds_write_b128 v19, v[24:27]
    v_mfma_f32_16x16x32_bf16 v[116:119], v[80:83], v[48:51], 0
    v_mfma_f32_16x16x32_bf16 v[120:123], v[84:87], v[32:35], 0
    ds_read_b128 v[96:99], v7 offset:0
    v_mfma_f32_16x16x32_bf16 v[124:127], v[84:87], v[48:51], 0
    ds_read_b128 v[100:103], v7 offset:2048
    v_mfma_f32_16x16x32_bf16 v[128:131], v[88:91], v[32:35], 0
    v_mfma_f32_16x16x32_bf16 v[132:135], v[88:91], v[48:51], 0
    ds_read_b128 v[104:107], v7 offset:4096
    v_mfma_f32_16x16x32_bf16 v[136:139], v[92:95], v[32:35], 0
    ds_read_b128 v[108:111], v7 offset:6144
    v_mfma_f32_16x16x32_bf16 v[140:143], v[92:95], v[48:51], 0
    s_waitcnt lgkmcnt(0)
    v_mfma_f32_16x16x32_bf16 v[112:115], v[96:99], v[36:39], v[112:115]
    v_mfma_f32_16x16x32_bf16 v[116:119], v[96:99], v[52:55], v[116:119]
    s_waitcnt vmcnt(2) lgkmcnt(0)
    s_barrier
    v_mfma_f32_16x16x32_bf16 v[120:123], v[100:103], v[36:39], v[120:123]
    s_add_u32 m0, s31, 32768
    ds_read_b128 v[80:83], v6 offset:8192
    ds_read_b128 v[84:87], v6 offset:10240
    v_mfma_f32_16x16x32_bf16 v[124:127], v[100:103], v[52:55], v[124:127]
    global_load_lds_dwordx4 v5, s[28:29]
    s_add_u32 s28, s28, s30
    s_addc_u32 s29, s29, 0
    ds_read_b128 v[88:91], v6 offset:12288
    v_mfma_f32_16x16x32_bf16 v[128:131], v[104:107], v[36:39], v[128:131]
    ds_read_b128 v[92:95], v6 offset:14336
    v_mfma_f32_16x16x32_bf16 v[132:135], v[104:107], v[52:55], v[132:135]
    v_lshlrev_b32 v21, 4, v2
    s_add_u32 s40, s31, 73728
    v_mfma_f32_16x16x32_bf16 v[136:139], v[108:111], v[36:39], v[136:139]
    v_add_u32 v21, s40, v21
    v_mfma_f32_16x16x32_bf16 v[140:143], v[108:111], v[52:55], v[140:143]
    ds_read_b128 v[24:27], v21
    s_waitcnt lgkmcnt(0)
    v_mfma_f32_16x16x32_bf16 v[112:115], v[80:83], v[40:43], v[112:115]
    v_mfma_f32_16x16x32_bf16 v[116:119], v[80:83], v[56:59], v[116:119]
    v_mfma_f32_16x16x32_bf16 v[120:123], v[84:87], v[40:43], v[120:123]
    ds_read_b128 v[96:99], v7 offset:8192
    v_mfma_f32_16x16x32_bf16 v[124:127], v[84:87], v[56:59], v[124:127]
    ds_read_b128 v[100:103], v7 offset:10240
    v_mfma_f32_16x16x32_bf16 v[128:131], v[88:91], v[40:43], v[128:131]
    v_mfma_f32_16x16x32_bf16 v[132:135], v[88:91], v[56:59], v[132:135]
    ds_read_b128 v[104:107], v7 offset:12288
    v_mfma_f32_16x16x32_bf16 v[136:139], v[92:95], v[40:43], v[136:139]
    ds_read_b128 v[108:111], v7 offset:14336
    v_mfma_f32_16x16x32_bf16 v[140:143], v[92:95], v[56:59], v[140:143]
    s_waitcnt lgkmcnt(0)
    v_mfma_f32_16x16x32_bf16 v[112:115], v[96:99], v[44:47], v[112:115]
    v_mfma_f32_16x16x32_bf16 v[116:119], v[96:99], v[60:63], v[116:119]
    s_waitcnt vmcnt(2)
    s_barrier
    v_mfma_f32_16x16x32_bf16 v[120:123], v[100:103], v[44:47], v[120:123]
    s_add_u32 m0, s31, 40960
    ds_read_b128 v[80:83], v6 offset:16384
    v_xor_b32_dpp v64, v32, v10 quad_perm:[1,0,2,3] row_mask:0xf bank_mask:0xf
    v_xor_b32_dpp v65, v33, v10 quad_perm:[1,0,2,3] row_mask:0xf bank_mask:0xf
    v_mfma_f32_16x16x32_bf16 v[124:127], v[100:103], v[60:63], v[124:127]
    global_load_lds_dwordx4 v5, s[28:29]
    s_add_u32 s28, s28, s30
    s_addc_u32 s29, s29, 0
    ds_read_b128 v[84:87], v6 offset:18432
    v_xor_b32_dpp v66, v34, v10 quad_perm:[1,0,2,3] row_mask:0xf bank_mask:0xf
    v_mfma_f32_16x16x32_bf16 v[128:131], v[104:107], v[44:47], v[128:131]
    v_xor_b32_dpp v67, v35, v10 quad_perm:[1,0,2,3] row_mask:0xf bank_mask:0xf
    v_mfma_f32_16x16x32_bf16 v[132:135], v[104:107], v[60:63], v[132:135]
    ds_read_b128 v[88:91], v6 offset:20480
    v_xor_b32_dpp v68, v48, v11 quad_perm:[1,0,2,3] row_mask:0xf bank_mask:0xf
    v_xor_b32_dpp v69, v49, v11 quad_perm:[1,0,2,3] row_mask:0xf bank_mask:0xf
    v_mfma_f32_16x16x32_bf16 v[136:139], v[108:111], v[44:47], v[136:139]
    ds_read_b128 v[92:95], v6 offset:22528
    v_xor_b32_dpp v70, v50, v11 quad_perm:[1,0,2,3] row_mask:0xf bank_mask:0xf
    v_mfma_f32_16x16x32_bf16 v[140:143], v[108:111], v[60:63], v[140:143]
    v_xor_b32_dpp v71, v51, v11 quad_perm:[1,0,2,3] row_mask:0xf bank_mask:0xf
    s_waitcnt lgkmcnt(0)
    v_mfma_f32_16x16x32_bf16 v[112:115], v[80:83], v[64:67], v[112:115]
    v_mfma_f32_16x16x32_bf16 v[116:119], v[80:83], v[68:71], v[116:119]
    v_mfma_f32_16x16x32_bf16 v[120:123], v[84:87], v[64:67], v[120:123]
    ds_read_b128 v[96:99], v7 offset:16384
    v_xor_b32_dpp v72, v36, v10 quad_perm:[1,0,2,3] row_mask:0xf bank_mask:0xf
    v_xor_b32_dpp v73, v37, v10 quad_perm:[1,0,2,3] row_mask:0xf bank_mask:0xf
    v_mfma_f32_16x16x32_bf16 v[124:127], v[84:87], v[68:71], v[124:127]
    ds_read_b128 v[100:103], v7 offset:18432
    v_xor_b32_dpp v74, v38, v10 quad_perm:[1,0,2,3] row_mask:0xf bank_mask:0xf
    v_mfma_f32_16x16x32_bf16 v[128:131], v[88:91], v[64:67], v[128:131]
    v_xor_b32_dpp v75, v39, v10 quad_perm:[1,0,2,3] row_mask:0xf bank_mask:0xf
    v_mfma_f32_16x16x32_bf16 v[132:135], v[88:91], v[68:71], v[132:135]
    ds_read_b128 v[104:107], v7 offset:20480
    v_xor_b32_dpp v76, v52, v11 quad_perm:[1,0,2,3] row_mask:0xf bank_mask:0xf
    v_xor_b32_dpp v77, v53, v11 quad_perm:[1,0,2,3] row_mask:0xf bank_mask:0xf
    v_mfma_f32_16x16x32_bf16 v[136:139], v[92:95], v[64:67], v[136:139]
    ds_read_b128 v[108:111], v7 offset:22528
    v_xor_b32_dpp v78, v54, v11 quad_perm:[1,0,2,3] row_mask:0xf bank_mask:0xf
    v_mfma_f32_16x16x32_bf16 v[140:143], v[92:95], v[68:71], v[140:143]
    v_xor_b32_dpp v79, v55, v11 quad_perm:[1,0,2,3] row_mask:0xf bank_mask:0xf
    s_waitcnt lgkmcnt(0)
    v_mfma_f32_16x16x32_bf16 v[112:115], v[96:99], v[72:75], v[112:115]
    v_mfma_f32_16x16x32_bf16 v[116:119], v[96:99], v[76:79], v[116:119]
    s_waitcnt vmcnt(2)
    s_barrier
    v_mfma_f32_16x16x32_bf16 v[120:123], v[100:103], v[72:75], v[120:123]
    s_add_u32 m0, s31, 49152
    ds_read_b128 v[80:83], v6 offset:24576
    v_xor_b32_dpp v64, v40, v10 quad_perm:[1,0,2,3] row_mask:0xf bank_mask:0xf
    v_xor_b32_dpp v65, v41, v10 quad_perm:[1,0,2,3] row_mask:0xf bank_mask:0xf
    v_mfma_f32_16x16x32_bf16 v[124:127], v[100:103], v[76:79], v[124:127]
    global_load_lds_dwordx4 v5, s[28:29]
    s_add_u32 s28, s28, s30
    s_addc_u32 s29, s29, 0
    ds_read_b128 v[84:87], v6 offset:26624
    v_xor_b32_dpp v66, v42, v10 quad_perm:[1,0,2,3] row_mask:0xf bank_mask:0xf
    v_mfma_f32_16x16x32_bf16 v[128:131], v[104:107], v[72:75], v[128:131]
    v_xor_b32_dpp v67, v43, v10 quad_perm:[1,0,2,3] row_mask:0xf bank_mask:0xf
    v_mfma_f32_16x16x32_bf16 v[132:135], v[104:107], v[76:79], v[132:135]
    ds_read_b128 v[88:91], v6 offset:28672
    v_xor_b32_dpp v68, v56, v11 quad_perm:[1,0,2,3] row_mask:0xf bank_mask:0xf
    v_xor_b32_dpp v69, v57, v11 quad_perm:[1,0,2,3] row_mask:0xf bank_mask:0xf
    v_mfma_f32_16x16x32_bf16 v[136:139], v[108:111], v[72:75], v[136:139]
    ds_read_b128 v[92:95], v6 offset:30720
    v_xor_b32_dpp v70, v58, v11 quad_perm:[1,0,2,3] row_mask:0xf bank_mask:0xf
    v_mfma_f32_16x16x32_bf16 v[140:143], v[108:111], v[76:79], v[140:143]
    v_xor_b32_dpp v71, v59, v11 quad_perm:[1,0,2,3] row_mask:0xf bank_mask:0xf
    s_waitcnt lgkmcnt(0)
    v_mfma_f32_16x16x32_bf16 v[112:115], v[80:83], v[64:67], v[112:115]
    v_mfma_f32_16x16x32_bf16 v[116:119], v[80:83], v[68:71], v[116:119]
    v_mfma_f32_16x16x32_bf16 v[120:123], v[84:87], v[64:67], v[120:123]
    ds_read_b128 v[96:99], v7 offset:24576
    v_xor_b32_dpp v72, v44, v10 quad_perm:[1,0,2,3] row_mask:0xf bank_mask:0xf
    v_xor_b32_dpp v73, v45, v10 quad_perm:[1,0,2,3] row_mask:0xf bank_mask:0xf
    v_mfma_f32_16x16x32_bf16 v[124:127], v[84:87], v[68:71], v[124:127]
    ds_read_b128 v[100:103], v7 offset:26624
    v_xor_b32_dpp v74, v46, v10 quad_perm:[1,0,2,3] row_mask:0xf bank_mask:0xf
    v_mfma_f32_16x16x32_bf16 v[128:131], v[88:91], v[64:67], v[128:131]
    v_xor_b32_dpp v75, v47, v10 quad_perm:[1,0,2,3] row_mask:0xf bank_mask:0xf
    v_mfma_f32_16x16x32_bf16 v[132:135], v[88:91], v[68:71], v[132:135]
    ds_read_b128 v[104:107], v7 offset:28672
    v_xor_b32_dpp v76, v60, v11 quad_perm:[1,0,2,3] row_mask:0xf bank_mask:0xf
    v_xor_b32_dpp v77, v61, v11 quad_perm:[1,0,2,3] row_mask:0xf bank_mask:0xf
    v_mfma_f32_16x16x32_bf16 v[136:139], v[92:95], v[64:67], v[136:139]
    ds_read_b128 v[108:111], v7 offset:30720
    v_xor_b32_dpp v78, v62, v11 quad_perm:[1,0,2,3] row_mask:0xf bank_mask:0xf
    v_mfma_f32_16x16x32_bf16 v[140:143], v[92:95], v[68:71], v[140:143]
    v_xor_b32_dpp v79, v63, v11 quad_perm:[1,0,2,3] row_mask:0xf bank_mask:0xf
    s_waitcnt lgkmcnt(0)
    v_mfma_f32_16x16x32_bf16 v[112:115], v[96:99], v[72:75], v[112:115]
    v_mfma_f32_16x16x32_bf16 v[116:119], v[96:99], v[76:79], v[116:119]
    s_waitcnt vmcnt(2)
    s_barrier
    v_mfma_f32_16x16x32_bf16 v[120:123], v[100:103], v[72:75], v[120:123]
    s_add_u32 m0, s31, 57344
    ds_read_b128 v[80:83], v6 offset:32768
    v_xor_b32 v64, v12, v32
    v_xor_b32 v65, v12, v33
    v_mfma_f32_16x16x32_bf16 v[124:127], v[100:103], v[76:79], v[124:127]
    global_load_lds_dwordx4 v5, s[28:29]
    s_add_u32 s28, s28, s30
    s_addc_u32 s29, s29, 0
    ds_read_b128 v[84:87], v6 offset:34816
    v_xor_b32 v66, v12, v34
    v_mfma_f32_16x16x32_bf16 v[128:131], v[104:107], v[72:75], v[128:131]
    v_xor_b32 v67, v12, v35
    v_mfma_f32_16x16x32_bf16 v[132:135], v[104:107], v[76:79], v[132:135]
    ds_read_b128 v[88:91], v6 offset:36864
    v_xor_b32 v68, v12, v48
    v_xor_b32 v69, v12, v49
    v_mfma_f32_16x16x32_bf16 v[136:139], v[108:111], v[72:75], v[136:139]
    ds_read_b128 v[92:95], v6 offset:38912
    v_xor_b32 v70, v12, v50
    v_mfma_f32_16x16x32_bf16 v[140:143], v[108:111], v[76:79], v[140:143]
    v_xor_b32 v71, v12, v51
    s_waitcnt lgkmcnt(0)
    v_mfma_f32_16x16x32_bf16 v[112:115], v[80:83], v[64:67], v[112:115]
    v_mfma_f32_16x16x32_bf16 v[116:119], v[80:83], v[68:71], v[116:119]
    v_mfma_f32_16x16x32_bf16 v[120:123], v[84:87], v[64:67], v[120:123]
    ds_read_b128 v[96:99], v7 offset:32768
    v_xor_b32 v72, v12, v36
    v_xor_b32 v73, v12, v37
    v_mfma_f32_16x16x32_bf16 v[124:127], v[84:87], v[68:71], v[124:127]
    ds_read_b128 v[100:103], v7 offset:34816
    v_xor_b32 v74, v12, v38
    v_mfma_f32_16x16x32_bf16 v[128:131], v[88:91], v[64:67], v[128:131]
    v_xor_b32 v75, v12, v39
    v_mfma_f32_16x16x32_bf16 v[132:135], v[88:91], v[68:71], v[132:135]
    ds_read_b128 v[104:107], v7 offset:36864
    v_xor_b32 v76, v12, v52
    v_xor_b32 v77, v12, v53
    v_mfma_f32_16x16x32_bf16 v[136:139], v[92:95], v[64:67], v[136:139]
    ds_read_b128 v[108:111], v7 offset:38912
    v_xor_b32 v78, v12, v54
    v_mfma_f32_16x16x32_bf16 v[140:143], v[92:95], v[68:71], v[140:143]
    v_xor_b32 v79, v12, v55
    s_waitcnt lgkmcnt(0)
    v_mfma_f32_16x16x32_bf16 v[112:115], v[96:99], v[72:75], v[112:115]
    v_mfma_f32_16x16x32_bf16 v[116:119], v[96:99], v[76:79], v[116:119]
    s_waitcnt vmcnt(2)
    s_barrier
    v_mfma_f32_16x16x32_bf16 v[120:123], v[100:103], v[72:75], v[120:123]
    ds_read_b128 v[80:83], v6 offset:40960
    v_xor_b32 v64, v12, v40
    v_xor_b32 v65, v12, v41
    v_mfma_f32_16x16x32_bf16 v[124:127], v[100:103], v[76:79], v[124:127]
    ds_read_b128 v[84:87], v6 offset:43008
    v_xor_b32 v66, v12, v42
    v_mfma_f32_16x16x32_bf16 v[128:131], v[104:107], v[72:75], v[128:131]
    v_xor_b32 v67, v12, v43
    v_mfma_f32_16x16x32_bf16 v[132:135], v[104:107], v[76:79], v[132:135]
    ds_read_b128 v[88:91], v6 offset:45056
    v_xor_b32 v68, v12, v56
    v_xor_b32 v69, v12, v57
    v_mfma_f32_16x16x32_bf16 v[136:139], v[108:111], v[72:75], v[136:139]
    ds_read_b128 v[92:95], v6 offset:47104
    v_xor_b32 v70, v12, v58
    v_mfma_f32_16x16x32_bf16 v[140:143], v[108:111], v[76:79], v[140:143]
    v_xor_b32 v71, v12, v59
    s_waitcnt lgkmcnt(0)
    v_mfma_f32_16x16x32_bf16 v[112:115], v[80:83], v[64:67], v[112:115]
    v_mfma_f32_16x16x32_bf16 v[116:119], v[80:83], v[68:71], v[116:119]
    v_mfma_f32_16x16x32_bf16 v[120:123], v[84:87], v[64:67], v[120:123]
    ds_read_b128 v[96:99], v7 offset:40960
    v_xor_b32 v72, v12, v44
    v_xor_b32 v73, v12, v45
    v_mfma_f32_16x16x32_bf16 v[124:127], v[84:87], v[68:71], v[124:127]
    ds_read_b128 v[100:103], v7 offset:43008
    v_xor_b32 v74, v12, v46
    v_mfma_f32_16x16x32_bf16 v[128:131], v[88:91], v[64:67], v[128:131]
    v_xor_b32 v75, v12, v47
    v_mfma_f32_16x16x32_bf16 v[132:135], v[88:91], v[68:71], v[132:135]
    ds_read_b128 v[104:107], v7 offset:45056
    v_xor_b32 v76, v12, v60
    v_xor_b32 v77, v12, v61
    v_mfma_f32_16x16x32_bf16 v[136:139], v[92:95], v[64:67], v[136:139]
    ds_read_b128 v[108:111], v7 offset:47104
    v_xor_b32 v78, v12, v62
    v_mfma_f32_16x16x32_bf16 v[140:143], v[92:95], v[68:71], v[140:143]
    v_xor_b32 v79, v12, v63
    s_waitcnt lgkmcnt(0)
    v_mfma_f32_16x16x32_bf16 v[112:115], v[96:99], v[72:75], v[112:115]
    v_mfma_f32_16x16x32_bf16 v[116:119], v[96:99], v[76:79], v[116:119]
    s_waitcnt vmcnt(1)
    s_barrier
    v_mfma_f32_16x16x32_bf16 v[120:123], v[100:103], v[72:75], v[120:123]
    ds_read_b128 v[80:83], v6 offset:49152
    v_xor_b32_dpp v64, v32, v13 quad_perm:[1,0,2,3] row_mask:0xf bank_mask:0xf
    v_xor_b32_dpp v65, v33, v13 quad_perm:[1,0,2,3] row_mask:0xf bank_mask:0xf
    v_mfma_f32_16x16x32_bf16 v[124:127], v[100:103], v[76:79], v[124:127]
    ds_read_b128 v[84:87], v6 offset:51200
    v_xor_b32_dpp v66, v34, v13 quad_perm:[1,0,2,3] row_mask:0xf bank_mask:0xf
    v_mfma_f32_16x16x32_bf16 v[128:131], v[104:107], v[72:75], v[128:131]
    v_xor_b32_dpp v67, v35, v13 quad_perm:[1,0,2,3] row_mask:0xf bank_mask:0xf
    v_mfma_f32_16x16x32_bf16 v[132:135], v[104:107], v[76:79], v[132:135]
    ds_read_b128 v[88:91], v6 offset:53248
    v_xor_b32_dpp v68, v48, v14 quad_perm:[1,0,2,3] row_mask:0xf bank_mask:0xf
    v_xor_b32_dpp v69, v49, v14 quad_perm:[1,0,2,3] row_mask:0xf bank_mask:0xf
    v_mfma_f32_16x16x32_bf16 v[136:139], v[108:111], v[72:75], v[136:139]
    ds_read_b128 v[92:95], v6 offset:55296
    v_xor_b32_dpp v70, v50, v14 quad_perm:[1,0,2,3] row_mask:0xf bank_mask:0xf
    v_mfma_f32_16x16x32_bf16 v[140:143], v[108:111], v[76:79], v[140:143]
    v_xor_b32_dpp v71, v51, v14 quad_perm:[1,0,2,3] row_mask:0xf bank_mask:0xf
    s_waitcnt lgkmcnt(0)
    v_mfma_f32_16x16x32_bf16 v[112:115], v[80:83], v[64:67], v[112:115]
    v_mfma_f32_16x16x32_bf16 v[116:119], v[80:83], v[68:71], v[116:119]
    v_mfma_f32_16x16x32_bf16 v[120:123], v[84:87], v[64:67], v[120:123]
    ds_read_b128 v[96:99], v7 offset:49152
    v_xor_b32_dpp v72, v36, v13 quad_perm:[1,0,2,3] row_mask:0xf bank_mask:0xf
    v_xor_b32_dpp v73, v37, v13 quad_perm:[1,0,2,3] row_mask:0xf bank_mask:0xf
    v_mfma_f32_16x16x32_bf16 v[124:127], v[84:87], v[68:71], v[124:127]
    ds_read_b128 v[100:103], v7 offset:51200
    v_xor_b32_dpp v74, v38, v13 quad_perm:[1,0,2,3] row_mask:0xf bank_mask:0xf
    v_mfma_f32_16x16x32_bf16 v[128:131], v[88:91], v[64:67], v[128:131]
    v_xor_b32_dpp v75, v39, v13 quad_perm:[1,0,2,3] row_mask:0xf bank_mask:0xf
    v_mfma_f32_16x16x32_bf16 v[132:135], v[88:91], v[68:71], v[132:135]
    ds_read_b128 v[104:107], v7 offset:53248
    v_xor_b32_dpp v76, v52, v14 quad_perm:[1,0,2,3] row_mask:0xf bank_mask:0xf
    v_xor_b32_dpp v77, v53, v14 quad_perm:[1,0,2,3] row_mask:0xf bank_mask:0xf
    v_mfma_f32_16x16x32_bf16 v[136:139], v[92:95], v[64:67], v[136:139]
    ds_read_b128 v[108:111], v7 offset:55296
    v_xor_b32_dpp v78, v54, v14 quad_perm:[1,0,2,3] row_mask:0xf bank_mask:0xf
    v_mfma_f32_16x16x32_bf16 v[140:143], v[92:95], v[68:71], v[140:143]
    v_xor_b32_dpp v79, v55, v14 quad_perm:[1,0,2,3] row_mask:0xf bank_mask:0xf
    s_waitcnt lgkmcnt(0)
    v_mfma_f32_16x16x32_bf16 v[112:115], v[96:99], v[72:75], v[112:115]
    v_mfma_f32_16x16x32_bf16 v[116:119], v[96:99], v[76:79], v[116:119]
    s_waitcnt vmcnt(0)
    s_barrier
    v_mfma_f32_16x16x32_bf16 v[120:123], v[100:103], v[72:75], v[120:123]
    ds_read_b128 v[80:83], v6 offset:57344
    v_xor_b32_dpp v64, v40, v13 quad_perm:[1,0,2,3] row_mask:0xf bank_mask:0xf
    v_xor_b32_dpp v65, v41, v13 quad_perm:[1,0,2,3] row_mask:0xf bank_mask:0xf
    v_mfma_f32_16x16x32_bf16 v[124:127], v[100:103], v[76:79], v[124:127]
    ds_read_b128 v[84:87], v6 offset:59392
    v_xor_b32_dpp v66, v42, v13 quad_perm:[1,0,2,3] row_mask:0xf bank_mask:0xf
    v_mfma_f32_16x16x32_bf16 v[128:131], v[104:107], v[72:75], v[128:131]
    v_xor_b32_dpp v67, v43, v13 quad_perm:[1,0,2,3] row_mask:0xf bank_mask:0xf
    v_mfma_f32_16x16x32_bf16 v[132:135], v[104:107], v[76:79], v[132:135]
    ds_read_b128 v[88:91], v6 offset:61440
    v_xor_b32_dpp v68, v56, v14 quad_perm:[1,0,2,3] row_mask:0xf bank_mask:0xf
    v_xor_b32_dpp v69, v57, v14 quad_perm:[1,0,2,3] row_mask:0xf bank_mask:0xf
    v_mfma_f32_16x16x32_bf16 v[136:139], v[108:111], v[72:75], v[136:139]
    ds_read_b128 v[92:95], v6 offset:63488
    v_xor_b32_dpp v70, v58, v14 quad_perm:[1,0,2,3] row_mask:0xf bank_mask:0xf
    v_mfma_f32_16x16x32_bf16 v[140:143], v[108:111], v[76:79], v[140:143]
    v_xor_b32_dpp v71, v59, v14 quad_perm:[1,0,2,3] row_mask:0xf bank_mask:0xf
    s_waitcnt lgkmcnt(0)
    v_mfma_f32_16x16x32_bf16 v[112:115], v[80:83], v[64:67], v[112:115]
    v_mfma_f32_16x16x32_bf16 v[116:119], v[80:83], v[68:71], v[116:119]
    v_mfma_f32_16x16x32_bf16 v[120:123], v[84:87], v[64:67], v[120:123]
    ds_read_b128 v[96:99], v7 offset:57344
    v_xor_b32_dpp v72, v44, v13 quad_perm:[1,0,2,3] row_mask:0xf bank_mask:0xf
    v_xor_b32_dpp v73, v45, v13 quad_perm:[1,0,2,3] row_mask:0xf bank_mask:0xf
    v_mfma_f32_16x16x32_bf16 v[124:127], v[84:87], v[68:71], v[124:127]
    ds_read_b128 v[100:103], v7 offset:59392
    v_xor_b32_dpp v74, v46, v13 quad_perm:[1,0,2,3] row_mask:0xf bank_mask:0xf
    v_mfma_f32_16x16x32_bf16 v[128:131], v[88:91], v[64:67], v[128:131]
    v_xor_b32_dpp v75, v47, v13 quad_perm:[1,0,2,3] row_mask:0xf bank_mask:0xf
    v_xor_b32_dpp v76, v60, v14 quad_perm:[1,0,2,3] row_mask:0xf bank_mask:0xf
    v_mfma_f32_16x16x32_bf16 v[132:135], v[88:91], v[68:71], v[132:135]
    ds_read_b128 v[104:107], v7 offset:61440
    v_xor_b32_dpp v77, v61, v14 quad_perm:[1,0,2,3] row_mask:0xf bank_mask:0xf
    v_mfma_f32_16x16x32_bf16 v[136:139], v[92:95], v[64:67], v[136:139]
    ds_read_b128 v[108:111], v7 offset:63488
    v_xor_b32_dpp v78, v62, v14 quad_perm:[1,0,2,3] row_mask:0xf bank_mask:0xf
    v_xor_b32_dpp v79, v63, v14 quad_perm:[1,0,2,3] row_mask:0xf bank_mask:0xf
    v_mfma_f32_16x16x32_bf16 v[140:143], v[92:95], v[68:71], v[140:143]
    global_store_dwordx4 v20, v[24:27], s[22:23] sc1
    s_waitcnt lgkmcnt(0)
    v_mfma_f32_16x16x32_bf16 v[112:115], v[96:99], v[72:75], v[112:115]
    v_mfma_f32_16x16x32_bf16 v[116:119], v[96:99], v[76:79], v[116:119]
    v_mfma_f32_16x16x32_bf16 v[120:123], v[100:103], v[72:75], v[120:123]
    v_mfma_f32_16x16x32_bf16 v[124:127], v[100:103], v[76:79], v[124:127]
    v_mfma_f32_16x16x32_bf16 v[128:131], v[104:107], v[72:75], v[128:131]
    v_mfma_f32_16x16x32_bf16 v[132:135], v[104:107], v[76:79], v[132:135]
    v_mfma_f32_16x16x32_bf16 v[136:139], v[108:111], v[72:75], v[136:139]
    v_mfma_f32_16x16x32_bf16 v[140:143], v[108:111], v[76:79], v[140:143]
k1_epi_ab:
    s_nop 0
    v_mul_f32 v112, v15, v112
    v_mul_f32 v113, v15, v113
    v_mul_f32 v114, v15, v114
    v_mul_f32 v115, v15, v115
    v_mul_f32 v116, v16, v116
    v_mul_f32 v117, v16, v117
    v_mul_f32 v118, v16, v118
    v_mul_f32 v119, v16, v119
    v_mul_f32 v120, v15, v120
    v_mul_f32 v121, v15, v121
    v_mul_f32 v122, v15, v122
    v_mul_f32 v123, v15, v123
    v_mul_f32 v124, v16, v124
    v_mul_f32 v125, v16, v125
    v_mul_f32 v126, v16, v126
    v_mul_f32 v127, v16, v127
    v_mul_f32 v128, v15, v128
    v_mul_f32 v129, v15, v129
    v_mul_f32 v130, v15, v130
    v_mul_f32 v131, v15, v131
    v_mul_f32 v132, v16, v132
    v_mul_f32 v133, v16, v133
    v_mul_f32 v134, v16, v134
    v_mul_f32 v135, v16, v135
    v_mul_f32 v136, v15, v136
    v_mul_f32 v137, v15, v137
    v_mul_f32 v138, v15, v138
    v_mul_f32 v139, v15, v139
    v_mul_f32 v140, v16, v140
    v_mul_f32 v141, v16, v141
    v_mul_f32 v142, v16, v142
    v_mul_f32 v143, v16, v143
    v_cvt_pk_bf16_f32 v32, v112, v113
    v_cvt_pk_bf16_f32 v33, v114, v115
    v_cvt_pk_bf16_f32 v34, v120, v121
    v_cvt_pk_bf16_f32 v35, v122, v123
    v_cvt_pk_bf16_f32 v36, v116, v117
    v_cvt_pk_bf16_f32 v37, v118, v119
    v_cvt_pk_bf16_f32 v38, v124, v125
    v_cvt_pk_bf16_f32 v39, v126, v127
    v_cvt_pk_bf16_f32 v40, v128, v129
    v_cvt_pk_bf16_f32 v41, v130, v131
    v_cvt_pk_bf16_f32 v42, v136, v137
    v_cvt_pk_bf16_f32 v43, v138, v139
    v_cvt_pk_bf16_f32 v44, v132, v133
    v_cvt_pk_bf16_f32 v45, v134, v135
    v_cvt_pk_bf16_f32 v46, v140, v141
    v_cvt_pk_bf16_f32 v47, v142, v143
    s_cmp_eq_u32 s26, 1
    s_cbranch_scc1 k1_epi_b
    s_lshl_b32 s40, s3, 12
    s_add_u32 s40, s40, 81920
    v_and_b32 v21, 7, v4
    v_xor_b32 v21, v21, v3
    v_lshlrev_b32 v21, 4, v21
    v_lshl_add_u32 v21, v4, 7, v21
    v_add_u32 v21, s40, v21
    v_xor_b32 v22, 64, v21
    ds_write_b128 v21, v[32:35] offset:0
    ds_write_b128 v21, v[36:39] offset:2048
    ds_write_b128 v22, v[40:43] offset:0
    ds_write_b128 v22, v[44:47] offset:2048
    v_lshl_add_u32 v21, v2, 4, s40
    v_lshrrev_b32 v22, 3, v2
    v_and_b32 v23, 7, v2
    v_xor_b32 v23, v23, v22
    v_lshlrev_b32 v23, 4, v23
    v_lshl_add_u32 v23, v22, 12, v23
    s_lshl_b32 s40, s25, 3
    s_add_u32 s40, s40, s3
    s_lshl_b32 s40, s40, 17
    s_lshl_b32 s41, s24, 7
    s_add_u32 s40, s40, s41
    s_add_u32 s34, s22, s40
    s_addc_u32 s35, s23, 0
    s_waitcnt lgkmcnt(0)
    ds_read_b128 v[64:67], v21 offset:0
    ds_read_b128 v[68:71], v21 offset:1024
    ds_read_b128 v[72:75], v21 offset:2048
    ds_read_b128 v[76:79], v21 offset:3072
    s_waitcnt lgkmcnt(3)
    global_store_dwordx4 v23, v[64:67], s[34:35] sc1
    s_add_u32 s34, s34, 32768
    s_addc_u32 s35, s35, 0
    s_waitcnt lgkmcnt(2)
    global_store_dwordx4 v23, v[68:71], s[34:35] sc1
    s_add_u32 s34, s34, 32768
    s_addc_u32 s35, s35, 0
    s_waitcnt lgkmcnt(1)
    global_store_dwordx4 v23, v[72:75], s[34:35] sc1
    s_add_u32 s34, s34, 32768
    s_addc_u32 s35, s35, 0
    s_waitcnt lgkmcnt(0)
    global_store_dwordx4 v23, v[76:79], s[34:35] sc1
    s_cmp_eq_u32 s25, 1
    s_cbranch_scc0 k1_end
    s_barrier
    s_cmp_eq_u32 s3, 0
    s_cbranch_scc0 k1_end
    v_lshlrev_b32 v21, 2, v2
    v_add_u32 v21, 65536, v21
    ds_read_b32 v24, v21
    ds_read_b32 v25, v21 offset:256
    ds_read_b32 v26, v21 offset:512
    v_and_b32 v22, 35, v2
    v_bfe_u32 v23, v2, 4, 1
    v_lshl_or_b32 v22, v23, 2, v22
    v_bfe_u32 v23, v2, 2, 2
    v_lshl_or_b32 v22, v23, 3, v22
    s_lshl_b32 s40, s24, 8
    s_add_u32 s40, s40, 4194304
    v_lshl_add_u32 v22, v22, 2, s40
    s_waitcnt lgkmcnt(0)
    v_add_f32 v24, v24, v25
    v_mul_f32 v23, 0xbb000000, v26
    v_fmac_f32 v24, v23, v26
    v_max_f32 v24, 0, v24
    global_store_dword v22, v24, s[22:23] sc1
    s_branch k1_end
k1_epi_b:
    s_lshl_b32 s40, s25, 4
    s_lshl_b32 s41, s3, 1
    s_add_u32 s40, s40, s41
    s_mul_i32 s40, s40, 56
    s_lshl_b32 s41, s33, 1
    s_add_u32 s40, s40, s41
    s_lshl_b32 s40, s40, 10
    s_add_u32 s41, s40, 16777216
    s_add_u32 s42, s40, 18874368
    v_lshlrev_b32 v21, 4, v2
    v_add_u32 v22, 57344, v21
    s_add_u32 s34, s22, s41
    s_addc_u32 s35, s23, 0
    global_store_dwordx4 v21, v[32:35], s[34:35] offset:0 sc1
    global_store_dwordx4 v21, v[40:43], s[34:35] offset:1024 sc1
    global_store_dwordx4 v22, v[36:39], s[34:35] offset:0 sc1
    global_store_dwordx4 v22, v[44:47], s[34:35] offset:1024 sc1
    s_branch k1_end
k1_pre_c:
    v_bfe_u32 v21, v2, 2, 2
    v_and_b32 v22, 3, v2
    v_lshl_add_u32 v23, v3, 3, v21
    v_lshlrev_b32 v23, 7, v23
    v_and_b32 v21, 2, v21
    v_and_b32 v144, 1, v3
    v_lshl_add_u32 v21, v144, 2, v21
    v_lshrrev_b32 v144, 1, v22
    v_xor_b32 v21, v21, v144
    v_lshl_add_u32 v23, v21, 4, v23
    v_and_b32 v22, 1, v22
    v_lshl_add_u32 v6, v22, 3, v23
    v_xor_b32 v7, 32, v6
    v_xor_b32 v8, 64, v6
    v_xor_b32 v9, 96, v6
    s_waitcnt vmcnt(3)
    ds_write_b128 v17, v[24:27]
    s_waitcnt vmcnt(2) lgkmcnt(0)
    s_barrier
    ds_read_b64_tr_b16 v[80:81], v6 offset:0
    ds_read_b64_tr_b16 v[82:83], v6 offset:512
    ds_read_b64_tr_b16 v[84:85], v7 offset:0
    ds_read_b64_tr_b16 v[86:87], v7 offset:512
    ds_read_b64_tr_b16 v[88:89], v8 offset:0
    ds_read_b64_tr_b16 v[90:91], v8 offset:512
    ds_read_b64_tr_b16 v[92:93], v9 offset:0
    ds_read_b64_tr_b16 v[94:95], v9 offset:512
    ds_read_b64_tr_b16 v[24:25], v18
    ds_read_b64_tr_b16 v[26:27], v18 offset:2048
    s_add_u32 m0, s31, 24576
    s_nop 0
    global_load_lds_dwordx4 v5, s[28:29]
    s_add_u32 s28, s28, s30
    s_addc_u32 s29, s29, 0
    s_waitcnt lgkmcnt(0)
    v_mfma_f32_16x16x32_bf16 v[112:115], v[32:35], v[80:83], 0
    ds_write_b128 v19, v[24:27]
    v_mfma_f32_16x16x32_bf16 v[116:119], v[48:51], v[80:83], 0
    v_mfma_f32_16x16x32_bf16 v[120:123], v[32:35], v[84:87], 0
    ds_read_b64_tr_b16 v[96:97], v6 offset:4096
    ds_read_b64_tr_b16 v[98:99], v6 offset:4608
    v_mfma_f32_16x16x32_bf16 v[124:127], v[48:51], v[84:87], 0
    ds_read_b64_tr_b16 v[100:101], v7 offset:4096
    v_mfma_f32_16x16x32_bf16 v[128:131], v[32:35], v[88:91], 0
    ds_read_b64_tr_b16 v[102:103], v7 offset:4608
    v_mfma_f32_16x16x32_bf16 v[132:135], v[48:51], v[88:91], 0
    ds_read_b64_tr_b16 v[104:105], v8 offset:4096
    ds_read_b64_tr_b16 v[106:107], v8 offset:4608
    v_mfma_f32_16x16x32_bf16 v[136:139], v[32:35], v[92:95], 0
    ds_read_b64_tr_b16 v[108:109], v9 offset:4096
    v_mfma_f32_16x16x32_bf16 v[140:143], v[48:51], v[92:95], 0
    ds_read_b64_tr_b16 v[110:111], v9 offset:4608
    s_waitcnt lgkmcnt(0)
    v_mfma_f32_16x16x32_bf16 v[112:115], v[36:39], v[96:99], v[112:115]
    v_mfma_f32_16x16x32_bf16 v[116:119], v[52:55], v[96:99], v[116:119]
    s_waitcnt vmcnt(2) lgkmcnt(0)
    s_barrier
    v_mfma_f32_16x16x32_bf16 v[120:123], v[36:39], v[100:103], v[120:123]
    s_add_u32 m0, s31, 32768
    ds_read_b64_tr_b16 v[80:81], v6 offset:8192
    ds_read_b64_tr_b16 v[82:83], v6 offset:8704
    v_mfma_f32_16x16x32_bf16 v[124:127], v[52:55], v[100:103], v[124:127]
    global_load_lds_dwordx4 v5, s[28:29]
    s_add_u32 s28, s28, s30
    s_addc_u32 s29, s29, 0
    ds_read_b64_tr_b16 v[84:85], v7 offset:8192
    ds_read_b64_tr_b16 v[86:87], v7 offset:8704
    v_mfma_f32_16x16x32_bf16 v[128:131], v[36:39], v[104:107], v[128:131]
    ds_read_b64_tr_b16 v[88:89], v8 offset:8192
    ds_read_b64_tr_b16 v[90:91], v8 offset:8704
    v_mfma_f32_16x16x32_bf16 v[132:135], v[52:55], v[104:107], v[132:135]
    ds_read_b64_tr_b16 v[92:93], v9 offset:8192
    ds_read_b64_tr_b16 v[94:95], v9 offset:8704
    v_mfma_f32_16x16x32_bf16 v[136:139], v[36:39], v[108:111], v[136:139]
    v_lshlrev_b32 v21, 4, v2
    s_add_u32 s40, s31, 73728
    v_mfma_f32_16x16x32_bf16 v[140:143], v[52:55], v[108:111], v[140:143]
    v_add_u32 v21, s40, v21
    ds_read_b128 v[24:27], v21
    s_waitcnt lgkmcnt(0)
    v_mfma_f32_16x16x32_bf16 v[112:115], v[40:43], v[80:83], v[112:115]
    v_mfma_f32_16x16x32_bf16 v[116:119], v[56:59], v[80:83], v[116:119]
    v_mfma_f32_16x16x32_bf16 v[120:123], v[40:43], v[84:87], v[120:123]
    ds_read_b64_tr_b16 v[96:97], v6 offset:12288
    ds_read_b64_tr_b16 v[98:99], v6 offset:12800
    v_mfma_f32_16x16x32_bf16 v[124:127], v[56:59], v[84:87], v[124:127]
    ds_read_b64_tr_b16 v[100:101], v7 offset:12288
    v_mfma_f32_16x16x32_bf16 v[128:131], v[40:43], v[88:91], v[128:131]
    ds_read_b64_tr_b16 v[102:103], v7 offset:12800
    v_mfma_f32_16x16x32_bf16 v[132:135], v[56:59], v[88:91], v[132:135]
    ds_read_b64_tr_b16 v[104:105], v8 offset:12288
    ds_read_b64_tr_b16 v[106:107], v8 offset:12800
    v_mfma_f32_16x16x32_bf16 v[136:139], v[40:43], v[92:95], v[136:139]
    ds_read_b64_tr_b16 v[108:109], v9 offset:12288
    v_mfma_f32_16x16x32_bf16 v[140:143], v[56:59], v[92:95], v[140:143]
    ds_read_b64_tr_b16 v[110:111], v9 offset:12800
    s_waitcnt lgkmcnt(0)
    v_mfma_f32_16x16x32_bf16 v[112:115], v[44:47], v[96:99], v[112:115]
    v_mfma_f32_16x16x32_bf16 v[116:119], v[60:63], v[96:99], v[116:119]
    s_waitcnt vmcnt(2)
    s_barrier
    v_mfma_f32_16x16x32_bf16 v[120:123], v[44:47], v[100:103], v[120:123]
    s_add_u32 m0, s31, 40960
    ds_read_b64_tr_b16 v[80:81], v6 offset:16384
    ds_read_b64_tr_b16 v[82:83], v6 offset:16896
    v_xor_b32_dpp v64, v32, v10 quad_perm:[1,0,2,3] row_mask:0xf bank_mask:0xf
    v_xor_b32_dpp v65, v33, v10 quad_perm:[1,0,2,3] row_mask:0xf bank_mask:0xf
    v_mfma_f32_16x16x32_bf16 v[124:127], v[60:63], v[100:103], v[124:127]
    global_load_lds_dwordx4 v5, s[28:29]
    s_add_u32 s28, s28, s30
    s_addc_u32 s29, s29, 0
    ds_read_b64_tr_b16 v[84:85], v7 offset:16384
    v_xor_b32_dpp v66, v34, v10 quad_perm:[1,0,2,3] row_mask:0xf bank_mask:0xf
    v_mfma_f32_16x16x32_bf16 v[128:131], v[44:47], v[104:107], v[128:131]
    ds_read_b64_tr_b16 v[86:87], v7 offset:16896
    v_xor_b32_dpp v67, v35, v10 quad_perm:[1,0,2,3] row_mask:0xf bank_mask:0xf
    v_mfma_f32_16x16x32_bf16 v[132:135], v[60:63], v[104:107], v[132:135]
    ds_read_b64_tr_b16 v[88:89], v8 offset:16384
    ds_read_b64_tr_b16 v[90:91], v8 offset:16896
    v_xor_b32_dpp v68, v48, v11 quad_perm:[1,0,2,3] row_mask:0xf bank_mask:0xf
    v_xor_b32_dpp v69, v49, v11 quad_perm:[1,0,2,3] row_mask:0xf bank_mask:0xf
    v_mfma_f32_16x16x32_bf16 v[136:139], v[44:47], v[108:111], v[136:139]
    ds_read_b64_tr_b16 v[92:93], v9 offset:16384
    v_xor_b32_dpp v70, v50, v11 quad_perm:[1,0,2,3] row_mask:0xf bank_mask:0xf
    v_mfma_f32_16x16x32_bf16 v[140:143], v[60:63], v[108:111], v[140:143]
    ds_read_b64_tr_b16 v[94:95], v9 offset:16896
    v_xor_b32_dpp v71, v51, v11 quad_perm:[1,0,2,3] row_mask:0xf bank_mask:0xf
    s_waitcnt lgkmcnt(0)
    v_mfma_f32_16x16x32_bf16 v[112:115], v[64:67], v[80:83], v[112:115]
    v_mfma_f32_16x16x32_bf16 v[116:119], v[68:71], v[80:83], v[116:119]
    v_mfma_f32_16x16x32_bf16 v[120:123], v[64:67], v[84:87], v[120:123]
    ds_read_b64_tr_b16 v[96:97], v6 offset:20480
    ds_read_b64_tr_b16 v[98:99], v6 offset:20992
    v_xor_b32_dpp v72, v36, v10 quad_perm:[1,0,2,3] row_mask:0xf bank_mask:0xf
    v_xor_b32_dpp v73, v37, v10 quad_perm:[1,0,2,3] row_mask:0xf bank_mask:0xf
    v_mfma_f32_16x16x32_bf16 v[124:127], v[68:71], v[84:87], v[124:127]
    ds_read_b64_tr_b16 v[100:101], v7 offset:20480
    v_xor_b32_dpp v74, v38, v10 quad_perm:[1,0,2,3] row_mask:0xf bank_mask:0xf
    v_mfma_f32_16x16x32_bf16 v[128:131], v[64:67], v[88:91], v[128:131]
    ds_read_b64_tr_b16 v[102:103], v7 offset:20992
    v_xor_b32_dpp v75, v39, v10 quad_perm:[1,0,2,3] row_mask:0xf bank_mask:0xf
    v_mfma_f32_16x16x32_bf16 v[132:135], v[68:71], v[88:91], v[132:135]
    ds_read_b64_tr_b16 v[104:105], v8 offset:20480
    ds_read_b64_tr_b16 v[106:107], v8 offset:20992
    v_xor_b32_dpp v76, v52, v11 quad_perm:[1,0,2,3] row_mask:0xf bank_mask:0xf
    v_xor_b32_dpp v77, v53, v11 quad_perm:[1,0,2,3] row_mask:0xf bank_mask:0xf
    v_mfma_f32_16x16x32_bf16 v[136:139], v[64:67], v[92:95], v[136:139]
    ds_read_b64_tr_b16 v[108:109], v9 offset:20480
    v_xor_b32_dpp v78, v54, v11 quad_perm:[1,0,2,3] row_mask:0xf bank_mask:0xf
    v_mfma_f32_16x16x32_bf16 v[140:143], v[68:71], v[92:95], v[140:143]
    ds_read_b64_tr_b16 v[110:111], v9 offset:20992
    v_xor_b32_dpp v79, v55, v11 quad_perm:[1,0,2,3] row_mask:0xf bank_mask:0xf
    s_waitcnt lgkmcnt(0)
    v_mfma_f32_16x16x32_bf16 v[112:115], v[72:75], v[96:99], v[112:115]
    v_mfma_f32_16x16x32_bf16 v[116:119], v[76:79], v[96:99], v[116:119]
    s_waitcnt vmcnt(2)
    s_barrier
    v_mfma_f32_16x16x32_bf16 v[120:123], v[72:75], v[100:103], v[120:123]
    s_add_u32 m0, s31, 49152
    ds_read_b64_tr_b16 v[80:81], v6 offset:24576
    ds_read_b64_tr_b16 v[82:83], v6 offset:25088
    v_xor_b32_dpp v64, v40, v10 quad_perm:[1,0,2,3] row_mask:0xf bank_mask:0xf
    v_xor_b32_dpp v65, v41, v10 quad_perm:[1,0,2,3] row_mask:0xf bank_mask:0xf
    v_mfma_f32_16x16x32_bf16 v[124:127], v[76:79], v[100:103], v[124:127]
    global_load_lds_dwordx4 v5, s[28:29]
    s_add_u32 s28, s28, s30
    s_addc_u32 s29, s29, 0
    ds_read_b64_tr_b16 v[84:85], v7 offset:24576
    v_xor_b32_dpp v66, v42, v10 quad_perm:[1,0,2,3] row_mask:0xf bank_mask:0xf
    v_mfma_f32_16x16x32_bf16 v[128:131], v[72:75], v[104:107], v[128:131]
    ds_read_b64_tr_b16 v[86:87], v7 offset:25088
    v_xor_b32_dpp v67, v43, v10 quad_perm:[1,0,2,3] row_mask:0xf bank_mask:0xf
    v_mfma_f32_16x16x32_bf16 v[132:135], v[76:79], v[104:107], v[132:135]
    ds_read_b64_tr_b16 v[88:89], v8 offset:24576
    ds_read_b64_tr_b16 v[90:91], v8 offset:25088
    v_xor_b32_dpp v68, v56, v11 quad_perm:[1,0,2,3] row_mask:0xf bank_mask:0xf
    v_xor_b32_dpp v69, v57, v11 quad_perm:[1,0,2,3] row_mask:0xf bank_mask:0xf
    v_mfma_f32_16x16x32_bf16 v[136:139], v[72:75], v[108:111], v[136:139]
    ds_read_b64_tr_b16 v[92:93], v9 offset:24576
    v_xor_b32_dpp v70, v58, v11 quad_perm:[1,0,2,3] row_mask:0xf bank_mask:0xf
    v_mfma_f32_16x16x32_bf16 v[140:143], v[76:79], v[108:111], v[140:143]
    ds_read_b64_tr_b16 v[94:95], v9 offset:25088
    v_xor_b32_dpp v71, v59, v11 quad_perm:[1,0,2,3] row_mask:0xf bank_mask:0xf
    s_waitcnt lgkmcnt(0)
    v_mfma_f32_16x16x32_bf16 v[112:115], v[64:67], v[80:83], v[112:115]
    v_mfma_f32_16x16x32_bf16 v[116:119], v[68:71], v[80:83], v[116:119]
    v_mfma_f32_16x16x32_bf16 v[120:123], v[64:67], v[84:87], v[120:123]
    ds_read_b64_tr_b16 v[96:97], v6 offset:28672
    ds_read_b64_tr_b16 v[98:99], v6 offset:29184
    v_xor_b32_dpp v72, v44, v10 quad_perm:[1,0,2,3] row_mask:0xf bank_mask:0xf
    v_xor_b32_dpp v73, v45, v10 quad_perm:[1,0,2,3] row_mask:0xf bank_mask:0xf
    v_mfma_f32_16x16x32_bf16 v[124:127], v[68:71], v[84:87], v[124:127]
    ds_read_b64_tr_b16 v[100:101], v7 offset:28672
    v_xor_b32_dpp v74, v46, v10 quad_perm:[1,0,2,3] row_mask:0xf bank_mask:0xf
    v_mfma_f32_16x16x32_bf16 v[128:131], v[64:67], v[88:91], v[128:131]
    ds_read_b64_tr_b16 v[102:103], v7 offset:29184
    v_xor_b32_dpp v75, v47, v10 quad_perm:[1,0,2,3] row_mask:0xf bank_mask:0xf
    v_mfma_f32_16x16x32_bf16 v[132:135], v[68:71], v[88:91], v[132:135]
    ds_read_b64_tr_b16 v[104:105], v8 offset:28672
    ds_read_b64_tr_b16 v[106:107], v8 offset:29184
    v_xor_b32_dpp v76, v60, v11 quad_perm:[1,0,2,3] row_mask:0xf bank_mask:0xf
    v_xor_b32_dpp v77, v61, v11 quad_perm:[1,0,2,3] row_mask:0xf bank_mask:0xf
    v_mfma_f32_16x16x32_bf16 v[136:139], v[64:67], v[92:95], v[136:139]
    ds_read_b64_tr_b16 v[108:109], v9 offset:28672
    v_xor_b32_dpp v78, v62, v11 quad_perm:[1,0,2,3] row_mask:0xf bank_mask:0xf
    v_mfma_f32_16x16x32_bf16 v[140:143], v[68:71], v[92:95], v[140:143]
    ds_read_b64_tr_b16 v[110:111], v9 offset:29184
    v_xor_b32_dpp v79, v63, v11 quad_perm:[1,0,2,3] row_mask:0xf bank_mask:0xf
    s_waitcnt lgkmcnt(0)
    v_mfma_f32_16x16x32_bf16 v[112:115], v[72:75], v[96:99], v[112:115]
    v_mfma_f32_16x16x32_bf16 v[116:119], v[76:79], v[96:99], v[116:119]
    s_waitcnt vmcnt(2)
    s_barrier
    v_mfma_f32_16x16x32_bf16 v[120:123], v[72:75], v[100:103], v[120:123]
    s_add_u32 m0, s31, 57344
    ds_read_b64_tr_b16 v[80:81], v6 offset:32768
    ds_read_b64_tr_b16 v[82:83], v6 offset:33280
    v_xor_b32 v64, v12, v32
    v_xor_b32 v65, v12, v33
    v_mfma_f32_16x16x32_bf16 v[124:127], v[76:79], v[100:103], v[124:127]
    global_load_lds_dwordx4 v5, s[28:29]
    s_add_u32 s28, s28, s30
    s_addc_u32 s29, s29, 0
    ds_read_b64_tr_b16 v[84:85], v7 offset:32768
    v_xor_b32 v66, v12, v34
    v_mfma_f32_16x16x32_bf16 v[128:131], v[72:75], v[104:107], v[128:131]
    ds_read_b64_tr_b16 v[86:87], v7 offset:33280
    v_xor_b32 v67, v12, v35
    v_mfma_f32_16x16x32_bf16 v[132:135], v[76:79], v[104:107], v[132:135]
    ds_read_b64_tr_b16 v[88:89], v8 offset:32768
    ds_read_b64_tr_b16 v[90:91], v8 offset:33280
    v_xor_b32 v68, v12, v48
    v_xor_b32 v69, v12, v49
    v_mfma_f32_16x16x32_bf16 v[136:139], v[72:75], v[108:111], v[136:139]
    ds_read_b64_tr_b16 v[92:93], v9 offset:32768
    v_xor_b32 v70, v12, v50
    v_mfma_f32_16x16x32_bf16 v[140:143], v[76:79], v[108:111], v[140:143]
    ds_read_b64_tr_b16 v[94:95], v9 offset:33280
    v_xor_b32 v71, v12, v51
    s_waitcnt lgkmcnt(0)
    v_mfma_f32_16x16x32_bf16 v[112:115], v[64:67], v[80:83], v[112:115]
    v_mfma_f32_16x16x32_bf16 v[116:119], v[68:71], v[80:83], v[116:119]
    v_mfma_f32_16x16x32_bf16 v[120:123], v[64:67], v[84:87], v[120:123]
    ds_read_b64_tr_b16 v[96:97], v6 offset:36864
    ds_read_b64_tr_b16 v[98:99], v6 offset:37376
    v_xor_b32 v72, v12, v36
    v_xor_b32 v73, v12, v37
    v_mfma_f32_16x16x32_bf16 v[124:127], v[68:71], v[84:87], v[124:127]
    ds_read_b64_tr_b16 v[100:101], v7 offset:36864
    v_xor_b32 v74, v12, v38
    v_mfma_f32_16x16x32_bf16 v[128:131], v[64:67], v[88:91], v[128:131]
    ds_read_b64_tr_b16 v[102:103], v7 offset:37376
    v_xor_b32 v75, v12, v39
    v_mfma_f32_16x16x32_bf16 v[132:135], v[68:71], v[88:91], v[132:135]
    ds_read_b64_tr_b16 v[104:105], v8 offset:36864
    ds_read_b64_tr_b16 v[106:107], v8 offset:37376
    v_xor_b32 v76, v12, v52
    v_xor_b32 v77, v12, v53
    v_mfma_f32_16x16x32_bf16 v[136:139], v[64:67], v[92:95], v[136:139]
    ds_read_b64_tr_b16 v[108:109], v9 offset:36864
    v_xor_b32 v78, v12, v54
    v_mfma_f32_16x16x32_bf16 v[140:143], v[68:71], v[92:95], v[140:143]
    ds_read_b64_tr_b16 v[110:111], v9 offset:37376
    v_xor_b32 v79, v12, v55
    s_waitcnt lgkmcnt(0)
    v_mfma_f32_16x16x32_bf16 v[112:115], v[72:75], v[96:99], v[112:115]
    v_mfma_f32_16x16x32_bf16 v[116:119], v[76:79], v[96:99], v[116:119]
    s_waitcnt vmcnt(2)
    s_barrier
    v_mfma_f32_16x16x32_bf16 v[120:123], v[72:75], v[100:103], v[120:123]
    ds_read_b64_tr_b16 v[80:81], v6 offset:40960
    ds_read_b64_tr_b16 v[82:83], v6 offset:41472
    v_xor_b32 v64, v12, v40
    v_xor_b32 v65, v12, v41
    v_mfma_f32_16x16x32_bf16 v[124:127], v[76:79], v[100:103], v[124:127]
    ds_read_b64_tr_b16 v[84:85], v7 offset:40960
    v_xor_b32 v66, v12, v42
    v_mfma_f32_16x16x32_bf16 v[128:131], v[72:75], v[104:107], v[128:131]
    ds_read_b64_tr_b16 v[86:87], v7 offset:41472
    v_xor_b32 v67, v12, v43
    v_mfma_f32_16x16x32_bf16 v[132:135], v[76:79], v[104:107], v[132:135]
    ds_read_b64_tr_b16 v[88:89], v8 offset:40960
    ds_read_b64_tr_b16 v[90:91], v8 offset:41472
    v_xor_b32 v68, v12, v56
    v_xor_b32 v69, v12, v57
    v_mfma_f32_16x16x32_bf16 v[136:139], v[72:75], v[108:111], v[136:139]
    ds_read_b64_tr_b16 v[92:93], v9 offset:40960
    v_xor_b32 v70, v12, v58
    v_mfma_f32_16x16x32_bf16 v[140:143], v[76:79], v[108:111], v[140:143]
    ds_read_b64_tr_b16 v[94:95], v9 offset:41472
    v_xor_b32 v71, v12, v59
    s_waitcnt lgkmcnt(0)
    v_mfma_f32_16x16x32_bf16 v[112:115], v[64:67], v[80:83], v[112:115]
    v_mfma_f32_16x16x32_bf16 v[116:119], v[68:71], v[80:83], v[116:119]
    v_mfma_f32_16x16x32_bf16 v[120:123], v[64:67], v[84:87], v[120:123]
    ds_read_b64_tr_b16 v[96:97], v6 offset:45056
    ds_read_b64_tr_b16 v[98:99], v6 offset:45568
    v_xor_b32 v72, v12, v44
    v_xor_b32 v73, v12, v45
    v_mfma_f32_16x16x32_bf16 v[124:127], v[68:71], v[84:87], v[124:127]
    ds_read_b64_tr_b16 v[100:101], v7 offset:45056
    v_xor_b32 v74, v12, v46
    v_mfma_f32_16x16x32_bf16 v[128:131], v[64:67], v[88:91], v[128:131]
    ds_read_b64_tr_b16 v[102:103], v7 offset:45568
    v_xor_b32 v75, v12, v47
    v_mfma_f32_16x16x32_bf16 v[132:135], v[68:71], v[88:91], v[132:135]
    ds_read_b64_tr_b16 v[104:105], v8 offset:45056
    ds_read_b64_tr_b16 v[106:107], v8 offset:45568
    v_xor_b32 v76, v12, v60
    v_xor_b32 v77, v12, v61
    v_mfma_f32_16x16x32_bf16 v[136:139], v[64:67], v[92:95], v[136:139]
    ds_read_b64_tr_b16 v[108:109], v9 offset:45056
    v_xor_b32 v78, v12, v62
    v_mfma_f32_16x16x32_bf16 v[140:143], v[68:71], v[92:95], v[140:143]
    ds_read_b64_tr_b16 v[110:111], v9 offset:45568
    v_xor_b32 v79, v12, v63
    s_waitcnt lgkmcnt(0)
    v_mfma_f32_16x16x32_bf16 v[112:115], v[72:75], v[96:99], v[112:115]
    v_mfma_f32_16x16x32_bf16 v[116:119], v[76:79], v[96:99], v[116:119]
    s_waitcnt vmcnt(1)
    s_barrier
    v_mfma_f32_16x16x32_bf16 v[120:123], v[72:75], v[100:103], v[120:123]
    ds_read_b64_tr_b16 v[80:81], v6 offset:49152
    ds_read_b64_tr_b16 v[82:83], v6 offset:49664
    v_xor_b32_dpp v64, v32, v13 quad_perm:[1,0,2,3] row_mask:0xf bank_mask:0xf
    v_xor_b32_dpp v65, v33, v13 quad_perm:[1,0,2,3] row_mask:0xf bank_mask:0xf
    v_mfma_f32_16x16x32_bf16 v[124:127], v[76:79], v[100:103], v[124:127]
    ds_read_b64_tr_b16 v[84:85], v7 offset:49152
    v_xor_b32_dpp v66, v34, v13 quad_perm:[1,0,2,3] row_mask:0xf bank_mask:0xf
    v_mfma_f32_16x16x32_bf16 v[128:131], v[72:75], v[104:107], v[128:131]
    ds_read_b64_tr_b16 v[86:87], v7 offset:49664
    v_xor_b32_dpp v67, v35, v13 quad_perm:[1,0,2,3] row_mask:0xf bank_mask:0xf
    v_mfma_f32_16x16x32_bf16 v[132:135], v[76:79], v[104:107], v[132:135]
    ds_read_b64_tr_b16 v[88:89], v8 offset:49152
    ds_read_b64_tr_b16 v[90:91], v8 offset:49664
    v_xor_b32_dpp v68, v48, v14 quad_perm:[1,0,2,3] row_mask:0xf bank_mask:0xf
    v_xor_b32_dpp v69, v49, v14 quad_perm:[1,0,2,3] row_mask:0xf bank_mask:0xf
    v_mfma_f32_16x16x32_bf16 v[136:139], v[72:75], v[108:111], v[136:139]
    ds_read_b64_tr_b16 v[92:93], v9 offset:49152
    v_xor_b32_dpp v70, v50, v14 quad_perm:[1,0,2,3] row_mask:0xf bank_mask:0xf
    v_mfma_f32_16x16x32_bf16 v[140:143], v[76:79], v[108:111], v[140:143]
    ds_read_b64_tr_b16 v[94:95], v9 offset:49664
    v_xor_b32_dpp v71, v51, v14 quad_perm:[1,0,2,3] row_mask:0xf bank_mask:0xf
    s_waitcnt lgkmcnt(0)
    v_mfma_f32_16x16x32_bf16 v[112:115], v[64:67], v[80:83], v[112:115]
    v_mfma_f32_16x16x32_bf16 v[116:119], v[68:71], v[80:83], v[116:119]
    v_mfma_f32_16x16x32_bf16 v[120:123], v[64:67], v[84:87], v[120:123]
    ds_read_b64_tr_b16 v[96:97], v6 offset:53248
    ds_read_b64_tr_b16 v[98:99], v6 offset:53760
    v_xor_b32_dpp v72, v36, v13 quad_perm:[1,0,2,3] row_mask:0xf bank_mask:0xf
    v_xor_b32_dpp v73, v37, v13 quad_perm:[1,0,2,3] row_mask:0xf bank_mask:0xf
    v_mfma_f32_16x16x32_bf16 v[124:127], v[68:71], v[84:87], v[124:127]
    ds_read_b64_tr_b16 v[100:101], v7 offset:53248
    v_xor_b32_dpp v74, v38, v13 quad_perm:[1,0,2,3] row_mask:0xf bank_mask:0xf
    v_mfma_f32_16x16x32_bf16 v[128:131], v[64:67], v[88:91], v[128:131]
    ds_read_b64_tr_b16 v[102:103], v7 offset:53760
    v_xor_b32_dpp v75, v39, v13 quad_perm:[1,0,2,3] row_mask:0xf bank_mask:0xf
    v_mfma_f32_16x16x32_bf16 v[132:135], v[68:71], v[88:91], v[132:135]
    ds_read_b64_tr_b16 v[104:105], v8 offset:53248
    ds_read_b64_tr_b16 v[106:107], v8 offset:53760
    v_xor_b32_dpp v76, v52, v14 quad_perm:[1,0,2,3] row_mask:0xf bank_mask:0xf
    v_xor_b32_dpp v77, v53, v14 quad_perm:[1,0,2,3] row_mask:0xf bank_mask:0xf
    v_mfma_f32_16x16x32_bf16 v[136:139], v[64:67], v[92:95], v[136:139]
    ds_read_b64_tr_b16 v[108:109], v9 offset:53248
    v_xor_b32_dpp v78, v54, v14 quad_perm:[1,0,2,3] row_mask:0xf bank_mask:0xf
    v_mfma_f32_16x16x32_bf16 v[140:143], v[68:71], v[92:95], v[140:143]
    ds_read_b64_tr_b16 v[110:111], v9 offset:53760
    v_xor_b32_dpp v79, v55, v14 quad_perm:[1,0,2,3] row_mask:0xf bank_mask:0xf
    s_waitcnt lgkmcnt(0)
    v_mfma_f32_16x16x32_bf16 v[112:115], v[72:75], v[96:99], v[112:115]
    v_mfma_f32_16x16x32_bf16 v[116:119], v[76:79], v[96:99], v[116:119]
    s_waitcnt vmcnt(0)
    s_barrier
    v_mfma_f32_16x16x32_bf16 v[120:123], v[72:75], v[100:103], v[120:123]
    ds_read_b64_tr_b16 v[80:81], v6 offset:57344
    ds_read_b64_tr_b16 v[82:83], v6 offset:57856
    v_xor_b32_dpp v64, v40, v13 quad_perm:[1,0,2,3] row_mask:0xf bank_mask:0xf
    v_xor_b32_dpp v65, v41, v13 quad_perm:[1,0,2,3] row_mask:0xf bank_mask:0xf
    v_mfma_f32_16x16x32_bf16 v[124:127], v[76:79], v[100:103], v[124:127]
    ds_read_b64_tr_b16 v[84:85], v7 offset:57344
    v_xor_b32_dpp v66, v42, v13 quad_perm:[1,0,2,3] row_mask:0xf bank_mask:0xf
    v_mfma_f32_16x16x32_bf16 v[128:131], v[72:75], v[104:107], v[128:131]
    ds_read_b64_tr_b16 v[86:87], v7 offset:57856
    v_xor_b32_dpp v67, v43, v13 quad_perm:[1,0,2,3] row_mask:0xf bank_mask:0xf
    v_mfma_f32_16x16x32_bf16 v[132:135], v[76:79], v[104:107], v[132:135]
    ds_read_b64_tr_b16 v[88:89], v8 offset:57344
    ds_read_b64_tr_b16 v[90:91], v8 offset:57856
    v_xor_b32_dpp v68, v56, v14 quad_perm:[1,0,2,3] row_mask:0xf bank_mask:0xf
    v_xor_b32_dpp v69, v57, v14 quad_perm:[1,0,2,3] row_mask:0xf bank_mask:0xf
    v_mfma_f32_16x16x32_bf16 v[136:139], v[72:75], v[108:111], v[136:139]
    ds_read_b64_tr_b16 v[92:93], v9 offset:57344
    v_xor_b32_dpp v70, v58, v14 quad_perm:[1,0,2,3] row_mask:0xf bank_mask:0xf
    v_mfma_f32_16x16x32_bf16 v[140:143], v[76:79], v[108:111], v[140:143]
    ds_read_b64_tr_b16 v[94:95], v9 offset:57856
    v_xor_b32_dpp v71, v59, v14 quad_perm:[1,0,2,3] row_mask:0xf bank_mask:0xf
    s_waitcnt lgkmcnt(0)
    v_mfma_f32_16x16x32_bf16 v[112:115], v[64:67], v[80:83], v[112:115]
    v_mfma_f32_16x16x32_bf16 v[116:119], v[68:71], v[80:83], v[116:119]
    v_mfma_f32_16x16x32_bf16 v[120:123], v[64:67], v[84:87], v[120:123]
    ds_read_b64_tr_b16 v[96:97], v6 offset:61440
    ds_read_b64_tr_b16 v[98:99], v6 offset:61952
    v_xor_b32_dpp v72, v44, v13 quad_perm:[1,0,2,3] row_mask:0xf bank_mask:0xf
    v_xor_b32_dpp v73, v45, v13 quad_perm:[1,0,2,3] row_mask:0xf bank_mask:0xf
    v_mfma_f32_16x16x32_bf16 v[124:127], v[68:71], v[84:87], v[124:127]
    ds_read_b64_tr_b16 v[100:101], v7 offset:61440
    v_xor_b32_dpp v74, v46, v13 quad_perm:[1,0,2,3] row_mask:0xf bank_mask:0xf
    v_mfma_f32_16x16x32_bf16 v[128:131], v[64:67], v[88:91], v[128:131]
    ds_read_b64_tr_b16 v[102:103], v7 offset:61952
    v_xor_b32_dpp v75, v47, v13 quad_perm:[1,0,2,3] row_mask:0xf bank_mask:0xf
    v_xor_b32_dpp v76, v60, v14 quad_perm:[1,0,2,3] row_mask:0xf bank_mask:0xf
    v_mfma_f32_16x16x32_bf16 v[132:135], v[68:71], v[88:91], v[132:135]
    ds_read_b64_tr_b16 v[104:105], v8 offset:61440
    ds_read_b64_tr_b16 v[106:107], v8 offset:61952
    v_xor_b32_dpp v77, v61, v14 quad_perm:[1,0,2,3] row_mask:0xf bank_mask:0xf
    v_mfma_f32_16x16x32_bf16 v[136:139], v[64:67], v[92:95], v[136:139]
    ds_read_b64_tr_b16 v[108:109], v9 offset:61440
    v_xor_b32_dpp v78, v62, v14 quad_perm:[1,0,2,3] row_mask:0xf bank_mask:0xf
    v_xor_b32_dpp v79, v63, v14 quad_perm:[1,0,2,3] row_mask:0xf bank_mask:0xf
    v_mfma_f32_16x16x32_bf16 v[140:143], v[68:71], v[92:95], v[140:143]
    ds_read_b64_tr_b16 v[110:111], v9 offset:61952
    global_store_dwordx4 v20, v[24:27], s[22:23] sc1
    s_waitcnt lgkmcnt(0)
    v_mfma_f32_16x16x32_bf16 v[112:115], v[72:75], v[96:99], v[112:115]
    v_mfma_f32_16x16x32_bf16 v[116:119], v[76:79], v[96:99], v[116:119]
    v_mfma_f32_16x16x32_bf16 v[120:123], v[72:75], v[100:103], v[120:123]
    v_mfma_f32_16x16x32_bf16 v[124:127], v[76:79], v[100:103], v[124:127]
    v_mfma_f32_16x16x32_bf16 v[128:131], v[72:75], v[104:107], v[128:131]
    v_mfma_f32_16x16x32_bf16 v[132:135], v[76:79], v[104:107], v[132:135]
    v_mfma_f32_16x16x32_bf16 v[136:139], v[72:75], v[108:111], v[136:139]
    v_mfma_f32_16x16x32_bf16 v[140:143], v[76:79], v[108:111], v[140:143]
    s_lshl_b32 s40, s25, 3
    s_add_u32 s40, s40, s3
    s_cmp_eq_u32 s40, 15
    s_cselect_b32 s41, 3, 99
    v_cmp_eq_u32 vcc, s41, v3
    v_mov_b32 v21, 0x3d800000
    v_mov_b32 v22, 0x3d3504f3
    v_cndmask_b32 v22, v21, v22, vcc
    v_mov_b32 v23, 0
    v_cndmask_b32 v23, v21, v23, vcc
    v_mul_f32 v112, v21, v112
    v_mul_f32 v113, v21, v113
    v_mul_f32 v114, v21, v114
    v_mul_f32 v115, v21, v115
    v_mul_f32 v116, v21, v116
    v_mul_f32 v117, v21, v117
    v_mul_f32 v118, v22, v118
    v_mul_f32 v119, v23, v119
    v_mul_f32 v120, v21, v120
    v_mul_f32 v121, v21, v121
    v_mul_f32 v122, v21, v122
    v_mul_f32 v123, v21, v123
    v_mul_f32 v124, v21, v124
    v_mul_f32 v125, v21, v125
    v_mul_f32 v126, v22, v126
    v_mul_f32 v127, v23, v127
    v_mul_f32 v128, v21, v128
    v_mul_f32 v129, v21, v129
    v_mul_f32 v130, v21, v130
    v_mul_f32 v131, v21, v131
    v_mul_f32 v132, v21, v132
    v_mul_f32 v133, v21, v133
    v_mul_f32 v134, v22, v134
    v_mul_f32 v135, v23, v135
    v_mul_f32 v136, v21, v136
    v_mul_f32 v137, v21, v137
    v_mul_f32 v138, v21, v138
    v_mul_f32 v139, v21, v139
    v_mul_f32 v140, v21, v140
    v_mul_f32 v141, v21, v141
    v_mul_f32 v142, v22, v142
    v_mul_f32 v143, v23, v143
    s_lshr_b32 s41, s33, 2
    s_lshl_b32 s41, s41, 18
    s_lshl_b32 s40, s40, 14
    s_add_u32 s40, s40, s41
    s_bfe_u32 s41, s33, 0x10001
    s_lshl_b32 s41, s41, 13
    s_add_u32 s40, s40, s41
    s_and_b32 s41, s33, 1
    s_lshl_b32 s41, s41, 10
    s_add_u32 s40, s40, s41
    s_add_u32 s40, s40, 5242880
    v_lshlrev_b32 v24, 4, v2
    v_add_u32 v25, 4096, v24
    s_add_u32 s34, s22, s40
    s_addc_u32 s35, s23, 0
    v_cvt_pk_bf16_f32 v32, v112, v113
    v_cvt_pk_bf16_f32 v33, v114, v115
    v_cvt_pk_bf16_f32 v34, v116, v117
    v_cvt_pk_bf16_f32 v35, v118, v119
    global_store_dwordx4 v24, v[32:35], s[34:35] offset:0 sc1
    v_cvt_pk_bf16_f32 v36, v120, v121
    v_cvt_pk_bf16_f32 v37, v122, v123
    v_cvt_pk_bf16_f32 v38, v124, v125
    v_cvt_pk_bf16_f32 v39, v126, v127
    global_store_dwordx4 v24, v[36:39], s[34:35] offset:2048 sc1
    v_cvt_pk_bf16_f32 v40, v128, v129
    v_cvt_pk_bf16_f32 v41, v130, v131
    v_cvt_pk_bf16_f32 v42, v132, v133
    v_cvt_pk_bf16_f32 v43, v134, v135
    global_store_dwordx4 v25, v[40:43], s[34:35] offset:0 sc1
    v_cvt_pk_bf16_f32 v44, v136, v137
    v_cvt_pk_bf16_f32 v45, v138, v139
    v_cvt_pk_bf16_f32 v46, v140, v141
    v_cvt_pk_bf16_f32 v47, v142, v143
    global_store_dwordx4 v25, v[44:47], s[34:35] offset:2048 sc1
    s_branch k1_end
k1_helper:
    s_cmp_ge_u32 s2, 240
    s_cbranch_scc0 k1_fslice
    s_sub_u32 s33, s2, 228
    v_and_b32 v23, 6, v21
    v_xor_b32 v23, v23, v22
    v_lshlrev_b32 v23, 4, v23
    v_lshl_add_u32 v5, v21, 10, v23
    s_mov_b32 s30, 128
    s_lshl_b32 s40, s33, 3
    s_add_u32 s40, s40, s3
    s_lshl_b32 s40, s40, 13
    s_add_u32 s28, s16, s40
    s_addc_u32 s29, s17, 0
    s_add_u32 m0, s31, 0
    s_nop 0
    global_load_lds_dwordx4 v5, s[28:29]
    s_add_u32 s28, s28, s30
    s_addc_u32 s29, s29, 0
    s_add_u32 m0, s31, 8192
    s_nop 0
    global_load_lds_dwordx4 v5, s[28:29]
    s_add_u32 s28, s28, s30
    s_addc_u32 s29, s29, 0
    s_add_u32 m0, s31, 16384
    s_nop 0
    global_load_lds_dwordx4 v5, s[28:29]
    s_add_u32 s28, s28, s30
    s_addc_u32 s29, s29, 0
    s_add_u32 m0, s31, 24576
    s_nop 0
    global_load_lds_dwordx4 v5, s[28:29]
    s_add_u32 s28, s28, s30
    s_addc_u32 s29, s29, 0
    s_add_u32 m0, s31, 32768
    s_nop 0
    global_load_lds_dwordx4 v5, s[28:29]
    s_add_u32 s28, s28, s30
    s_addc_u32 s29, s29, 0
    s_add_u32 m0, s31, 40960
    s_nop 0
    global_load_lds_dwordx4 v5, s[28:29]
    s_add_u32 s28, s28, s30
    s_addc_u32 s29, s29, 0
    s_add_u32 m0, s31, 49152
    s_nop 0
    global_load_lds_dwordx4 v5, s[28:29]
    s_add_u32 s28, s28, s30
    s_addc_u32 s29, s29, 0
    s_add_u32 m0, s31, 57344
    s_nop 0
    global_load_lds_dwordx4 v5, s[28:29]
    s_add_u32 s28, s28, s30
    s_addc_u32 s29, s29, 0
    v_lshrrev_b32 v21, 3, v2
    v_and_b32 v22, 7, v2
    v_bfe_u32 v23, v2, 4, 1
    v_lshlrev_b32 v23, 2, v23
    v_xor_b32 v23, v23, v22
    v_lshlrev_b32 v23, 4, v23
    v_lshl_add_u32 v23, v21, 7, v23
    s_add_u32 s40, s31, 65536
    v_add_u32 v17, s40, v23
    v_bfe_u32 v21, v2, 2, 2
    v_and_b32 v22, 3, v2
    s_lshr_b32 s40, s3, 2
    s_lshl_b32 s40, s40, 5
    s_and_b32 s41, s3, 3
    s_lshl_b32 s41, s41, 2
    s_add_u32 s40, s40, s41
    s_lshl_b32 s40, s40, 7
    s_add_u32 s40, s40, 65536
    v_lshrrev_b32 v23, 1, v22
    v_lshl_add_u32 v23, v3, 1, v23
    v_lshrrev_b32 v18, 1, v21
    v_lshlrev_b32 v18, 2, v18
    v_xor_b32 v23, v23, v18
    v_lshlrev_b32 v23, 4, v23
    v_lshl_add_u32 v23, v21, 7, v23
    v_and_b32 v22, 1, v22
    v_lshl_add_u32 v23, v22, 3, v23
    v_add_u32 v18, s40, v23
    s_and_b32 s40, s3, 3
    s_lshl_b32 s40, s40, 1
    s_lshr_b32 s41, s3, 2
    s_add_u32 s40, s40, s41
    v_and_b32 v22, 7, v2
    v_xor_b32 v22, s40, v22
    v_lshlrev_b32 v22, 4, v22
    v_lshl_add_u32 v22, v2, 7, v22
    v_add_u32 v19, 73728, v22
    v_lshrrev_b32 v21, 3, v2
    v_and_b32 v22, 7, v2
    v_xor_b32 v22, v22, v21
    v_lshlrev_b32 v22, 4, v22
    v_lshl_add_u32 v22, v21, 13, v22
    s_and_b32 s40, s2, 3
    s_lshl_b32 s40, s40, 3
    s_add_u32 s40, s40, s3
    s_lshl_b32 s40, s40, 16
    s_lshl_b32 s41, s27, 7
    s_add_u32 s40, s40, s41
    s_add_u32 s40, s40, 20971520
    v_add_u32 v20, s40, v22
    s_waitcnt vmcnt(8)
    ds_write_b128 v17, v[24:27]
    s_waitcnt lgkmcnt(0)
    s_barrier
    ds_read_b64_tr_b16 v[24:25], v18
    ds_read_b64_tr_b16 v[26:27], v18 offset:2048
    s_waitcnt lgkmcnt(0)
    ds_write_b128 v19, v[24:27]
    s_waitcnt lgkmcnt(0)
    s_barrier
    v_lshlrev_b32 v21, 4, v2
    s_add_u32 s40, s31, 73728
    v_add_u32 v21, s40, v21
    ds_read_b128 v[24:27], v21
    s_waitcnt lgkmcnt(0)
    global_store_dwordx4 v20, v[24:27], s[22:23] sc1
    s_lshr_b32 s40, s3, 1
    s_lshl_b32 s40, s40, 13
    s_and_b32 s41, s3, 1
    s_lshl_b32 s41, s41, 2
    v_bfe_u32 v21, v2, 2, 2
    v_and_b32 v22, 3, v2
    v_lshl_add_u32 v23, v3, 2, v21
    v_and_b32 v21, 6, v23
    v_lshlrev_b32 v23, 7, v23
    v_lshrrev_b32 v144, 1, v22
    v_or_b32 v144, s41, v144
    v_xor_b32 v144, v144, v21
    v_lshl_add_u32 v23, v144, 4, v23
    v_and_b32 v22, 1, v22
    v_lshl_add_u32 v23, v22, 3, v23
    v_add_u32 v23, s40, v23
    v_xor_b32 v22, 32, v23
    s_mul_i32 s40, s3, 114688
    s_lshl_b32 s41, s33, 11
    s_add_u32 s40, s40, s41
    s_add_u32 s40, s40, 18874368
    v_lshlrev_b32 v144, 4, v2
    v_add_u32 v145, 57344, v144
    s_add_u32 s36, s22, s40
    s_addc_u32 s37, s23, 0
    s_waitcnt vmcnt(0)
    s_barrier
    ds_read_b64_tr_b16 v[64:65], v23 offset:0
    ds_read_b64_tr_b16 v[66:67], v23 offset:2048
    ds_read_b64_tr_b16 v[68:69], v23 offset:4096
    ds_read_b64_tr_b16 v[70:71], v23 offset:6144
    ds_read_b64_tr_b16 v[72:73], v22 offset:0
    ds_read_b64_tr_b16 v[74:75], v22 offset:2048
    ds_read_b64_tr_b16 v[76:77], v22 offset:4096
    ds_read_b64_tr_b16 v[78:79], v22 offset:6144
    ds_read_b64_tr_b16 v[80:81], v23 offset:32768
    ds_read_b64_tr_b16 v[82:83], v23 offset:34816
    ds_read_b64_tr_b16 v[84:85], v23 offset:36864
    ds_read_b64_tr_b16 v[86:87], v23 offset:38912
    ds_read_b64_tr_b16 v[88:89], v22 offset:32768
    ds_read_b64_tr_b16 v[90:91], v22 offset:34816
    ds_read_b64_tr_b16 v[92:93], v22 offset:36864
    ds_read_b64_tr_b16 v[94:95], v22 offset:38912
    s_waitcnt lgkmcnt(8)
    global_store_dwordx4 v144, v[64:67], s[36:37] offset:0 sc1
    global_store_dwordx4 v144, v[68:71], s[36:37] offset:1024 sc1
    global_store_dwordx4 v145, v[72:75], s[36:37] offset:0 sc1
    global_store_dwordx4 v145, v[76:79], s[36:37] offset:1024 sc1
    s_add_u32 s36, s36, 917504
    s_addc_u32 s37, s37, 0
    s_waitcnt lgkmcnt(0)
    global_store_dwordx4 v144, v[80:83], s[36:37] offset:0 sc1
    global_store_dwordx4 v144, v[84:87], s[36:37] offset:1024 sc1
    global_store_dwordx4 v145, v[88:91], s[36:37] offset:0 sc1
    global_store_dwordx4 v145, v[92:95], s[36:37] offset:1024 sc1
    s_branch k1_end
    s_branch k1_fslice
    s_sub_u32 s33, s2, 240
    s_and_b32 s40, s33, 3
    s_lshl_b32 s40, s40, 3
    s_bfe_u32 s41, s33, 0x10002
    s_lshl_b32 s41, s41, 5
    s_add_u32 s40, s40, s41
    s_lshl_b32 s40, s40, 15
    s_lshl_b32 s41, s3, 1
    s_lshr_b32 s42, s33, 3
    s_lshl_b32 s42, s42, 4
    s_add_u32 s41, s41, s42
    s_lshl_b32 s41, s41, 10
    s_add_u32 s40, s40, s41
    v_lshlrev_b32 v21, 4, v2
    s_add_u32 s28, s4, s40
    s_addc_u32 s29, s5, 0
    v_and_b32 v21, 7, v4
    v_lshlrev_b32 v21, 15, v21
    v_lshrrev_b32 v22, 3, v4
    v_lshl_add_u32 v21, v22, 10, v21
    v_lshl_add_u32 v21, v3, 4, v21
    global_load_dwordx4 v[32:35], v21, s[28:29]
    global_load_dwordx4 v[36:39], v21, s[28:29] offset:64
    global_load_dwordx4 v[40:43], v21, s[28:29] offset:128
    global_load_dwordx4 v[44:47], v21, s[28:29] offset:192
    global_load_dwordx4 v[48:51], v21, s[28:29] offset:256
    global_load_dwordx4 v[52:55], v21, s[28:29] offset:320
    global_load_dwordx4 v[56:59], v21, s[28:29] offset:384
    global_load_dwordx4 v[60:63], v21, s[28:29] offset:448
    global_load_dwordx4 v[64:67], v21, s[28:29] offset:512
    global_load_dwordx4 v[68:71], v21, s[28:29] offset:576
    global_load_dwordx4 v[72:75], v21, s[28:29] offset:640
    global_load_dwordx4 v[76:79], v21, s[28:29] offset:704
    global_load_dwordx4 v[80:83], v21, s[28:29] offset:768
    global_load_dwordx4 v[84:87], v21, s[28:29] offset:832
    global_load_dwordx4 v[88:91], v21, s[28:29] offset:896
    global_load_dwordx4 v[92:95], v21, s[28:29] offset:960
    v_lshrrev_b32 v21, 3, v2
    v_and_b32 v22, 7, v2
    v_bfe_u32 v23, v2, 4, 1
    v_lshlrev_b32 v23, 2, v23
    v_xor_b32 v23, v23, v22
    v_lshlrev_b32 v23, 4, v23
    v_lshl_add_u32 v23, v21, 7, v23
    s_add_u32 s40, s31, 65536
    v_add_u32 v17, s40, v23
    v_bfe_u32 v21, v2, 2, 2
    v_and_b32 v22, 3, v2
    s_lshr_b32 s40, s3, 2
    s_lshl_b32 s40, s40, 5
    s_and_b32 s41, s3, 3
    s_lshl_b32 s41, s41, 2
    s_add_u32 s40, s40, s41
    s_lshl_b32 s40, s40, 7
    s_add_u32 s40, s40, 65536
    v_lshrrev_b32 v23, 1, v22
    v_lshl_add_u32 v23, v3, 1, v23
    v_lshrrev_b32 v18, 1, v21
    v_lshlrev_b32 v18, 2, v18
    v_xor_b32 v23, v23, v18
    v_lshlrev_b32 v23, 4, v23
    v_lshl_add_u32 v23, v21, 7, v23
    v_and_b32 v22, 1, v22
    v_lshl_add_u32 v23, v22, 3, v23
    v_add_u32 v18, s40, v23
    s_and_b32 s40, s3, 3
    s_lshl_b32 s40, s40, 1
    s_lshr_b32 s41, s3, 2
    s_add_u32 s40, s40, s41
    v_and_b32 v22, 7, v2
    v_xor_b32 v22, s40, v22
    v_lshlrev_b32 v22, 4, v22
    v_lshl_add_u32 v22, v2, 7, v22
    v_add_u32 v19, 73728, v22
    v_lshrrev_b32 v21, 3, v2
    v_and_b32 v22, 7, v2
    v_xor_b32 v22, v22, v21
    v_lshlrev_b32 v22, 4, v22
    v_lshl_add_u32 v22, v21, 13, v22
    s_and_b32 s40, s2, 3
    s_lshl_b32 s40, s40, 3
    s_add_u32 s40, s40, s3
    s_lshl_b32 s40, s40, 16
    s_lshl_b32 s41, s27, 7
    s_add_u32 s40, s40, s41
    s_add_u32 s40, s40, 20971520
    v_add_u32 v20, s40, v22
    s_waitcnt vmcnt(16)
    ds_write_b128 v17, v[24:27]
    s_waitcnt lgkmcnt(0)
    s_barrier
    ds_read_b64_tr_b16 v[24:25], v18
    ds_read_b64_tr_b16 v[26:27], v18 offset:2048
    s_waitcnt lgkmcnt(0)
    ds_write_b128 v19, v[24:27]
    s_waitcnt lgkmcnt(0)
    s_barrier
    v_lshlrev_b32 v21, 4, v2
    s_add_u32 s40, s31, 73728
    v_add_u32 v21, s40, v21
    ds_read_b128 v[24:27], v21
    v_mov_b32 v112, 0x3f803f80
    v_mov_b32 v113, 0x3f803f80
    v_mov_b32 v114, 0x3f803f80
    v_mov_b32 v115, 0x3f803f80
    s_waitcnt vmcnt(15)
    v_mfma_f32_16x16x32_bf16 v[96:99], v[32:35], v[32:35], 0
    v_mfma_f32_16x16x32_bf16 v[104:107], v[32:35], v[112:115], 0
    s_waitcnt vmcnt(14)
    v_mfma_f32_16x16x32_bf16 v[100:103], v[36:39], v[36:39], 0
    v_mfma_f32_16x16x32_bf16 v[108:111], v[36:39], v[112:115], 0
    s_waitcnt vmcnt(13)
    v_mfma_f32_16x16x32_bf16 v[96:99], v[40:43], v[40:43], v[96:99]
    v_mfma_f32_16x16x32_bf16 v[104:107], v[40:43], v[112:115], v[104:107]
    s_waitcnt vmcnt(12)
    v_mfma_f32_16x16x32_bf16 v[100:103], v[44:47], v[44:47], v[100:103]
    v_mfma_f32_16x16x32_bf16 v[108:111], v[44:47], v[112:115], v[108:111]
    s_waitcnt vmcnt(11)
    v_mfma_f32_16x16x32_bf16 v[96:99], v[48:51], v[48:51], v[96:99]
    v_mfma_f32_16x16x32_bf16 v[104:107], v[48:51], v[112:115], v[104:107]
    s_waitcnt vmcnt(10)
    v_mfma_f32_16x16x32_bf16 v[100:103], v[52:55], v[52:55], v[100:103]
    v_mfma_f32_16x16x32_bf16 v[108:111], v[52:55], v[112:115], v[108:111]
    s_waitcnt vmcnt(9)
    v_mfma_f32_16x16x32_bf16 v[96:99], v[56:59], v[56:59], v[96:99]
    v_mfma_f32_16x16x32_bf16 v[104:107], v[56:59], v[112:115], v[104:107]
    s_waitcnt vmcnt(8)
    v_mfma_f32_16x16x32_bf16 v[100:103], v[60:63], v[60:63], v[100:103]
    v_mfma_f32_16x16x32_bf16 v[108:111], v[60:63], v[112:115], v[108:111]
    s_waitcnt vmcnt(7)
    v_mfma_f32_16x16x32_bf16 v[96:99], v[64:67], v[64:67], v[96:99]
    v_mfma_f32_16x16x32_bf16 v[104:107], v[64:67], v[112:115], v[104:107]
    s_waitcnt vmcnt(6)
    v_mfma_f32_16x16x32_bf16 v[100:103], v[68:71], v[68:71], v[100:103]
    v_mfma_f32_16x16x32_bf16 v[108:111], v[68:71], v[112:115], v[108:111]
    s_waitcnt vmcnt(5)
    v_mfma_f32_16x16x32_bf16 v[96:99], v[72:75], v[72:75], v[96:99]
    v_mfma_f32_16x16x32_bf16 v[104:107], v[72:75], v[112:115], v[104:107]
    s_waitcnt vmcnt(4)
    v_mfma_f32_16x16x32_bf16 v[100:103], v[76:79], v[76:79], v[100:103]
    v_mfma_f32_16x16x32_bf16 v[108:111], v[76:79], v[112:115], v[108:111]
    s_waitcnt vmcnt(3)
    v_mfma_f32_16x16x32_bf16 v[96:99], v[80:83], v[80:83], v[96:99]
    v_mfma_f32_16x16x32_bf16 v[104:107], v[80:83], v[112:115], v[104:107]
    s_waitcnt vmcnt(2)
    v_mfma_f32_16x16x32_bf16 v[100:103], v[84:87], v[84:87], v[100:103]
    v_mfma_f32_16x16x32_bf16 v[108:111], v[84:87], v[112:115], v[108:111]
    s_waitcnt vmcnt(1)
    v_mfma_f32_16x16x32_bf16 v[96:99], v[88:91], v[88:91], v[96:99]
    v_mfma_f32_16x16x32_bf16 v[104:107], v[88:91], v[112:115], v[104:107]
    s_waitcnt vmcnt(0)
    v_mfma_f32_16x16x32_bf16 v[100:103], v[92:95], v[92:95], v[100:103]
    v_mfma_f32_16x16x32_bf16 v[108:111], v[92:95], v[112:115], v[108:111]
    s_waitcnt lgkmcnt(0)
    global_store_dwordx4 v20, v[24:27], s[22:23] sc1
    s_nop 4
    v_add_f32 v96, v96, v100
    v_add_f32 v104, v104, v108
    v_add_f32 v97, v97, v101
    v_add_f32 v105, v105, v109
    v_add_f32 v98, v98, v102
    v_add_f32 v106, v106, v110
    v_add_f32 v99, v99, v103
    v_add_f32 v107, v107, v111
    v_and_b32 v22, 3, v4
    v_cmp_eq_u32 vcc, 1, v22
    s_nop 1
    v_cndmask_b32 v96, v96, v97, vcc
    v_cndmask_b32 v104, v104, v105, vcc
    v_cmp_eq_u32 vcc, 2, v22
    s_nop 1
    v_cndmask_b32 v96, v96, v98, vcc
    v_cndmask_b32 v104, v104, v106, vcc
    v_cmp_eq_u32 vcc, 3, v22
    s_nop 1
    v_cndmask_b32 v96, v96, v99, vcc
    v_cndmask_b32 v104, v104, v107, vcc
    v_mul_f32 v23, 0xbb000000, v104
    v_fmac_f32 v96, v23, v104
    v_max_f32 v96, 0, v96
    s_lshl_b32 s40, s33, 3
    s_add_u32 s40, s40, s3
    s_lshl_b32 s40, s40, 6
    s_add_u32 s40, s40, 4194304
    v_lshl_add_u32 v22, v4, 2, s40
    v_lshrrev_b32 v23, 2, v4
    v_cmp_eq_u32 vcc, v23, v3
    s_and_saveexec_b64 s[44:45], vcc
    global_store_dword v22, v96, s[22:23] sc1
    s_branch k1_end
k1_fslice:
    v_lshrrev_b32 v21, 3, v2
    v_and_b32 v22, 7, v2
    v_bfe_u32 v23, v2, 4, 1
    v_lshlrev_b32 v23, 2, v23
    v_xor_b32 v23, v23, v22
    v_lshlrev_b32 v23, 4, v23
    v_lshl_add_u32 v23, v21, 7, v23
    s_add_u32 s40, s31, 65536
    v_add_u32 v17, s40, v23
    v_bfe_u32 v21, v2, 2, 2
    v_and_b32 v22, 3, v2
    s_lshr_b32 s40, s3, 2
    s_lshl_b32 s40, s40, 5
    s_and_b32 s41, s3, 3
    s_lshl_b32 s41, s41, 2
    s_add_u32 s40, s40, s41
    s_lshl_b32 s40, s40, 7
    s_add_u32 s40, s40, 65536
    v_lshrrev_b32 v23, 1, v22
    v_lshl_add_u32 v23, v3, 1, v23
    v_lshrrev_b32 v18, 1, v21
    v_lshlrev_b32 v18, 2, v18
    v_xor_b32 v23, v23, v18
    v_lshlrev_b32 v23, 4, v23
    v_lshl_add_u32 v23, v21, 7, v23
    v_and_b32 v22, 1, v22
    v_lshl_add_u32 v23, v22, 3, v23
    v_add_u32 v18, s40, v23
    s_and_b32 s40, s3, 3
    s_lshl_b32 s40, s40, 1
    s_lshr_b32 s41, s3, 2
    s_add_u32 s40, s40, s41
    v_and_b32 v22, 7, v2
    v_xor_b32 v22, s40, v22
    v_lshlrev_b32 v22, 4, v22
    v_lshl_add_u32 v22, v2, 7, v22
    v_add_u32 v19, 73728, v22
    v_lshrrev_b32 v21, 3, v2
    v_and_b32 v22, 7, v2
    v_xor_b32 v22, v22, v21
    v_lshlrev_b32 v22, 4, v22
    v_lshl_add_u32 v22, v21, 13, v22
    s_and_b32 s40, s2, 3
    s_lshl_b32 s40, s40, 3
    s_add_u32 s40, s40, s3
    s_lshl_b32 s40, s40, 16
    s_lshl_b32 s41, s27, 7
    s_add_u32 s40, s40, s41
    s_add_u32 s40, s40, 20971520
    v_add_u32 v20, s40, v22
    s_waitcnt vmcnt(0)
    ds_write_b128 v17, v[24:27]
    s_waitcnt lgkmcnt(0)
    s_barrier
    ds_read_b64_tr_b16 v[24:25], v18
    ds_read_b64_tr_b16 v[26:27], v18 offset:2048
    s_waitcnt lgkmcnt(0)
    ds_write_b128 v19, v[24:27]
    s_waitcnt lgkmcnt(0)
    s_barrier
    v_lshlrev_b32 v21, 4, v2
    s_add_u32 s40, s31, 73728
    v_add_u32 v21, s40, v21
    ds_read_b128 v[24:27], v21
    s_waitcnt lgkmcnt(0)
    global_store_dwordx4 v20, v[24:27], s[22:23] sc1
    s_cmp_ge_u32 s2, 240
    s_cbranch_scc1 k1_end
    s_and_b32 s33, s2, 3
    s_lshl_b32 s40, s3, 4
    s_lshl_b32 s41, s25, 8
    s_add_u32 s40, s40, s41
    v_add_u32 v32, s40, v4
    v_add_u32 v33, 128, v32
    s_lshl_b32 s40, s33, 6
    s_add_u32 s40, s40, 1
    v_lshl_add_u32 v34, v3, 2, s40
    s_add_u32 s40, s25, 14
    s_lshl_b32 s40, s40, 18
    s_lshl_b32 s41, s33, 16
    s_add_u32 s40, s40, s41
    s_add_u32 s40, s40, s31
    s_add_u32 s40, s40, 5242880
    v_lshlrev_b32 v35, 4, v2
    s_add_u32 s34, s22, s40
    s_addc_u32 s35, s23, 0
    v_mov_b32 v36, 0x3d800000
    v_mov_b32 v37, 0xbd800000
    v_mov_b32 v38, 0x3d3504f3
    v_add_u32 v40, 0, v34
    v_add_u32 v41, 0, v40
    v_mul_u32_u24 v41, v41, v32
    v_and_b32 v41, 511, v41
    v_cvt_f32_u32 v41, v41
    v_mul_f32 v44, 0x3b000000, v41
    v_add_u32 v41, 1, v40
    v_mul_u32_u24 v41, v41, v32
    v_and_b32 v41, 511, v41
    v_cvt_f32_u32 v41, v41
    v_mul_f32 v45, 0x3b000000, v41
    v_add_u32 v41, 2, v40
    v_mul_u32_u24 v41, v41, v32
    v_and_b32 v41, 511, v41
    v_cvt_f32_u32 v41, v41
    v_mul_f32 v46, 0x3b000000, v41
    v_add_u32 v41, 3, v40
    v_mul_u32_u24 v41, v41, v32
    v_and_b32 v41, 511, v41
    v_cvt_f32_u32 v41, v41
    v_mul_f32 v47, 0x3b000000, v41
    v_cos_f32 v48, v44
    v_sin_f32 v49, v44
    v_cos_f32 v50, v45
    v_sin_f32 v51, v45
    v_cos_f32 v52, v46
    v_sin_f32 v53, v46
    v_cos_f32 v54, v47
    v_sin_f32 v55, v47
    v_mul_f32 v48, v36, v48
    v_mul_f32 v49, v37, v49
    v_mul_f32 v50, v36, v50
    v_mul_f32 v51, v37, v51
    v_mul_f32 v52, v36, v52
    v_mul_f32 v53, v37, v53
    v_mul_f32 v54, v36, v54
    v_mul_f32 v55, v37, v55
    v_cvt_pk_bf16_f32 v56, v48, v49
    v_cvt_pk_bf16_f32 v57, v50, v51
    v_cvt_pk_bf16_f32 v58, v52, v53
    v_cvt_pk_bf16_f32 v59, v54, v55
    v_add_u32 v42, 0, v35
    global_store_dwordx4 v42, v[56:59], s[34:35] sc1
    v_add_u32 v40, 0, v34
    v_add_u32 v41, 0, v40
    v_mul_u32_u24 v41, v41, v33
    v_and_b32 v41, 511, v41
    v_cvt_f32_u32 v41, v41
    v_mul_f32 v44, 0x3b000000, v41
    v_add_u32 v41, 1, v40
    v_mul_u32_u24 v41, v41, v33
    v_and_b32 v41, 511, v41
    v_cvt_f32_u32 v41, v41
    v_mul_f32 v45, 0x3b000000, v41
    v_add_u32 v41, 2, v40
    v_mul_u32_u24 v41, v41, v33
    v_and_b32 v41, 511, v41
    v_cvt_f32_u32 v41, v41
    v_mul_f32 v46, 0x3b000000, v41
    v_add_u32 v41, 3, v40
    v_mul_u32_u24 v41, v41, v33
    v_and_b32 v41, 511, v41
    v_cvt_f32_u32 v41, v41
    v_mul_f32 v47, 0x3b000000, v41
    v_cos_f32 v48, v44
    v_sin_f32 v49, v44
    v_cos_f32 v50, v45
    v_sin_f32 v51, v45
    v_cos_f32 v52, v46
    v_sin_f32 v53, v46
    v_cos_f32 v54, v47
    v_sin_f32 v55, v47
    v_mul_f32 v48, v36, v48
    v_mul_f32 v49, v37, v49
    v_mul_f32 v50, v36, v50
    v_mul_f32 v51, v37, v51
    v_mul_f32 v52, v36, v52
    v_mul_f32 v53, v37, v53
    v_mul_f32 v54, v36, v54
    v_mul_f32 v55, v37, v55
    v_cvt_pk_bf16_f32 v60, v48, v49
    v_cvt_pk_bf16_f32 v61, v50, v51
    v_cvt_pk_bf16_f32 v62, v52, v53
    v_cvt_pk_bf16_f32 v63, v54, v55
    v_add_u32 v42, 8192, v35
    global_store_dwordx4 v42, v[60:63], s[34:35] sc1
    v_add_u32 v40, 16, v34
    v_add_u32 v41, 0, v40
    v_mul_u32_u24 v41, v41, v32
    v_and_b32 v41, 511, v41
    v_cvt_f32_u32 v41, v41
    v_mul_f32 v44, 0x3b000000, v41
    v_add_u32 v41, 1, v40
    v_mul_u32_u24 v41, v41, v32
    v_and_b32 v41, 511, v41
    v_cvt_f32_u32 v41, v41
    v_mul_f32 v45, 0x3b000000, v41
    v_add_u32 v41, 2, v40
    v_mul_u32_u24 v41, v41, v32
    v_and_b32 v41, 511, v41
    v_cvt_f32_u32 v41, v41
    v_mul_f32 v46, 0x3b000000, v41
    v_add_u32 v41, 3, v40
    v_mul_u32_u24 v41, v41, v32
    v_and_b32 v41, 511, v41
    v_cvt_f32_u32 v41, v41
    v_mul_f32 v47, 0x3b000000, v41
    v_cos_f32 v48, v44
    v_sin_f32 v49, v44
    v_cos_f32 v50, v45
    v_sin_f32 v51, v45
    v_cos_f32 v52, v46
    v_sin_f32 v53, v46
    v_cos_f32 v54, v47
    v_sin_f32 v55, v47
    v_mul_f32 v48, v36, v48
    v_mul_f32 v49, v37, v49
    v_mul_f32 v50, v36, v50
    v_mul_f32 v51, v37, v51
    v_mul_f32 v52, v36, v52
    v_mul_f32 v53, v37, v53
    v_mul_f32 v54, v36, v54
    v_mul_f32 v55, v37, v55
    v_cvt_pk_bf16_f32 v56, v48, v49
    v_cvt_pk_bf16_f32 v57, v50, v51
    v_cvt_pk_bf16_f32 v58, v52, v53
    v_cvt_pk_bf16_f32 v59, v54, v55
    v_add_u32 v42, 16384, v35
    global_store_dwordx4 v42, v[56:59], s[34:35] sc1
    v_add_u32 v40, 16, v34
    v_add_u32 v41, 0, v40
    v_mul_u32_u24 v41, v41, v33
    v_and_b32 v41, 511, v41
    v_cvt_f32_u32 v41, v41
    v_mul_f32 v44, 0x3b000000, v41
    v_add_u32 v41, 1, v40
    v_mul_u32_u24 v41, v41, v33
    v_and_b32 v41, 511, v41
    v_cvt_f32_u32 v41, v41
    v_mul_f32 v45, 0x3b000000, v41
    v_add_u32 v41, 2, v40
    v_mul_u32_u24 v41, v41, v33
    v_and_b32 v41, 511, v41
    v_cvt_f32_u32 v41, v41
    v_mul_f32 v46, 0x3b000000, v41
    v_add_u32 v41, 3, v40
    v_mul_u32_u24 v41, v41, v33
    v_and_b32 v41, 511, v41
    v_cvt_f32_u32 v41, v41
    v_mul_f32 v47, 0x3b000000, v41
    v_cos_f32 v48, v44
    v_sin_f32 v49, v44
    v_cos_f32 v50, v45
    v_sin_f32 v51, v45
    v_cos_f32 v52, v46
    v_sin_f32 v53, v46
    v_cos_f32 v54, v47
    v_sin_f32 v55, v47
    v_mul_f32 v48, v36, v48
    v_mul_f32 v49, v37, v49
    v_mul_f32 v50, v36, v50
    v_mul_f32 v51, v37, v51
    v_mul_f32 v52, v36, v52
    v_mul_f32 v53, v37, v53
    v_mul_f32 v54, v36, v54
    v_mul_f32 v55, v37, v55
    v_cvt_pk_bf16_f32 v60, v48, v49
    v_cvt_pk_bf16_f32 v61, v50, v51
    v_cvt_pk_bf16_f32 v62, v52, v53
    v_cvt_pk_bf16_f32 v63, v54, v55
    v_add_u32 v42, 24576, v35
    global_store_dwordx4 v42, v[60:63], s[34:35] sc1
    v_add_u32 v40, 32, v34
    v_add_u32 v41, 0, v40
    v_mul_u32_u24 v41, v41, v32
    v_and_b32 v41, 511, v41
    v_cvt_f32_u32 v41, v41
    v_mul_f32 v44, 0x3b000000, v41
    v_add_u32 v41, 1, v40
    v_mul_u32_u24 v41, v41, v32
    v_and_b32 v41, 511, v41
    v_cvt_f32_u32 v41, v41
    v_mul_f32 v45, 0x3b000000, v41
    v_add_u32 v41, 2, v40
    v_mul_u32_u24 v41, v41, v32
    v_and_b32 v41, 511, v41
    v_cvt_f32_u32 v41, v41
    v_mul_f32 v46, 0x3b000000, v41
    v_add_u32 v41, 3, v40
    v_mul_u32_u24 v41, v41, v32
    v_and_b32 v41, 511, v41
    v_cvt_f32_u32 v41, v41
    v_mul_f32 v47, 0x3b000000, v41
    v_cos_f32 v48, v44
    v_sin_f32 v49, v44
    v_cos_f32 v50, v45
    v_sin_f32 v51, v45
    v_cos_f32 v52, v46
    v_sin_f32 v53, v46
    v_cos_f32 v54, v47
    v_sin_f32 v55, v47
    v_mul_f32 v48, v36, v48
    v_mul_f32 v49, v37, v49
    v_mul_f32 v50, v36, v50
    v_mul_f32 v51, v37, v51
    v_mul_f32 v52, v36, v52
    v_mul_f32 v53, v37, v53
    v_mul_f32 v54, v36, v54
    v_mul_f32 v55, v37, v55
    v_cvt_pk_bf16_f32 v56, v48, v49
    v_cvt_pk_bf16_f32 v57, v50, v51
    v_cvt_pk_bf16_f32 v58, v52, v53
    v_cvt_pk_bf16_f32 v59, v54, v55
    v_add_u32 v42, 32768, v35
    global_store_dwordx4 v42, v[56:59], s[34:35] sc1
    v_add_u32 v40, 32, v34
    v_add_u32 v41, 0, v40
    v_mul_u32_u24 v41, v41, v33
    v_and_b32 v41, 511, v41
    v_cvt_f32_u32 v41, v41
    v_mul_f32 v44, 0x3b000000, v41
    v_add_u32 v41, 1, v40
    v_mul_u32_u24 v41, v41, v33
    v_and_b32 v41, 511, v41
    v_cvt_f32_u32 v41, v41
    v_mul_f32 v45, 0x3b000000, v41
    v_add_u32 v41, 2, v40
    v_mul_u32_u24 v41, v41, v33
    v_and_b32 v41, 511, v41
    v_cvt_f32_u32 v41, v41
    v_mul_f32 v46, 0x3b000000, v41
    v_add_u32 v41, 3, v40
    v_mul_u32_u24 v41, v41, v33
    v_and_b32 v41, 511, v41
    v_cvt_f32_u32 v41, v41
    v_mul_f32 v47, 0x3b000000, v41
    v_cos_f32 v48, v44
    v_sin_f32 v49, v44
    v_cos_f32 v50, v45
    v_sin_f32 v51, v45
    v_cos_f32 v52, v46
    v_sin_f32 v53, v46
    v_cos_f32 v54, v47
    v_sin_f32 v55, v47
    v_mul_f32 v48, v36, v48
    v_mul_f32 v49, v37, v49
    v_mul_f32 v50, v36, v50
    v_mul_f32 v51, v37, v51
    v_mul_f32 v52, v36, v52
    v_mul_f32 v53, v37, v53
    v_mul_f32 v54, v36, v54
    v_mul_f32 v55, v37, v55
    v_cvt_pk_bf16_f32 v60, v48, v49
    v_cvt_pk_bf16_f32 v61, v50, v51
    v_cvt_pk_bf16_f32 v62, v52, v53
    v_cvt_pk_bf16_f32 v63, v54, v55
    v_add_u32 v42, 40960, v35
    global_store_dwordx4 v42, v[60:63], s[34:35] sc1
    v_add_u32 v40, 48, v34
    v_add_u32 v41, 0, v40
    v_mul_u32_u24 v41, v41, v32
    v_and_b32 v41, 511, v41
    v_cvt_f32_u32 v41, v41
    v_mul_f32 v44, 0x3b000000, v41
    v_add_u32 v41, 1, v40
    v_mul_u32_u24 v41, v41, v32
    v_and_b32 v41, 511, v41
    v_cvt_f32_u32 v41, v41
    v_mul_f32 v45, 0x3b000000, v41
    v_add_u32 v41, 2, v40
    v_mul_u32_u24 v41, v41, v32
    v_and_b32 v41, 511, v41
    v_cvt_f32_u32 v41, v41
    v_mul_f32 v46, 0x3b000000, v41
    v_add_u32 v41, 3, v40
    v_mul_u32_u24 v41, v41, v32
    v_and_b32 v41, 511, v41
    v_cvt_f32_u32 v41, v41
    v_mul_f32 v47, 0x3b000000, v41
    v_cos_f32 v48, v44
    v_sin_f32 v49, v44
    v_cos_f32 v50, v45
    v_sin_f32 v51, v45
    v_cos_f32 v52, v46
    v_sin_f32 v53, v46
    v_cos_f32 v54, v47
    v_sin_f32 v55, v47
    v_mul_f32 v48, v36, v48
    v_mul_f32 v49, v37, v49
    v_mul_f32 v50, v36, v50
    v_mul_f32 v51, v37, v51
    v_mul_f32 v52, v36, v52
    v_mul_f32 v53, v37, v53
    v_mul_f32 v54, v36, v54
    v_mul_f32 v55, v37, v55
    v_cmp_eq_u32 vcc, 253, v40
    v_mul_f32 v41, 0x3f3504f3, v54
    s_nop 0
    v_cndmask_b32 v54, v54, v41, vcc
    v_cndmask_b32 v55, v55, v38, vcc
    v_cvt_pk_bf16_f32 v56, v48, v49
    v_cvt_pk_bf16_f32 v57, v50, v51
    v_cvt_pk_bf16_f32 v58, v52, v53
    v_cvt_pk_bf16_f32 v59, v54, v55
    v_add_u32 v42, 49152, v35
    global_store_dwordx4 v42, v[56:59], s[34:35] sc1
    v_add_u32 v40, 48, v34
    v_add_u32 v41, 0, v40
    v_mul_u32_u24 v41, v41, v33
    v_and_b32 v41, 511, v41
    v_cvt_f32_u32 v41, v41
    v_mul_f32 v44, 0x3b000000, v41
    v_add_u32 v41, 1, v40
    v_mul_u32_u24 v41, v41, v33
    v_and_b32 v41, 511, v41
    v_cvt_f32_u32 v41, v41
    v_mul_f32 v45, 0x3b000000, v41
    v_add_u32 v41, 2, v40
    v_mul_u32_u24 v41, v41, v33
    v_and_b32 v41, 511, v41
    v_cvt_f32_u32 v41, v41
    v_mul_f32 v46, 0x3b000000, v41
    v_add_u32 v41, 3, v40
    v_mul_u32_u24 v41, v41, v33
    v_and_b32 v41, 511, v41
    v_cvt_f32_u32 v41, v41
    v_mul_f32 v47, 0x3b000000, v41
    v_cos_f32 v48, v44
    v_sin_f32 v49, v44
    v_cos_f32 v50, v45
    v_sin_f32 v51, v45
    v_cos_f32 v52, v46
    v_sin_f32 v53, v46
    v_cos_f32 v54, v47
    v_sin_f32 v55, v47
    v_mul_f32 v48, v36, v48
    v_mul_f32 v49, v37, v49
    v_mul_f32 v50, v36, v50
    v_mul_f32 v51, v37, v51
    v_mul_f32 v52, v36, v52
    v_mul_f32 v53, v37, v53
    v_mul_f32 v54, v36, v54
    v_mul_f32 v55, v37, v55
    v_cmp_eq_u32 vcc, 253, v40
    v_mul_f32 v41, 0x3f3504f3, v54
    s_nop 0
    v_cndmask_b32 v54, v54, v41, vcc
    v_cndmask_b32 v55, v55, v38, vcc
    v_cvt_pk_bf16_f32 v60, v48, v49
    v_cvt_pk_bf16_f32 v61, v50, v51
    v_cvt_pk_bf16_f32 v62, v52, v53
    v_cvt_pk_bf16_f32 v63, v54, v55
    v_add_u32 v42, 57344, v35
    global_store_dwordx4 v42, v[60:63], s[34:35] sc1
k1_end:
k1_end2:
    s_endpgm
.globl fft0_kernel
.p2align 8
.type fft0_kernel,@function
fft0_kernel:
    s_mov_b32 s60, 0
fft_body:
    s_cmp_ge_u32 s2, 256
    s_cbranch_scc1 fft_end2
    s_load_dwordx16 s[4:19], s[0:1], 0
    s_load_dwordx4 s[20:23], s[0:1], 64
    s_cmp_lt_u32 s2, 8
    s_cbranch_scc0 fft_nopf
    s_getpc_b64 s[62:63]
fft_pc:
    s_add_u32 s62, s62, glu0_kernel-512-fft_pc
    s_addc_u32 s63, s63, 0
    v_lshlrev_b32 v28, 7, v0
    v_min_u32 v28, glu1_kernel+64-(glu0_kernel-512)-4, v28
    global_load_dword v28, v28, s[62:63]
fft_nopf:
    v_lshrrev_b32 v1, 6, v0
    v_and_b32 v2, 63, v0
    v_readfirstlane_b32 s3, v1
    v_bfe_u32 v3, v0, 4, 2
    v_and_b32 v4, 15, v0
    v_lshlrev_b32 v5, 4, v0
    v_lshlrev_b32 v6, 5, v0
    v_lshl_add_u32 v17, v1, 4, v4
    v_lshlrev_b32 v7, 7, v17
    v_lshl_add_u32 v7, v3, 5, v7
    v_and_b32 v18, 1, v3
    v_lshlrev_b32 v18, 3, v18
    v_lshl_add_u32 v8, v4, 4, v18
    v_lshrrev_b32 v18, 1, v3
    v_lshl_add_u32 v8, v18, 8, v8
    v_and_b32 v18, 1, v1
    v_lshl_add_u32 v8, v18, 9, v8
    v_lshrrev_b32 v18, 1, v1
    v_lshl_add_u32 v8, v18, 10, v8
    s_lshl_b32 s32, s2, 13
    v_bfe_i32 v16, v0, 0, 1
    v_and_b32 v16, 0x80008000, v16
    v_cvt_f32_u32 v17, v17
    v_cvt_f32_u32 v19, v3
    v_mul_f32 v18, 0x3c800000, v17
    v_mul_f32 v116, 0x41000000, v19
    v_mul_f32 v116, v116, v18
    v_add_f32 v117, v116, v18
    v_add_f32 v118, v117, v18
    v_add_f32 v119, v118, v18
    v_add_f32 v120, v119, v18
    v_add_f32 v121, v120, v18
    v_add_f32 v122, v121, v18
    v_add_f32 v123, v122, v18
    v_cos_f32 v124, v116
    v_sin_f32 v132, v116
    v_cos_f32 v125, v117
    v_sin_f32 v133, v117
    v_cos_f32 v126, v118
    v_sin_f32 v134, v118
    v_cos_f32 v127, v119
    v_sin_f32 v135, v119
    v_cos_f32 v128, v120
    v_sin_f32 v136, v120
    v_cos_f32 v129, v121
    v_sin_f32 v137, v121
    v_cos_f32 v130, v122
    v_sin_f32 v138, v122
    v_cos_f32 v131, v123
    v_sin_f32 v139, v123
    v_cvt_pk_bf16_f32 v52, v124, v125
    v_cvt_pk_bf16_f32 v56, v132, v133
    v_cvt_pk_bf16_f32 v53, v126, v127
    v_cvt_pk_bf16_f32 v57, v134, v135
    v_cvt_pk_bf16_f32 v54, v128, v129
    v_cvt_pk_bf16_f32 v58, v136, v137
    v_cvt_pk_bf16_f32 v55, v130, v131
    v_cvt_pk_bf16_f32 v59, v138, v139
    v_xor_b32 v60, 0x80008000, v56
    v_xor_b32 v64, v16, v52
    v_xor_b32 v68, v16, v56
    v_xor_b32 v61, 0x80008000, v57
    v_xor_b32 v65, v16, v53
    v_xor_b32 v69, v16, v57
    v_xor_b32 v62, 0x80008000, v58
    v_xor_b32 v66, v16, v54
    v_xor_b32 v70, v16, v58
    v_xor_b32 v63, 0x80008000, v59
    v_xor_b32 v67, v16, v55
    v_xor_b32 v71, v16, v59
    v_xor_b32 v72, v16, v60
    v_xor_b32 v73, v16, v61
    v_xor_b32 v74, v16, v62
    v_xor_b32 v75, v16, v63
    v_mul_f32 v18, 0x3a000000, v17
    v_mul_f32 v116, 0x40800000, v19
    v_mul_f32 v116, v116, v18
    v_add_f32 v117, v116, v18
    v_add_f32 v118, v117, v18
    v_add_f32 v119, v118, v18
    v_mul_f32 v124, 0x41800000, v18
    v_add_f32 v120, v116, v124
    v_add_f32 v121, v120, v18
    v_add_f32 v122, v121, v18
    v_add_f32 v123, v122, v18
    v_cos_f32 v100, v116
    v_sin_f32 v108, v116
    v_cos_f32 v101, v117
    v_sin_f32 v109, v117
    v_cos_f32 v102, v118
    v_sin_f32 v110, v118
    v_cos_f32 v103, v119
    v_sin_f32 v111, v119
    v_cos_f32 v104, v120
    v_sin_f32 v112, v120
    v_cos_f32 v105, v121
    v_sin_f32 v113, v121
    v_cos_f32 v106, v122
    v_sin_f32 v114, v122
    v_cos_f32 v107, v123
    v_sin_f32 v115, v123
    s_waitcnt lgkmcnt(0)
    s_add_u32 s33, s32, 4096
    s_add_u32 s33, s33, s60
    s_add_u32 s24, s22, s33
    s_addc_u32 s25, s23, 0
    s_add_u32 s33, s60, 4194304
    s_add_u32 s28, s22, s33
    s_addc_u32 s29, s23, 0
    global_load_dwordx4 v[28:31], v6, s[28:29]
    global_load_dwordx4 v[32:35], v6, s[28:29] offset:16
    global_load_dwordx4 v[20:23], v5, s[24:25] offset:-4096
    global_load_dwordx4 v[24:27], v5, s[24:25]
    s_add_u32 s33, s32, 20971520
    s_add_u32 s30, s22, s33
    s_addc_u32 s31, s23, 0
    global_load_dwordx4 v[36:39], v7, s[30:31]
    global_load_dwordx4 v[40:43], v7, s[30:31] offset:16
    global_load_dwordx2 v[44:45], v8, s[24:25] offset:-4096
    global_load_dwordx2 v[46:47], v8, s[24:25] offset:-2048
    global_load_dwordx2 v[48:49], v8, s[24:25] offset:0
    global_load_dwordx2 v[50:51], v8, s[24:25] offset:2048
    s_add_u32 s26, s24, 2097152
    s_addc_u32 s27, s25, 0
    v_cvt_f32_u32 v18, v4
    v_mul_f32 v18, 0x3d000000, v18
    v_mul_f32 v116, 0x40800000, v19
    v_mul_f32 v116, v116, v18
    v_add_f32 v117, v116, v18
    v_add_f32 v118, v117, v18
    v_add_f32 v119, v118, v18
    v_cos_f32 v124, v116
    v_sin_f32 v132, v116
    v_cos_f32 v125, v117
    v_sin_f32 v133, v117
    v_cos_f32 v126, v118
    v_sin_f32 v134, v118
    v_cos_f32 v127, v119
    v_sin_f32 v135, v119
    v_cvt_pk_bf16_f32 v76, v124, v125
    v_cvt_pk_bf16_f32 v84, v132, v133
    v_cvt_pk_bf16_f32 v77, v126, v127
    v_cvt_pk_bf16_f32 v85, v134, v135
    v_xor_b32 v78, v16, v76
    v_xor_b32 v86, v16, v84
    v_xor_b32 v79, v16, v77
    v_xor_b32 v87, v16, v85
    v_xor_b32 v80, 0x80000000, v76
    v_xor_b32 v88, 0x80000000, v84
    v_xor_b32 v92, 0x80008000, v84
    v_xor_b32 v81, 0x80000000, v77
    v_xor_b32 v89, 0x80000000, v85
    v_xor_b32 v93, 0x80008000, v85
    v_xor_b32 v82, 0x80000000, v78
    v_xor_b32 v90, 0x80000000, v86
    v_xor_b32 v94, 0x80008000, v86
    v_xor_b32 v83, 0x80000000, v79
    v_xor_b32 v91, 0x80000000, v87
    v_xor_b32 v95, 0x80008000, v87
    v_xor_b32 v96, 0x80000000, v92
    v_xor_b32 v97, 0x80000000, v93
    v_xor_b32 v98, 0x80000000, v94
    v_xor_b32 v99, 0x80000000, v95
    v_lshlrev_b32 v9, 4, v2
    v_lshl_add_u32 v17, v1, 4, v4
    v_bfe_u32 v18, v17, 1, 3
    v_xor_b32 v18, v18, v3
    v_lshlrev_b32 v18, 3, v18
    v_lshl_add_u32 v10, v17, 6, v18
    v_add_u32 v10, 8192, v10
    v_xor_b32 v11, 32, v10
    v_bfe_u32 v17, v0, 2, 2
    v_and_b32 v18, 3, v0
    v_lshl_add_u32 v19, v3, 3, v17
    v_lshlrev_b32 v19, 6, v19
    v_lshrrev_b32 v17, 1, v17
    v_xor_b32 v18, v18, v17
    v_and_b32 v17, 1, v3
    v_lshlrev_b32 v17, 2, v17
    v_xor_b32 v18, v18, v17
    v_lshl_add_u32 v19, v18, 3, v19
    v_add_u32 v12, 8192, v19
    v_xor_b32 v13, 272, v12
    v_xor_b32 v14, 32, v12
    v_xor_b32 v15, 32, v13
    v_mov_b32 v18, 0x46000000
    v_mov_b32 v19, 0x4227c5ac
    s_waitcnt vmcnt(8)
    v_pk_fma_f32 v[228:229], v[28:29], v[18:19], v[18:19] op_sel:[0,0,1] op_sel_hi:[1,0,1]
    v_pk_fma_f32 v[230:231], v[30:31], v[18:19], v[18:19] op_sel:[0,0,1] op_sel_hi:[1,0,1]
    v_pk_fma_f32 v[232:233], v[32:33], v[18:19], v[18:19] op_sel:[0,0,1] op_sel_hi:[1,0,1]
    v_pk_fma_f32 v[234:235], v[34:35], v[18:19], v[18:19] op_sel:[0,0,1] op_sel_hi:[1,0,1]
    v_rsq_f32 v228, v228
    v_rsq_f32 v229, v229
    v_rsq_f32 v230, v230
    v_rsq_f32 v231, v231
    v_rsq_f32 v232, v232
    v_rsq_f32 v233, v233
    v_rsq_f32 v234, v234
    v_rsq_f32 v235, v235
    s_waitcnt vmcnt(6)
    s_cmp_eq_u32 s2, 255
    s_cbranch_scc0 fft_nz
    v_mov_b32 v24, 0
    v_mov_b32 v25, 0
    v_mov_b32 v26, 0
    v_mov_b32 v27, 0
fft_nz:
    v_lshlrev_b32 v116, 16, v20
    v_and_b32 v117, 0xffff0000, v20
    v_lshlrev_b32 v118, 16, v21
    v_and_b32 v119, 0xffff0000, v21
    v_lshlrev_b32 v120, 16, v22
    v_and_b32 v121, 0xffff0000, v22
    v_lshlrev_b32 v122, 16, v23
    v_and_b32 v123, 0xffff0000, v23
    v_pk_mul_f32 v[116:117], v[116:117], v[228:229]
    v_pk_mul_f32 v[118:119], v[118:119], v[230:231]
    v_pk_mul_f32 v[120:121], v[120:121], v[232:233]
    v_pk_mul_f32 v[122:123], v[122:123], v[234:235]
    v_cvt_pk_bf16_f32 v20, v116, v117
    v_cvt_pk_bf16_f32 v21, v118, v119
    v_cvt_pk_bf16_f32 v22, v120, v121
    v_cvt_pk_bf16_f32 v23, v122, v123
    ds_write_b128 v5, v[20:23] offset:0
    v_lshlrev_b32 v124, 16, v24
    v_and_b32 v125, 0xffff0000, v24
    v_lshlrev_b32 v126, 16, v25
    v_and_b32 v127, 0xffff0000, v25
    v_lshlrev_b32 v128, 16, v26
    v_and_b32 v129, 0xffff0000, v26
    v_lshlrev_b32 v130, 16, v27
    v_and_b32 v131, 0xffff0000, v27
    v_pk_mul_f32 v[124:125], v[124:125], v[228:229]
    v_pk_mul_f32 v[126:127], v[126:127], v[230:231]
    v_pk_mul_f32 v[128:129], v[128:129], v[232:233]
    v_pk_mul_f32 v[130:131], v[130:131], v[234:235]
    v_cvt_pk_bf16_f32 v24, v124, v125
    v_cvt_pk_bf16_f32 v25, v126, v127
    v_cvt_pk_bf16_f32 v26, v128, v129
    v_cvt_pk_bf16_f32 v27, v130, v131
    ds_write_b128 v5, v[24:27] offset:4096
    s_waitcnt lgkmcnt(0)
    s_barrier
    ds_read_b128 v[116:119], v9 offset:0
    ds_read_b128 v[120:123], v9 offset:4096
    ds_read_b128 v[124:127], v9 offset:1024
    ds_read_b128 v[128:131], v9 offset:5120
    ds_read_b128 v[132:135], v9 offset:2048
    ds_read_b128 v[136:139], v9 offset:6144
    ds_read_b128 v[140:143], v9 offset:3072
    ds_read_b128 v[144:147], v9 offset:7168
    s_waitcnt lgkmcnt(6)
    v_mfma_f32_16x16x32_bf16 v[148:151], v[116:119], v[52:55], 0
    v_mfma_f32_16x16x32_bf16 v[156:159], v[120:123], v[52:55], 0
    v_mfma_f32_16x16x32_bf16 v[148:151], v[120:123], v[56:59], v[148:151]
    v_mfma_f32_16x16x32_bf16 v[156:159], v[116:119], v[60:63], v[156:159]
    s_waitcnt lgkmcnt(4)
    v_mfma_f32_16x16x32_bf16 v[148:151], v[124:127], v[64:67], v[148:151]
    v_mfma_f32_16x16x32_bf16 v[156:159], v[128:131], v[64:67], v[156:159]
    v_mfma_f32_16x16x32_bf16 v[148:151], v[128:131], v[68:71], v[148:151]
    v_mfma_f32_16x16x32_bf16 v[156:159], v[124:127], v[72:75], v[156:159]
    s_waitcnt lgkmcnt(2)
    v_mfma_f32_16x16x32_bf16 v[152:155], v[132:135], v[52:55], 0
    s_waitcnt vmcnt(4)
    v_lshlrev_b32 v188, 16, v36
    v_mfma_f32_16x16x32_bf16 v[160:163], v[136:139], v[52:55], 0
    v_and_b32 v189, 0xffff0000, v36
    v_lshlrev_b32 v190, 16, v37
    v_mfma_f32_16x16x32_bf16 v[152:155], v[136:139], v[56:59], v[152:155]
    v_and_b32 v191, 0xffff0000, v37
    v_lshlrev_b32 v192, 16, v38
    v_mfma_f32_16x16x32_bf16 v[160:163], v[132:135], v[60:63], v[160:163]
    v_mul_f32 v228, v156, v108
    v_mul_f32 v229, v157, v109
    s_waitcnt lgkmcnt(0)
    v_mfma_f32_16x16x32_bf16 v[152:155], v[140:143], v[64:67], v[152:155]
    v_mul_f32 v230, v148, v108
    v_mul_f32 v231, v149, v109
    v_mfma_f32_16x16x32_bf16 v[160:163], v[144:147], v[64:67], v[160:163]
    v_fma_f32 v232, v148, v100, v228
    v_fma_f32 v233, v149, v101, v229
    v_mfma_f32_16x16x32_bf16 v[152:155], v[144:147], v[68:71], v[152:155]
    v_fma_f32 v234, v156, v100, -v230
    v_fma_f32 v235, v157, v101, -v231
    v_mfma_f32_16x16x32_bf16 v[160:163], v[140:143], v[72:75], v[160:163]
    v_mul_f32 v236, v158, v110
    v_mul_f32 v237, v159, v111
    v_mul_f32 v238, v150, v110
    v_mul_f32 v239, v151, v111
    v_fma_f32 v240, v150, v102, v236
    v_fma_f32 v241, v151, v103, v237
    v_fma_f32 v242, v158, v102, -v238
    v_fma_f32 v243, v159, v103, -v239
    v_cvt_pk_bf16_f32 v164, v232, v233
    v_cvt_pk_bf16_f32 v168, v234, v235
    v_cvt_pk_bf16_f32 v165, v240, v241
    v_cvt_pk_bf16_f32 v169, v242, v243
    v_and_b32 v193, 0xffff0000, v38
    v_lshlrev_b32 v194, 16, v39
    v_and_b32 v195, 0xffff0000, v39
    v_lshlrev_b32 v196, 16, v40
    v_and_b32 v197, 0xffff0000, v40
    v_lshlrev_b32 v198, 16, v41
    v_and_b32 v199, 0xffff0000, v41
    v_lshlrev_b32 v200, 16, v42
    v_pk_mul_f32 v[228:229], v[160:161], v[112:113]
    v_pk_mul_f32 v[230:231], v[152:153], v[112:113]
    v_pk_fma_f32 v[232:233], v[152:153], v[104:105], v[228:229]
    v_pk_fma_f32 v[234:235], v[160:161], v[104:105], v[230:231] neg_lo:[0,0,1] neg_hi:[0,0,1]
    v_pk_mul_f32 v[236:237], v[162:163], v[114:115]
    v_pk_mul_f32 v[238:239], v[154:155], v[114:115]
    v_pk_fma_f32 v[240:241], v[154:155], v[106:107], v[236:237]
    v_pk_fma_f32 v[242:243], v[162:163], v[106:107], v[238:239] neg_lo:[0,0,1] neg_hi:[0,0,1]
    v_cvt_pk_bf16_f32 v166, v232, v233
    v_cvt_pk_bf16_f32 v170, v234, v235
    v_cvt_pk_bf16_f32 v167, v240, v241
    v_cvt_pk_bf16_f32 v171, v242, v243
    s_nop 0
    v_mfma_f32_16x16x32_bf16 v[172:175], v[76:79], v[164:167], 0
    v_and_b32 v201, 0xffff0000, v42
    v_lshlrev_b32 v202, 16, v43
    v_mfma_f32_16x16x32_bf16 v[180:183], v[76:79], v[168:171], 0
    v_and_b32 v203, 0xffff0000, v43
    v_mfma_f32_16x16x32_bf16 v[172:175], v[84:87], v[168:171], v[172:175]
    v_mfma_f32_16x16x32_bf16 v[180:183], v[92:95], v[164:167], v[180:183]
    v_mfma_f32_16x16x32_bf16 v[176:179], v[80:83], v[164:167], 0
    s_waitcnt vmcnt(0)
    v_lshlrev_b32 v212, 16, v44
    v_mfma_f32_16x16x32_bf16 v[184:187], v[80:83], v[168:171], 0
    v_and_b32 v213, 0xffff0000, v44
    v_lshlrev_b32 v214, 16, v45
    v_mfma_f32_16x16x32_bf16 v[176:179], v[88:91], v[168:171], v[176:179]
    v_and_b32 v215, 0xffff0000, v45
    v_lshlrev_b32 v216, 16, v46
    v_mfma_f32_16x16x32_bf16 v[184:187], v[96:99], v[164:167], v[184:187]
    v_and_b32 v217, 0xffff0000, v46
    v_lshlrev_b32 v218, 16, v47
    v_and_b32 v219, 0xffff0000, v47
    v_lshlrev_b32 v220, 16, v48
    v_and_b32 v221, 0xffff0000, v48
    v_lshlrev_b32 v222, 16, v49
    v_and_b32 v223, 0xffff0000, v49
    v_pk_mul_f32 v[228:229], v[180:181], v[196:197]
    v_pk_mul_f32 v[230:231], v[172:173], v[196:197]
    v_pk_fma_f32 v[232:233], v[172:173], v[188:189], v[228:229] neg_lo:[0,0,1] neg_hi:[0,0,1]
    v_pk_fma_f32 v[234:235], v[180:181], v[188:189], v[230:231]
    v_pk_mul_f32 v[236:237], v[182:183], v[198:199]
    v_pk_mul_f32 v[238:239], v[174:175], v[198:199]
    v_pk_fma_f32 v[240:241], v[174:175], v[190:191], v[236:237] neg_lo:[0,0,1] neg_hi:[0,0,1]
    v_pk_fma_f32 v[242:243], v[182:183], v[190:191], v[238:239]
    v_cvt_pk_bf16_f32 v204, v232, v233
    v_cvt_pk_bf16_f32 v208, v234, v235
    v_cvt_pk_bf16_f32 v205, v240, v241
    v_cvt_pk_bf16_f32 v209, v242, v243
    v_pk_mul_f32 v[228:229], v[184:185], v[200:201]
    v_pk_mul_f32 v[230:231], v[176:177], v[200:201]
    v_pk_fma_f32 v[232:233], v[176:177], v[192:193], v[228:229] neg_lo:[0,0,1] neg_hi:[0,0,1]
    v_pk_fma_f32 v[234:235], v[184:185], v[192:193], v[230:231]
    v_pk_mul_f32 v[236:237], v[186:187], v[202:203]
    v_pk_mul_f32 v[238:239], v[178:179], v[202:203]
    v_pk_fma_f32 v[240:241], v[178:179], v[194:195], v[236:237] neg_lo:[0,0,1] neg_hi:[0,0,1]
    v_pk_fma_f32 v[242:243], v[186:187], v[194:195], v[238:239]
    v_cvt_pk_bf16_f32 v206, v232, v233
    v_cvt_pk_bf16_f32 v210, v234, v235
    v_cvt_pk_bf16_f32 v207, v240, v241
    v_cvt_pk_bf16_f32 v211, v242, v243
    s_nop 0
    v_mfma_f32_16x16x32_bf16 v[148:151], v[76:79], v[204:207], 0
    v_mfma_f32_16x16x32_bf16 v[156:159], v[76:79], v[208:211], 0
    v_mfma_f32_16x16x32_bf16 v[148:151], v[92:95], v[208:211], v[148:151]
    v_mfma_f32_16x16x32_bf16 v[156:159], v[84:87], v[204:207], v[156:159]
    v_mfma_f32_16x16x32_bf16 v[152:155], v[80:83], v[204:207], 0
    v_lshlrev_b32 v224, 16, v50
    v_and_b32 v225, 0xffff0000, v50
    v_mfma_f32_16x16x32_bf16 v[160:163], v[80:83], v[208:211], 0
    v_lshlrev_b32 v226, 16, v51
    v_and_b32 v227, 0xffff0000, v51
    v_mfma_f32_16x16x32_bf16 v[152:155], v[96:99], v[208:211], v[152:155]
    v_mfma_f32_16x16x32_bf16 v[160:163], v[88:91], v[204:207], v[160:163]
    v_mul_f32 v228, v156, v108
    v_mul_f32 v229, v157, v109
    v_mul_f32 v230, v148, v108
    v_mul_f32 v231, v149, v109
    v_fma_f32 v232, v148, v100, -v228
    v_fma_f32 v233, v149, v101, -v229
    v_fma_f32 v234, v156, v100, v230
    v_fma_f32 v235, v157, v101, v231
    v_mul_f32 v236, v158, v110
    v_mul_f32 v237, v159, v111
    v_mul_f32 v238, v150, v110
    v_mul_f32 v239, v151, v111
    v_fma_f32 v240, v150, v102, -v236
    v_fma_f32 v241, v151, v103, -v237
    v_fma_f32 v242, v158, v102, v238
    v_fma_f32 v243, v159, v103, v239
    v_cvt_pk_bf16_f32 v164, v232, v233
    v_cvt_pk_bf16_f32 v168, v234, v235
    v_cvt_pk_bf16_f32 v165, v240, v241
    v_cvt_pk_bf16_f32 v169, v242, v243
    ds_write_b64 v10, v[164:165]
    ds_write_b64 v10, v[168:169] offset:4096
    v_pk_mul_f32 v[228:229], v[160:161], v[112:113]
    v_pk_mul_f32 v[230:231], v[152:153], v[112:113]
    v_pk_fma_f32 v[232:233], v[152:153], v[104:105], v[228:229] neg_lo:[0,0,1] neg_hi:[0,0,1]
    v_pk_fma_f32 v[234:235], v[160:161], v[104:105], v[230:231]
    v_pk_mul_f32 v[236:237], v[162:163], v[114:115]
    v_pk_mul_f32 v[238:239], v[154:155], v[114:115]
    v_pk_fma_f32 v[240:241], v[154:155], v[106:107], v[236:237] neg_lo:[0,0,1] neg_hi:[0,0,1]
    v_pk_fma_f32 v[242:243], v[162:163], v[106:107], v[238:239]
    v_cvt_pk_bf16_f32 v166, v232, v233
    v_cvt_pk_bf16_f32 v170, v234, v235
    v_cvt_pk_bf16_f32 v167, v240, v241
    v_cvt_pk_bf16_f32 v171, v242, v243
    ds_write_b64 v11, v[166:167]
    ds_write_b64 v11, v[170:171] offset:4096
    s_waitcnt lgkmcnt(0)
    s_barrier
    ds_read_b64_tr_b16 v[116:117], v12 offset:0
    ds_read_b64_tr_b16 v[118:119], v13 offset:0
    ds_read_b64_tr_b16 v[120:121], v12 offset:4096
    ds_read_b64_tr_b16 v[122:123], v13 offset:4096
    ds_read_b64_tr_b16 v[124:125], v12 offset:2048
    ds_read_b64_tr_b16 v[126:127], v13 offset:2048
    ds_read_b64_tr_b16 v[128:129], v12 offset:6144
    ds_read_b64_tr_b16 v[130:131], v13 offset:6144
    ds_read_b64_tr_b16 v[132:133], v14 offset:0
    ds_read_b64_tr_b16 v[134:135], v15 offset:0
    ds_read_b64_tr_b16 v[136:137], v14 offset:4096
    ds_read_b64_tr_b16 v[138:139], v15 offset:4096
    s_cmp_eq_u32 s2, 255
    s_cbranch_scc1 fft_last
    s_waitcnt lgkmcnt(8)
    v_mfma_f32_16x16x32_bf16 v[212:215], v[52:55], v[116:119], v[212:215]
    ds_read_b64_tr_b16 v[140:141], v14 offset:2048
    v_mfma_f32_16x16x32_bf16 v[212:215], v[60:63], v[120:123], v[212:215]
    ds_read_b64_tr_b16 v[142:143], v15 offset:2048
    v_mfma_f32_16x16x32_bf16 v[220:223], v[52:55], v[120:123], v[220:223]
    ds_read_b64_tr_b16 v[144:145], v14 offset:6144
    v_mfma_f32_16x16x32_bf16 v[220:223], v[56:59], v[116:119], v[220:223]
    ds_read_b64_tr_b16 v[146:147], v15 offset:6144
    s_waitcnt lgkmcnt(8)
    v_mfma_f32_16x16x32_bf16 v[212:215], v[64:67], v[124:127], v[212:215]
    v_mfma_f32_16x16x32_bf16 v[212:215], v[72:75], v[128:131], v[212:215]
    v_mfma_f32_16x16x32_bf16 v[220:223], v[64:67], v[128:131], v[220:223]
    v_mfma_f32_16x16x32_bf16 v[220:223], v[68:71], v[124:127], v[220:223]
    s_waitcnt lgkmcnt(4)
    v_mfma_f32_16x16x32_bf16 v[216:219], v[52:55], v[132:135], v[216:219]
    v_mfma_f32_16x16x32_bf16 v[216:219], v[60:63], v[136:139], v[216:219]
    v_mfma_f32_16x16x32_bf16 v[224:227], v[52:55], v[136:139], v[224:227]
    v_mfma_f32_16x16x32_bf16 v[224:227], v[56:59], v[132:135], v[224:227]
    s_waitcnt lgkmcnt(0)
    v_mfma_f32_16x16x32_bf16 v[216:219], v[64:67], v[140:143], v[216:219]
    v_mfma_f32_16x16x32_bf16 v[216:219], v[72:75], v[144:147], v[216:219]
    v_mfma_f32_16x16x32_bf16 v[224:227], v[64:67], v[144:147], v[224:227]
    v_mfma_f32_16x16x32_bf16 v[224:227], v[68:71], v[140:143], v[224:227]
    s_branch fft_out
fft_last:
    s_waitcnt lgkmcnt(8)
    ds_read_b64_tr_b16 v[140:141], v14 offset:2048
    ds_read_b64_tr_b16 v[142:143], v15 offset:2048
    ds_read_b64_tr_b16 v[144:145], v14 offset:6144
    ds_read_b64_tr_b16 v[146:147], v15 offset:6144
    s_waitcnt lgkmcnt(0)
    v_mfma_f32_16x16x32_bf16 v[212:215], v[52:55], v[116:119], v[212:215]
    v_mfma_f32_16x16x32_bf16 v[212:215], v[60:63], v[120:123], v[212:215]
    v_mfma_f32_16x16x32_bf16 v[212:215], v[64:67], v[124:127], v[212:215]
    v_mfma_f32_16x16x32_bf16 v[212:215], v[72:75], v[128:131], v[212:215]
    v_mfma_f32_16x16x32_bf16 v[216:219], v[52:55], v[132:135], v[216:219]
    v_mfma_f32_16x16x32_bf16 v[216:219], v[60:63], v[136:139], v[216:219]
    v_mfma_f32_16x16x32_bf16 v[216:219], v[64:67], v[140:143], v[216:219]
    v_mfma_f32_16x16x32_bf16 v[216:219], v[72:75], v[144:147], v[216:219]
fft_out:
    v_and_b32 v18, 1, v3
    v_mul_u32_u24 v18, 2040, v18
    v_add_u32 v17, v18, v8
    s_nop 0
    v_cvt_pk_bf16_f32 v228, v212, v213
    v_cvt_pk_bf16_f32 v229, v214, v215
    s_nop 1
    v_cvt_pk_bf16_f32 v230, v216, v217
    v_cvt_pk_bf16_f32 v231, v218, v219
    s_nop 0
    v_permlane16_swap_b32 v228, v230
    v_permlane16_swap_b32 v229, v231
    global_store_dwordx4 v17, v[228:231], s[26:27] offset:-4096 sc1
    v_cvt_pk_bf16_f32 v232, v220, v221
    v_cvt_pk_bf16_f32 v233, v222, v223
    v_cvt_pk_bf16_f32 v234, v224, v225
    v_cvt_pk_bf16_f32 v235, v226, v227
    s_nop 0
    v_permlane16_swap_b32 v232, v234
    v_permlane16_swap_b32 v233, v235
    global_store_dwordx4 v17, v[232:235], s[26:27] offset:0 sc1
fft_end:
fft_end2:
    s_endpgm
.globl fft1_kernel
.p2align 8
.type fft1_kernel,@function
fft1_kernel:
    s_mov_b32 s60, 25165824
    s_branch fft_body
.globl glu0_kernel
.p2align 8
.type glu0_kernel,@function
glu0_kernel:
    s_mov_b32 s60, 0
glu_body:
    s_cmp_ge_u32 s2, 256
    s_cbranch_scc1 glu_end2
    s_load_dwordx16 s[4:19], s[0:1], 0
    s_load_dwordx4 s[20:23], s[0:1], 64
    s_cmp_lt_u32 s2, 8
    s_cbranch_scc0 glu_nopf
    s_getpc_b64 s[62:63]
glu_pc:
    s_add_u32 s62, s62, down0_kernel-512-glu_pc
    s_addc_u32 s63, s63, 0
    v_lshlrev_b32 v18, 7, v0
    v_min_u32 v18, text_end-(down0_kernel-512)-4, v18
    global_load_dword v18, v18, s[62:63]
glu_nopf:
    v_lshrrev_b32 v1, 6, v0
    v_and_b32 v2, 63, v0
    v_readfirstlane_b32 s3, v1
    v_bfe_u32 v3, v0, 4, 2
    v_and_b32 v4, 15, v0
    s_and_b32 s37, s2, 1
    s_lshl_b32 s37, s37, 3
    s_bfe_u32 s38, s2, 0x30003
    s_add_u32 s26, s37, s38
    s_bfe_u32 s37, s2, 0x20001
    s_lshl_b32 s37, s37, 2
    s_lshr_b32 s38, s2, 6
    s_add_u32 s27, s37, s38
    s_lshr_b32 s24, s3, 2
    s_and_b32 s25, s3, 3
    s_bfe_u32 s37, s3, 0x10001
    s_lshl_b32 s37, s37, 2
    v_or_b32 v14, s37, v3
    v_lshlrev_b32 v14, 1, v14
    v_xor_b32 v14, v14, v4
    v_lshlrev_b32 v14, 4, v14
    s_lshl_b32 s37, s3, 2
    v_add_u32 v15, s37, v3
    v_lshl_add_u32 v5, v15, 12, v14
    v_lshlrev_b32 v6, 4, v2
    s_lshl_b32 s34, s3, 10
    s_lshr_b32 s37, s3, 1
    s_lshl_b32 s37, s37, 2
    s_and_b32 s38, s3, 1
    s_add_u32 s39, s37, s38
    s_lshl_b32 s39, s39, 10
    s_add_u32 s35, s39, 32768
    s_add_u32 s36, s34, 98304
    s_mul_i32 s61, s60, 25165824
    s_lshl_b32 s37, s26, 8
    s_add_u32 s37, s37, 2097152
    s_add_u32 s37, s37, s61
    s_lshl_b32 s38, s27, 18
    s_add_u32 s38, s38, 5242880
    s_add_u32 s38, s38, s39
    s_lshr_b32 s46, s2, 3
    s_lshl_b32 s46, s46, 3
    s_add_u32 s46, s46, s3
    s_mul_i32 s46, s46, 7168
    s_lshl_b32 s39, s60, 21
    s_add_u32 s46, s46, s39
    s_add_u32 s46, s46, 16781312
    v_and_b32 v17, 3, v2
    v_lshl_add_u32 v17, v17, 7, s46
    s_lshr_b32 s39, s27, 1
    s_cmp_eq_u32 s39, 7
    s_cselect_b32 s39, 1, 0
    s_cmp_gt_u32 s39, s60
    s_waitcnt lgkmcnt(0)
    s_cbranch_scc1 glu_skip
    s_add_u32 s28, s22, s37
    s_addc_u32 s29, s23, 0
    s_add_u32 s30, s22, s38
    s_addc_u32 s31, s23, 0
    s_add_u32 s32, s30, 2048
    s_addc_u32 s33, s31, 0
    s_add_u32 s54, s30, 198656
    s_addc_u32 s55, s31, 0
    s_add_u32 m0, s34, 0
    s_nop 0
    global_load_lds_dwordx4 v5, s[28:29]
    s_add_u32 s28, s28, 131072
    s_addc_u32 s29, s29, 0
    s_add_u32 m0, s35, 0
    s_nop 0
    global_load_lds_dwordx4 v6, s[30:31]
    s_add_u32 s30, s30, 16384
    s_addc_u32 s31, s31, 0
    s_add_u32 m0, s34, 8192
    s_nop 0
    global_load_lds_dwordx4 v5, s[28:29]
    s_add_u32 s28, s28, 131072
    s_addc_u32 s29, s29, 0
    s_add_u32 m0, s35, 16384
    s_nop 0
    global_load_lds_dwordx4 v6, s[30:31]
    s_add_u32 s30, s30, 16384
    s_addc_u32 s31, s31, 0
    s_add_u32 m0, s34, 16384
    s_nop 0
    global_load_lds_dwordx4 v5, s[28:29]
    s_add_u32 s28, s28, 131072
    s_addc_u32 s29, s29, 0
    s_add_u32 m0, s35, 32768
    s_nop 0
    global_load_lds_dwordx4 v6, s[30:31]
    s_add_u32 s30, s30, 16384
    s_addc_u32 s31, s31, 0
    s_lshl_b32 s37, s25, 12
    s_add_u32 s37, s37, 32768
    v_add_u32 v7, s37, v6
    s_lshl_b32 s37, s25, 11
    s_add_u32 s37, s37, 98304
    v_add_u32 v16, s37, v6
    v_bfe_u32 v14, v0, 2, 2
    v_lshl_add_u32 v15, v3, 3, v14
    v_lshlrev_b32 v15, 8, v15
    v_and_b32 v19, 1, v3
    v_lshl_add_u32 v14, v19, 2, v14
    s_lshl_b32 s37, s24, 2
    s_add_u32 s37, s37, s25
    v_xor_b32 v14, s37, v14
    v_lshl_add_u32 v15, v14, 5, v15
    v_and_b32 v14, 3, v0
    v_lshl_add_u32 v8, v14, 3, v15
    v_xor_b32 v9, 32, v8
    v_xor_b32 v10, 64, v8
    v_xor_b32 v11, 96, v8
    v_and_b32 v14, 3, v4
    v_cmp_eq_u32 s[48:49], 1, v14
    v_cmp_eq_u32 s[50:51], 2, v14
    v_cmp_eq_u32 s[52:53], 3, v14
    s_lshl_b32 s37, s3, 6
    s_add_u32 s37, s37, 131072
    v_lshl_add_u32 v15, v4, 2, s37
    v_lshlrev_b32 v19, 2, v2
    v_add_u32 v19, 131584, v19
    v_lshrrev_b32 v14, 2, v4
    v_cmp_eq_u32 vcc, v14, v3
    s_nop 1
    v_cndmask_b32 v12, v19, v15, vcc
    v_mov_b32 v19, v15
    s_cmp_ge_u32 s27, 14
    s_cselect_b32 s37, -1, 0xffff
    v_mov_b32 v14, s37
    v_cmp_eq_u32 vcc, 3, v3
    s_nop 1
    v_cndmask_b32 v13, -1, v14, vcc
    s_lshl_b32 s37, s26, 3
    s_lshl_b32 s38, s24, 2
    s_add_u32 s37, s37, s38
    s_add_u32 s37, s37, s25
    s_lshl_b32 s38, s27, 2
    s_add_u32 s38, s38, s25
    s_lshl_b32 s38, s38, 10
    s_add_u32 s38, s38, 9437184
    s_add_u32 s38, s38, s61
    s_xor_b32 s40, s37, 0
    s_mul_i32 s40, s40, 57344
    s_add_u32 s40, s40, s38
    s_xor_b32 s41, s37, 1
    s_mul_i32 s41, s41, 57344
    s_add_u32 s41, s41, s38
    s_xor_b32 s42, s37, 2
    s_mul_i32 s42, s42, 57344
    s_add_u32 s42, s42, s38
    s_xor_b32 s43, s37, 3
    s_mul_i32 s43, s43, 57344
    s_add_u32 s43, s43, s38
    s_waitcnt vmcnt(4)
    s_barrier
    ds_read_b64_tr_b16 v[160:161], v8 offset:0
    ds_read_b64_tr_b16 v[162:163], v8 offset:1024
    ds_read_b128 v[32:35], v7 offset:0
    ds_read_b128 v[36:39], v7 offset:1024
    ds_read_b64_tr_b16 v[164:165], v9 offset:0
    ds_read_b64_tr_b16 v[166:167], v9 offset:1024
    ds_read_b64_tr_b16 v[168:169], v10 offset:0
    ds_read_b64_tr_b16 v[170:171], v10 offset:1024
    ds_read_b64_tr_b16 v[172:173], v11 offset:0
    ds_read_b64_tr_b16 v[174:175], v11 offset:1024
    s_waitcnt lgkmcnt(0)
    v_mfma_f32_16x16x32_bf16 v[128:131], v[160:163], v[160:163], 0
    v_mfma_f32_16x16x32_bf16 v[64:67], v[32:35], v[160:163], 0
    v_mfma_f32_16x16x32_bf16 v[80:83], v[36:39], v[160:163], 0
    s_waitcnt vmcnt(2)
    s_barrier
    v_mfma_f32_16x16x32_bf16 v[68:71], v[32:35], v[164:167], 0
    ds_read_b64_tr_b16 v[176:177], v8 offset:8192
    ds_read_b64_tr_b16 v[178:179], v8 offset:9216
    s_add_u32 m0, s34, 24576
    v_mfma_f32_16x16x32_bf16 v[84:87], v[36:39], v[164:167], 0
    ds_read_b128 v[48:51], v7 offset:16384
    ds_read_b128 v[52:55], v7 offset:17408
    global_load_lds_dwordx4 v5, s[28:29]
    s_add_u32 s28, s28, 131072
    s_addc_u32 s29, s29, 0
    v_mfma_f32_16x16x32_bf16 v[72:75], v[32:35], v[168:171], 0
    ds_read_b64_tr_b16 v[180:181], v9 offset:8192
    s_add_u32 m0, s35, 49152
    v_mfma_f32_16x16x32_bf16 v[88:91], v[36:39], v[168:171], 0
    ds_read_b64_tr_b16 v[182:183], v9 offset:9216
    ds_read_b64_tr_b16 v[184:185], v10 offset:8192
    global_load_lds_dwordx4 v6, s[30:31]
    s_add_u32 s30, s30, 16384
    s_addc_u32 s31, s31, 0
    v_mfma_f32_16x16x32_bf16 v[76:79], v[32:35], v[172:175], 0
    ds_read_b64_tr_b16 v[186:187], v10 offset:9216
    ds_read_b64_tr_b16 v[188:189], v11 offset:8192
    s_add_u32 m0, s34, 0
    v_mfma_f32_16x16x32_bf16 v[92:95], v[36:39], v[172:175], 0
    ds_read_b64_tr_b16 v[190:191], v11 offset:9216
    global_load_lds_dwordx4 v5, s[28:29]
    s_add_u32 s28, s28, 131072
    s_addc_u32 s29, s29, 0
    s_waitcnt lgkmcnt(0)
    v_mfma_f32_16x16x32_bf16 v[128:131], v[176:179], v[176:179], v[128:131]
    v_mfma_f32_16x16x32_bf16 v[64:67], v[48:51], v[176:179], v[64:67]
    v_mfma_f32_16x16x32_bf16 v[80:83], v[52:55], v[176:179], v[80:83]
    s_waitcnt vmcnt(3)
    s_barrier
    s_add_u32 m0, s35, 0
    v_mfma_f32_16x16x32_bf16 v[68:71], v[48:51], v[180:183], v[68:71]
    ds_read_b64_tr_b16 v[192:193], v8 offset:16384
    ds_read_b64_tr_b16 v[194:195], v8 offset:17408
    global_load_lds_dwordx4 v6, s[30:31]
    s_add_u32 s30, s30, 16384
    s_addc_u32 s31, s31, 0
    v_mfma_f32_16x16x32_bf16 v[84:87], v[52:55], v[180:183], v[84:87]
    ds_read_b128 v[32:35], v7 offset:32768
    ds_read_b128 v[36:39], v7 offset:33792
    s_add_u32 m0, s35, 2048
    v_mfma_f32_16x16x32_bf16 v[72:75], v[48:51], v[184:187], v[72:75]
    ds_read_b64_tr_b16 v[196:197], v9 offset:16384
    global_load_lds_dwordx4 v6, s[32:33]
    s_add_u32 s32, s32, 16384
    s_addc_u32 s33, s33, 0
    s_add_u32 m0, s34, 8192
    v_mfma_f32_16x16x32_bf16 v[88:91], v[52:55], v[184:187], v[88:91]
    ds_read_b64_tr_b16 v[198:199], v9 offset:17408
    ds_read_b64_tr_b16 v[200:201], v10 offset:16384
    global_load_lds_dwordx4 v5, s[28:29]
    s_add_u32 s28, s28, 131072
    s_addc_u32 s29, s29, 0
    v_mfma_f32_16x16x32_bf16 v[76:79], v[48:51], v[188:191], v[76:79]
    ds_read_b64_tr_b16 v[202:203], v10 offset:17408
    ds_read_b64_tr_b16 v[204:205], v11 offset:16384
    v_mfma_f32_16x16x32_bf16 v[92:95], v[52:55], v[188:191], v[92:95]
    ds_read_b64_tr_b16 v[206:207], v11 offset:17408
    s_mov_b64 exec, 15
    global_load_dword v18, v17, s[22:23] offset:-4096
    s_mov_b64 exec, -1
    s_waitcnt lgkmcnt(0)
    v_mfma_f32_16x16x32_bf16 v[128:131], v[192:195], v[192:195], v[128:131]
    v_mfma_f32_16x16x32_bf16 v[64:67], v[32:35], v[192:195], v[64:67]
    v_mfma_f32_16x16x32_bf16 v[80:83], v[36:39], v[192:195], v[80:83]
    s_waitcnt vmcnt(5)
    s_barrier
    s_add_u32 m0, s35, 16384
    v_mfma_f32_16x16x32_bf16 v[68:71], v[32:35], v[196:199], v[68:71]
    ds_read_b64_tr_b16 v[208:209], v8 offset:24576
    ds_read_b64_tr_b16 v[210:211], v8 offset:25600
    global_load_lds_dwordx4 v6, s[30:31]
    s_add_u32 s30, s30, 16384
    s_addc_u32 s31, s31, 0
    v_mfma_f32_16x16x32_bf16 v[84:87], v[36:39], v[196:199], v[84:87]
    ds_read_b128 v[48:51], v7 offset:49152
    ds_read_b128 v[52:55], v7 offset:50176
    s_add_u32 m0, s35, 18432
    v_mfma_f32_16x16x32_bf16 v[72:75], v[32:35], v[200:203], v[72:75]
    ds_read_b64_tr_b16 v[212:213], v9 offset:24576
    global_load_lds_dwordx4 v6, s[32:33]
    s_add_u32 s32, s32, 16384
    s_addc_u32 s33, s33, 0
    s_add_u32 m0, s34, 16384
    v_mfma_f32_16x16x32_bf16 v[88:91], v[36:39], v[200:203], v[88:91]
    ds_read_b64_tr_b16 v[214:215], v9 offset:25600
    ds_read_b64_tr_b16 v[216:217], v10 offset:24576
    global_load_lds_dwordx4 v5, s[28:29]
    s_add_u32 s28, s28, 131072
    s_addc_u32 s29, s29, 0
    v_mfma_f32_16x16x32_bf16 v[76:79], v[32:35], v[204:207], v[76:79]
    ds_read_b64_tr_b16 v[218:219], v10 offset:25600
    ds_read_b64_tr_b16 v[220:221], v11 offset:24576
    v_mfma_f32_16x16x32_bf16 v[92:95], v[36:39], v[204:207], v[92:95]
    ds_read_b64_tr_b16 v[222:223], v11 offset:25600
    s_mov_b64 exec, 15
    global_load_dword v18, v17, s[22:23] offset:-3584
    s_mov_b64 exec, -1
    s_waitcnt lgkmcnt(0)
    v_mfma_f32_16x16x32_bf16 v[128:131], v[208:211], v[208:211], v[128:131]
    v_mfma_f32_16x16x32_bf16 v[64:67], v[48:51], v[208:211], v[64:67]
    v_mfma_f32_16x16x32_bf16 v[80:83], v[52:55], v[208:211], v[80:83]
    s_waitcnt vmcnt(6)
    s_barrier
    s_add_u32 m0, s35, 32768
    v_mfma_f32_16x16x32_bf16 v[68:71], v[48:51], v[212:215], v[68:71]
    ds_read_b64_tr_b16 v[224:225], v8 offset:0
    ds_read_b64_tr_b16 v[226:227], v8 offset:1024
    global_load_lds_dwordx4 v6, s[30:31]
    s_add_u32 s30, s30, 16384
    s_addc_u32 s31, s31, 0
    v_mfma_f32_16x16x32_bf16 v[84:87], v[52:55], v[212:215], v[84:87]
    ds_read_b128 v[32:35], v7 offset:0
    ds_read_b128 v[36:39], v7 offset:1024
    s_add_u32 m0, s35, 34816
    v_mfma_f32_16x16x32_bf16 v[72:75], v[48:51], v[216:219], v[72:75]
    ds_read_b128 v[40:43], v7 offset:2048
    ds_read_b128 v[44:47], v7 offset:3072
    global_load_lds_dwordx4 v6, s[32:33]
    s_add_u32 s32, s32, 16384
    s_addc_u32 s33, s33, 0
    s_add_u32 m0, s34, 24576
    v_mfma_f32_16x16x32_bf16 v[88:91], v[52:55], v[216:219], v[88:91]
    ds_read_b64_tr_b16 v[228:229], v9 offset:0
    ds_read_b64_tr_b16 v[230:231], v9 offset:1024
    global_load_lds_dwordx4 v5, s[28:29]
    s_add_u32 s28, s28, 131072
    s_addc_u32 s29, s29, 0
    v_mfma_f32_16x16x32_bf16 v[76:79], v[48:51], v[220:223], v[76:79]
    ds_read_b64_tr_b16 v[232:233], v10 offset:0
    ds_read_b64_tr_b16 v[234:235], v10 offset:1024
    v_mfma_f32_16x16x32_bf16 v[92:95], v[52:55], v[220:223], v[92:95]
    ds_read_b64_tr_b16 v[236:237], v11 offset:0
    ds_read_b64_tr_b16 v[238:239], v11 offset:1024
    s_mov_b64 exec, 15
    global_load_dword v18, v17, s[22:23] offset:-3072
    s_mov_b64 exec, -1
    s_waitcnt lgkmcnt(0)
    v_mfma_f32_16x16x32_bf16 v[128:131], v[224:227], v[224:227], v[128:131]
    v_mfma_f32_16x16x32_bf16 v[64:67], v[32:35], v[224:227], v[64:67]
    v_mfma_f32_16x16x32_bf16 v[80:83], v[36:39], v[224:227], v[80:83]
    s_waitcnt vmcnt(6)
    s_barrier
    v_mfma_f32_16x16x32_bf16 v[96:99], v[40:43], v[160:163], 0
    ds_read_b64_tr_b16 v[240:241], v8 offset:8192
    s_add_u32 m0, s35, 49152
    v_mfma_f32_16x16x32_bf16 v[112:115], v[44:47], v[160:163], 0
    ds_read_b64_tr_b16 v[242:243], v8 offset:9216
    global_load_lds_dwordx4 v6, s[30:31]
    s_add_u32 s30, s30, 16384
    s_addc_u32 s31, s31, 0
    v_mfma_f32_16x16x32_bf16 v[68:71], v[32:35], v[228:231], v[68:71]
    ds_read_b128 v[48:51], v7 offset:16384
    v_mfma_f32_16x16x32_bf16 v[84:87], v[36:39], v[228:231], v[84:87]
    ds_read_b128 v[52:55], v7 offset:17408
    s_add_u32 m0, s35, 51200
    v_mfma_f32_16x16x32_bf16 v[100:103], v[40:43], v[164:167], 0
    ds_read_b128 v[56:59], v7 offset:18432
    global_load_lds_dwordx4 v6, s[32:33]
    s_add_u32 s32, s32, 16384
    s_addc_u32 s33, s33, 0
    v_mfma_f32_16x16x32_bf16 v[116:119], v[44:47], v[164:167], 0
    ds_read_b128 v[60:63], v7 offset:19456
    v_mfma_f32_16x16x32_bf16 v[72:75], v[32:35], v[232:235], v[72:75]
    s_add_u32 m0, s34, 0
    v_mfma_f32_16x16x32_bf16 v[88:91], v[36:39], v[232:235], v[88:91]
    ds_read_b64_tr_b16 v[244:245], v9 offset:8192
    global_load_lds_dwordx4 v5, s[28:29]
    s_add_u32 s28, s28, 131072
    s_addc_u32 s29, s29, 0
    v_mfma_f32_16x16x32_bf16 v[104:107], v[40:43], v[168:171], 0
    ds_read_b64_tr_b16 v[246:247], v9 offset:9216
    s_add_u32 m0, s35, 0
    v_mfma_f32_16x16x32_bf16 v[120:123], v[44:47], v[168:171], 0
    ds_read_b64_tr_b16 v[248:249], v10 offset:8192
    global_load_lds_dwordx4 v6, s[30:31]
    s_add_u32 s30, s30, 16384
    s_addc_u32 s31, s31, 0
    v_mfma_f32_16x16x32_bf16 v[76:79], v[32:35], v[236:239], v[76:79]
    ds_read_b64_tr_b16 v[250:251], v10 offset:9216
    v_mfma_f32_16x16x32_bf16 v[92:95], v[36:39], v[236:239], v[92:95]
    ds_read_b64_tr_b16 v[252:253], v11 offset:8192
    v_mfma_f32_16x16x32_bf16 v[108:111], v[40:43], v[172:175], 0
    ds_read_b64_tr_b16 v[254:255], v11 offset:9216
    s_mov_b64 exec, 15
    global_load_dword v18, v17, s[22:23] offset:-2560
    s_mov_b64 exec, -1
    v_mfma_f32_16x16x32_bf16 v[124:127], v[44:47], v[172:175], 0
    s_waitcnt lgkmcnt(0)
    v_mfma_f32_16x16x32_bf16 v[128:131], v[240:243], v[240:243], v[128:131]
    v_mfma_f32_16x16x32_bf16 v[64:67], v[48:51], v[240:243], v[64:67]
    v_mfma_f32_16x16x32_bf16 v[80:83], v[52:55], v[240:243], v[80:83]
    s_waitcnt vmcnt(7)
    s_barrier
    v_mfma_f32_16x16x32_bf16 v[96:99], v[56:59], v[176:179], v[96:99]
    ds_read_b64_tr_b16 v[160:161], v8 offset:16384
    s_add_u32 m0, s35, 2048
    v_mfma_f32_16x16x32_bf16 v[112:115], v[60:63], v[176:179], v[112:115]
    ds_read_b64_tr_b16 v[162:163], v8 offset:17408
    global_load_lds_dwordx4 v6, s[32:33]
    s_add_u32 s32, s32, 16384
    s_addc_u32 s33, s33, 0
    v_mfma_f32_16x16x32_bf16 v[68:71], v[48:51], v[244:247], v[68:71]
    ds_read_b128 v[32:35], v7 offset:32768
    v_mfma_f32_16x16x32_bf16 v[84:87], v[52:55], v[244:247], v[84:87]
    ds_read_b128 v[36:39], v7 offset:33792
    s_add_u32 m0, s34, 8192
    v_mfma_f32_16x16x32_bf16 v[100:103], v[56:59], v[180:183], v[100:103]
    ds_read_b128 v[40:43], v7 offset:34816
    global_load_lds_dwordx4 v5, s[28:29]
    s_add_u32 s28, s28, 131072
    s_addc_u32 s29, s29, 0
    v_mfma_f32_16x16x32_bf16 v[116:119], v[60:63], v[180:183], v[116:119]
    ds_read_b128 v[44:47], v7 offset:35840
    v_mfma_f32_16x16x32_bf16 v[72:75], v[48:51], v[248:251], v[72:75]
    s_add_u32 m0, s35, 16384
    v_mfma_f32_16x16x32_bf16 v[88:91], v[52:55], v[248:251], v[88:91]
    ds_read_b64_tr_b16 v[164:165], v9 offset:16384
    global_load_lds_dwordx4 v6, s[30:31]
    s_add_u32 s30, s30, 16384
    s_addc_u32 s31, s31, 0
    v_mfma_f32_16x16x32_bf16 v[104:107], v[56:59], v[184:187], v[104:107]
    ds_read_b64_tr_b16 v[166:167], v9 offset:17408
    s_add_u32 m0, s35, 18432
    v_mfma_f32_16x16x32_bf16 v[120:123], v[60:63], v[184:187], v[120:123]
    ds_read_b64_tr_b16 v[168:169], v10 offset:16384
    global_load_lds_dwordx4 v6, s[32:33]
    s_add_u32 s32, s32, 16384
    s_addc_u32 s33, s33, 0
    v_mfma_f32_16x16x32_bf16 v[76:79], v[48:51], v[252:255], v[76:79]
    ds_read_b64_tr_b16 v[170:171], v10 offset:17408
    v_mfma_f32_16x16x32_bf16 v[92:95], v[52:55], v[252:255], v[92:95]
    ds_read_b64_tr_b16 v[172:173], v11 offset:16384
    v_mfma_f32_16x16x32_bf16 v[108:111], v[56:59], v[188:191], v[108:111]
    ds_read_b64_tr_b16 v[174:175], v11 offset:17408
    s_mov_b64 exec, 15
    global_load_dword v18, v17, s[22:23] offset:-2048
    s_mov_b64 exec, -1
    v_mfma_f32_16x16x32_bf16 v[124:127], v[60:63], v[188:191], v[124:127]
    s_waitcnt lgkmcnt(0)
    v_mfma_f32_16x16x32_bf16 v[128:131], v[160:163], v[160:163], v[128:131]
    v_mfma_f32_16x16x32_bf16 v[64:67], v[32:35], v[160:163], v[64:67]
    v_mfma_f32_16x16x32_bf16 v[80:83], v[36:39], v[160:163], v[80:83]
    s_waitcnt vmcnt(8)
    s_barrier
    v_mfma_f32_16x16x32_bf16 v[96:99], v[40:43], v[192:195], v[96:99]
    ds_read_b64_tr_b16 v[176:177], v8 offset:24576
    s_add_u32 m0, s34, 16384
    v_mfma_f32_16x16x32_bf16 v[112:115], v[44:47], v[192:195], v[112:115]
    ds_read_b64_tr_b16 v[178:179], v8 offset:25600
    global_load_lds_dwordx4 v5, s[28:29]
    s_add_u32 s28, s28, 131072
    s_addc_u32 s29, s29, 0
    v_mfma_f32_16x16x32_bf16 v[68:71], v[32:35], v[164:167], v[68:71]
    ds_read_b128 v[48:51], v7 offset:49152
    v_mfma_f32_16x16x32_bf16 v[84:87], v[36:39], v[164:167], v[84:87]
    ds_read_b128 v[52:55], v7 offset:50176
    v_mfma_f32_16x16x32_bf16 v[100:103], v[40:43], v[196:199], v[100:103]
    ds_read_b128 v[56:59], v7 offset:51200
    s_add_u32 m0, s35, 32768
    v_mfma_f32_16x16x32_bf16 v[116:119], v[44:47], v[196:199], v[116:119]
    ds_read_b128 v[60:63], v7 offset:52224
    global_load_lds_dwordx4 v6, s[30:31]
    s_add_u32 s30, s30, 16384
    s_addc_u32 s31, s31, 0
    v_mfma_f32_16x16x32_bf16 v[72:75], v[32:35], v[168:171], v[72:75]
    v_mfma_f32_16x16x32_bf16 v[88:91], v[36:39], v[168:171], v[88:91]
    ds_read_b64_tr_b16 v[180:181], v9 offset:24576
    s_add_u32 m0, s35, 34816
    v_mfma_f32_16x16x32_bf16 v[104:107], v[40:43], v[200:203], v[104:107]
    ds_read_b64_tr_b16 v[182:183], v9 offset:25600
    global_load_lds_dwordx4 v6, s[32:33]
    s_add_u32 s32, s32, 16384
    s_addc_u32 s33, s33, 0
    v_mfma_f32_16x16x32_bf16 v[120:123], v[44:47], v[200:203], v[120:123]
    ds_read_b64_tr_b16 v[184:185], v10 offset:24576
    v_mfma_f32_16x16x32_bf16 v[76:79], v[32:35], v[172:175], v[76:79]
    ds_read_b64_tr_b16 v[186:187], v10 offset:25600
    v_mfma_f32_16x16x32_bf16 v[92:95], v[36:39], v[172:175], v[92:95]
    ds_read_b64_tr_b16 v[188:189], v11 offset:24576
    v_mfma_f32_16x16x32_bf16 v[108:111], v[40:43], v[204:207], v[108:111]
    ds_read_b64_tr_b16 v[190:191], v11 offset:25600
    s_mov_b64 exec, 15
    global_load_dword v18, v17, s[22:23] offset:-1536
    s_mov_b64 exec, -1
    v_mfma_f32_16x16x32_bf16 v[124:127], v[44:47], v[204:207], v[124:127]
    s_waitcnt lgkmcnt(0)
    v_mfma_f32_16x16x32_bf16 v[128:131], v[176:179], v[176:179], v[128:131]
    v_mfma_f32_16x16x32_bf16 v[64:67], v[48:51], v[176:179], v[64:67]
    v_mfma_f32_16x16x32_bf16 v[80:83], v[52:55], v[176:179], v[80:83]
    s_waitcnt vmcnt(8)
    s_barrier
    v_mfma_f32_16x16x32_bf16 v[96:99], v[56:59], v[208:211], v[96:99]
    ds_read_b64_tr_b16 v[192:193], v8 offset:0
    s_add_u32 m0, s34, 24576
    v_mfma_f32_16x16x32_bf16 v[112:115], v[60:63], v[208:211], v[112:115]
    ds_read_b64_tr_b16 v[194:195], v8 offset:1024
    global_load_lds_dwordx4 v5, s[28:29]
    s_add_u32 s28, s28, 131072
    s_addc_u32 s29, s29, 0
    v_mfma_f32_16x16x32_bf16 v[68:71], v[48:51], v[180:183], v[68:71]
    ds_read_b128 v[32:35], v7 offset:0
    v_mfma_f32_16x16x32_bf16 v[84:87], v[52:55], v[180:183], v[84:87]
    ds_read_b128 v[36:39], v7 offset:1024
    v_mfma_f32_16x16x32_bf16 v[100:103], v[56:59], v[212:215], v[100:103]
    ds_read_b128 v[40:43], v7 offset:2048
    s_add_u32 m0, s35, 49152
    v_mfma_f32_16x16x32_bf16 v[116:119], v[60:63], v[212:215], v[116:119]
    ds_read_b128 v[44:47], v7 offset:3072
    global_load_lds_dwordx4 v6, s[30:31]
    s_add_u32 s30, s30, 16384
    s_addc_u32 s31, s31, 0
    v_mfma_f32_16x16x32_bf16 v[72:75], v[48:51], v[184:187], v[72:75]
    v_mfma_f32_16x16x32_bf16 v[88:91], v[52:55], v[184:187], v[88:91]
    ds_read_b64_tr_b16 v[196:197], v9 offset:0
    s_add_u32 m0, s35, 51200
    v_mfma_f32_16x16x32_bf16 v[104:107], v[56:59], v[216:219], v[104:107]
    ds_read_b64_tr_b16 v[198:199], v9 offset:1024
    global_load_lds_dwordx4 v6, s[32:33]
    s_add_u32 s32, s32, 16384
    s_addc_u32 s33, s33, 0
    v_mfma_f32_16x16x32_bf16 v[120:123], v[60:63], v[216:219], v[120:123]
    ds_read_b64_tr_b16 v[200:201], v10 offset:0
    v_mfma_f32_16x16x32_bf16 v[76:79], v[48:51], v[188:191], v[76:79]
    ds_read_b64_tr_b16 v[202:203], v10 offset:1024
    v_mfma_f32_16x16x32_bf16 v[92:95], v[52:55], v[188:191], v[92:95]
    ds_read_b64_tr_b16 v[204:205], v11 offset:0
    v_mfma_f32_16x16x32_bf16 v[108:111], v[56:59], v[220:223], v[108:111]
    ds_read_b64_tr_b16 v[206:207], v11 offset:1024
    s_mov_b64 exec, 15
    global_load_dword v18, v17, s[22:23] offset:-1024
    s_mov_b64 exec, -1
    v_mfma_f32_16x16x32_bf16 v[124:127], v[60:63], v[220:223], v[124:127]
    s_waitcnt lgkmcnt(0)
    v_mfma_f32_16x16x32_bf16 v[128:131], v[192:195], v[192:195], v[128:131]
    v_mfma_f32_16x16x32_bf16 v[64:67], v[32:35], v[192:195], v[64:67]
    v_mfma_f32_16x16x32_bf16 v[80:83], v[36:39], v[192:195], v[80:83]
    s_waitcnt vmcnt(9)
    s_barrier
    v_mfma_f32_16x16x32_bf16 v[96:99], v[40:43], v[224:227], v[96:99]
    ds_read_b64_tr_b16 v[208:209], v8 offset:8192
    s_add_u32 m0, s34, 0
    v_mfma_f32_16x16x32_bf16 v[112:115], v[44:47], v[224:227], v[112:115]
    ds_read_b64_tr_b16 v[210:211], v8 offset:9216
    global_load_lds_dwordx4 v5, s[28:29]
    s_add_u32 s28, s28, 131072
    s_addc_u32 s29, s29, 0
    v_mfma_f32_16x16x32_bf16 v[68:71], v[32:35], v[196:199], v[68:71]
    ds_read_b128 v[48:51], v7 offset:16384
    v_mfma_f32_16x16x32_bf16 v[84:87], v[36:39], v[196:199], v[84:87]
    ds_read_b128 v[52:55], v7 offset:17408
    s_add_u32 m0, s35, 0
    v_mfma_f32_16x16x32_bf16 v[100:103], v[40:43], v[228:231], v[100:103]
    ds_read_b128 v[56:59], v7 offset:18432
    global_load_lds_dwordx4 v6, s[30:31]
    s_add_u32 s30, s30, 16384
    s_addc_u32 s31, s31, 0
    v_mfma_f32_16x16x32_bf16 v[116:119], v[44:47], v[228:231], v[116:119]
    ds_read_b128 v[60:63], v7 offset:19456
    v_mfma_f32_16x16x32_bf16 v[72:75], v[32:35], v[200:203], v[72:75]
    s_add_u32 m0, s35, 2048
    v_mfma_f32_16x16x32_bf16 v[88:91], v[36:39], v[200:203], v[88:91]
    ds_read_b64_tr_b16 v[212:213], v9 offset:8192
    global_load_lds_dwordx4 v6, s[32:33]
    s_add_u32 s32, s32, 16384
    s_addc_u32 s33, s33, 0
    v_mfma_f32_16x16x32_bf16 v[104:107], v[40:43], v[232:235], v[104:107]
    ds_read_b64_tr_b16 v[214:215], v9 offset:9216
    s_add_u32 m0, s36, 0
    v_mfma_f32_16x16x32_bf16 v[120:123], v[44:47], v[232:235], v[120:123]
    ds_read_b64_tr_b16 v[216:217], v10 offset:8192
    global_load_lds_dwordx4 v6, s[54:55]
    s_add_u32 s54, s54, 16384
    s_addc_u32 s55, s55, 0
    v_mfma_f32_16x16x32_bf16 v[76:79], v[32:35], v[204:207], v[76:79]
    ds_read_b64_tr_b16 v[218:219], v10 offset:9216
    v_mfma_f32_16x16x32_bf16 v[92:95], v[36:39], v[204:207], v[92:95]
    ds_read_b64_tr_b16 v[220:221], v11 offset:8192
    v_mfma_f32_16x16x32_bf16 v[108:111], v[40:43], v[236:239], v[108:111]
    ds_read_b64_tr_b16 v[222:223], v11 offset:9216
    s_mov_b64 exec, 15
    global_load_dword v18, v17, s[22:23] offset:-512
    s_mov_b64 exec, -1
    v_mfma_f32_16x16x32_bf16 v[124:127], v[44:47], v[236:239], v[124:127]
    s_waitcnt lgkmcnt(0)
    v_mfma_f32_16x16x32_bf16 v[128:131], v[208:211], v[208:211], v[128:131]
    v_mfma_f32_16x16x32_bf16 v[64:67], v[48:51], v[208:211], v[64:67]
    v_mfma_f32_16x16x32_bf16 v[80:83], v[52:55], v[208:211], v[80:83]
    s_waitcnt vmcnt(10)
    s_barrier
    v_mfma_f32_16x16x32_bf16 v[96:99], v[56:59], v[240:243], v[96:99]
    ds_read_b64_tr_b16 v[224:225], v8 offset:16384
    s_add_u32 m0, s34, 8192
    v_mfma_f32_16x16x32_bf16 v[112:115], v[60:63], v[240:243], v[112:115]
    ds_read_b64_tr_b16 v[226:227], v8 offset:17408
    global_load_lds_dwordx4 v5, s[28:29]
    s_add_u32 s28, s28, 131072
    s_addc_u32 s29, s29, 0
    v_mfma_f32_16x16x32_bf16 v[68:71], v[48:51], v[212:215], v[68:71]
    ds_read_b128 v[32:35], v7 offset:32768
    v_mfma_f32_16x16x32_bf16 v[84:87], v[52:55], v[212:215], v[84:87]
    ds_read_b128 v[36:39], v7 offset:33792
    s_add_u32 m0, s35, 16384
    v_mfma_f32_16x16x32_bf16 v[100:103], v[56:59], v[244:247], v[100:103]
    ds_read_b128 v[40:43], v7 offset:34816
    global_load_lds_dwordx4 v6, s[30:31]
    s_add_u32 s30, s30, 16384
    s_addc_u32 s31, s31, 0
    v_mfma_f32_16x16x32_bf16 v[116:119], v[60:63], v[244:247], v[116:119]
    ds_read_b128 v[44:47], v7 offset:35840
    v_mfma_f32_16x16x32_bf16 v[72:75], v[48:51], v[216:219], v[72:75]
    s_add_u32 m0, s35, 18432
    v_mfma_f32_16x16x32_bf16 v[88:91], v[52:55], v[216:219], v[88:91]
    ds_read_b64_tr_b16 v[228:229], v9 offset:16384
    global_load_lds_dwordx4 v6, s[32:33]
    s_add_u32 s32, s32, 16384
    s_addc_u32 s33, s33, 0
    v_mfma_f32_16x16x32_bf16 v[104:107], v[56:59], v[248:251], v[104:107]
    ds_read_b64_tr_b16 v[230:231], v9 offset:17408
    s_add_u32 m0, s36, 8192
    v_mfma_f32_16x16x32_bf16 v[120:123], v[60:63], v[248:251], v[120:123]
    ds_read_b64_tr_b16 v[232:233], v10 offset:16384
    global_load_lds_dwordx4 v6, s[54:55]
    s_add_u32 s54, s54, 16384
    s_addc_u32 s55, s55, 0
    v_mfma_f32_16x16x32_bf16 v[76:79], v[48:51], v[220:223], v[76:79]
    ds_read_b64_tr_b16 v[234:235], v10 offset:17408
    v_mfma_f32_16x16x32_bf16 v[92:95], v[52:55], v[220:223], v[92:95]
    ds_read_b64_tr_b16 v[236:237], v11 offset:16384
    v_mfma_f32_16x16x32_bf16 v[108:111], v[56:59], v[252:255], v[108:111]
    ds_read_b64_tr_b16 v[238:239], v11 offset:17408
    s_mov_b64 exec, 15
    global_load_dword v18, v17, s[22:23] offset:0
    s_mov_b64 exec, -1
    v_mfma_f32_16x16x32_bf16 v[124:127], v[60:63], v[252:255], v[124:127]
    s_waitcnt lgkmcnt(0)
    v_mfma_f32_16x16x32_bf16 v[128:131], v[224:227], v[224:227], v[128:131]
    v_mfma_f32_16x16x32_bf16 v[64:67], v[32:35], v[224:227], v[64:67]
    v_mfma_f32_16x16x32_bf16 v[80:83], v[36:39], v[224:227], v[80:83]
    s_waitcnt vmcnt(11)
    s_barrier
    v_mfma_f32_16x16x32_bf16 v[96:99], v[40:43], v[160:163], v[96:99]
    ds_read_b64_tr_b16 v[240:241], v8 offset:24576
    s_add_u32 m0, s34, 16384
    v_mfma_f32_16x16x32_bf16 v[112:115], v[44:47], v[160:163], v[112:115]
    ds_read_b64_tr_b16 v[242:243], v8 offset:25600
    global_load_lds_dwordx4 v5, s[28:29]
    s_add_u32 s28, s28, 131072
    s_addc_u32 s29, s29, 0
    v_mfma_f32_16x16x32_bf16 v[68:71], v[32:35], v[228:231], v[68:71]
    ds_read_b128 v[48:51], v7 offset:49152
    v_mfma_f32_16x16x32_bf16 v[84:87], v[36:39], v[228:231], v[84:87]
    ds_read_b128 v[52:55], v7 offset:50176
    s_add_u32 m0, s35, 32768
    v_mfma_f32_16x16x32_bf16 v[100:103], v[40:43], v[164:167], v[100:103]
    ds_read_b128 v[56:59], v7 offset:51200
    global_load_lds_dwordx4 v6, s[30:31]
    s_add_u32 s30, s30, 16384
    s_addc_u32 s31, s31, 0
    v_mfma_f32_16x16x32_bf16 v[116:119], v[44:47], v[164:167], v[116:119]
    ds_read_b128 v[60:63], v7 offset:52224
    v_mfma_f32_16x16x32_bf16 v[72:75], v[32:35], v[232:235], v[72:75]
    s_add_u32 m0, s35, 34816
    v_mfma_f32_16x16x32_bf16 v[88:91], v[36:39], v[232:235], v[88:91]
    ds_read_b64_tr_b16 v[244:245], v9 offset:24576
    global_load_lds_dwordx4 v6, s[32:33]
    s_add_u32 s32, s32, 16384
    s_addc_u32 s33, s33, 0
    v_mfma_f32_16x16x32_bf16 v[104:107], v[40:43], v[168:171], v[104:107]
    ds_read_b64_tr_b16 v[246:247], v9 offset:25600
    s_add_u32 m0, s36, 16384
    v_mfma_f32_16x16x32_bf16 v[120:123], v[44:47], v[168:171], v[120:123]
    ds_read_b64_tr_b16 v[248:249], v10 offset:24576
    global_load_lds_dwordx4 v6, s[54:55]
    s_add_u32 s54, s54, 16384
    s_addc_u32 s55, s55, 0
    v_mfma_f32_16x16x32_bf16 v[76:79], v[32:35], v[236:239], v[76:79]
    ds_read_b64_tr_b16 v[250:251], v10 offset:25600
    v_mfma_f32_16x16x32_bf16 v[92:95], v[36:39], v[236:239], v[92:95]
    ds_read_b64_tr_b16 v[252:253], v11 offset:24576
    v_mfma_f32_16x16x32_bf16 v[108:111], v[40:43], v[172:175], v[108:111]
    ds_read_b64_tr_b16 v[254:255], v11 offset:25600
    s_mov_b64 exec, 15
    global_load_dword v18, v17, s[22:23] offset:512
    s_mov_b64 exec, -1
    v_mfma_f32_16x16x32_bf16 v[124:127], v[44:47], v[172:175], v[124:127]
    s_waitcnt lgkmcnt(0)
    v_mfma_f32_16x16x32_bf16 v[128:131], v[240:243], v[240:243], v[128:131]
    v_mfma_f32_16x16x32_bf16 v[64:67], v[48:51], v[240:243], v[64:67]
    v_mfma_f32_16x16x32_bf16 v[80:83], v[52:55], v[240:243], v[80:83]
    s_waitcnt vmcnt(12)
    s_barrier
    v_mfma_f32_16x16x32_bf16 v[96:99], v[56:59], v[176:179], v[96:99]
    ds_read_b64_tr_b16 v[160:161], v8 offset:0
    s_add_u32 m0, s34, 24576
    v_mfma_f32_16x16x32_bf16 v[112:115], v[60:63], v[176:179], v[112:115]
    ds_read_b64_tr_b16 v[162:163], v8 offset:1024
    global_load_lds_dwordx4 v5, s[28:29]
    s_add_u32 s28, s28, 131072
    s_addc_u32 s29, s29, 0
    v_mfma_f32_16x16x32_bf16 v[68:71], v[48:51], v[244:247], v[68:71]
    ds_read_b128 v[32:35], v7 offset:0
    v_mfma_f32_16x16x32_bf16 v[84:87], v[52:55], v[244:247], v[84:87]
    ds_read_b128 v[36:39], v7 offset:1024
    s_add_u32 m0, s35, 49152
    v_mfma_f32_16x16x32_bf16 v[100:103], v[56:59], v[180:183], v[100:103]
    ds_read_b128 v[40:43], v7 offset:2048
    global_load_lds_dwordx4 v6, s[30:31]
    s_add_u32 s30, s30, 16384
    s_addc_u32 s31, s31, 0
    v_mfma_f32_16x16x32_bf16 v[116:119], v[60:63], v[180:183], v[116:119]
    ds_read_b128 v[44:47], v7 offset:3072
    v_mfma_f32_16x16x32_bf16 v[72:75], v[48:51], v[248:251], v[72:75]
    s_add_u32 m0, s35, 51200
    v_mfma_f32_16x16x32_bf16 v[88:91], v[52:55], v[248:251], v[88:91]
    ds_read_b64_tr_b16 v[164:165], v9 offset:0
    global_load_lds_dwordx4 v6, s[32:33]
    s_add_u32 s32, s32, 16384
    s_addc_u32 s33, s33, 0
    v_mfma_f32_16x16x32_bf16 v[104:107], v[56:59], v[184:187], v[104:107]
    ds_read_b64_tr_b16 v[166:167], v9 offset:1024
    s_add_u32 m0, s36, 24576
    v_mfma_f32_16x16x32_bf16 v[120:123], v[60:63], v[184:187], v[120:123]
    ds_read_b64_tr_b16 v[168:169], v10 offset:0
    global_load_lds_dwordx4 v6, s[54:55]
    s_add_u32 s54, s54, 16384
    s_addc_u32 s55, s55, 0
    v_mfma_f32_16x16x32_bf16 v[76:79], v[48:51], v[252:255], v[76:79]
    ds_read_b64_tr_b16 v[170:171], v10 offset:1024
    v_mfma_f32_16x16x32_bf16 v[92:95], v[52:55], v[252:255], v[92:95]
    ds_read_b64_tr_b16 v[172:173], v11 offset:0
    v_mfma_f32_16x16x32_bf16 v[108:111], v[56:59], v[188:191], v[108:111]
    ds_read_b64_tr_b16 v[174:175], v11 offset:1024
    s_mov_b64 exec, 15
    global_load_dword v18, v17, s[22:23] offset:1024
    s_mov_b64 exec, -1
    v_mfma_f32_16x16x32_bf16 v[124:127], v[60:63], v[188:191], v[124:127]
    s_waitcnt lgkmcnt(0)
    v_mfma_f32_16x16x32_bf16 v[128:131], v[160:163], v[160:163], v[128:131]
    v_mfma_f32_16x16x32_bf16 v[64:67], v[32:35], v[160:163], v[64:67]
    v_mfma_f32_16x16x32_bf16 v[80:83], v[36:39], v[160:163], v[80:83]
    s_waitcnt vmcnt(12)
    s_barrier
    v_mfma_f32_16x16x32_bf16 v[96:99], v[40:43], v[192:195], v[96:99]
    ds_read_b64_tr_b16 v[176:177], v8 offset:8192
    v_mfma_f32_16x16x32_bf16 v[112:115], v[44:47], v[192:195], v[112:115]
    ds_read_b64_tr_b16 v[178:179], v8 offset:9216
    v_mfma_f32_16x16x32_bf16 v[68:71], v[32:35], v[164:167], v[68:71]
    ds_read_b128 v[48:51], v7 offset:16384
    v_mfma_f32_16x16x32_bf16 v[84:87], v[36:39], v[164:167], v[84:87]
    ds_read_b128 v[52:55], v7 offset:17408
    v_mfma_f32_16x16x32_bf16 v[100:103], v[40:43], v[196:199], v[100:103]
    ds_read_b128 v[56:59], v7 offset:18432
    v_mfma_f32_16x16x32_bf16 v[116:119], v[44:47], v[196:199], v[116:119]
    ds_read_b128 v[60:63], v7 offset:19456
    v_mfma_f32_16x16x32_bf16 v[72:75], v[32:35], v[168:171], v[72:75]
    v_mfma_f32_16x16x32_bf16 v[88:91], v[36:39], v[168:171], v[88:91]
    ds_read_b64_tr_b16 v[180:181], v9 offset:8192
    s_mov_b64 exec, 15
    global_load_dword v18, v17, s[22:23] offset:1536
    s_mov_b64 exec, -1
    v_mfma_f32_16x16x32_bf16 v[104:107], v[40:43], v[200:203], v[104:107]
    ds_read_b64_tr_b16 v[182:183], v9 offset:9216
    v_mfma_f32_16x16x32_bf16 v[120:123], v[44:47], v[200:203], v[120:123]
    ds_read_b64_tr_b16 v[184:185], v10 offset:8192
    v_mfma_f32_16x16x32_bf16 v[76:79], v[32:35], v[172:175], v[76:79]
    ds_read_b64_tr_b16 v[186:187], v10 offset:9216
    v_mfma_f32_16x16x32_bf16 v[92:95], v[36:39], v[172:175], v[92:95]
    ds_read_b64_tr_b16 v[188:189], v11 offset:8192
    v_mfma_f32_16x16x32_bf16 v[108:111], v[40:43], v[204:207], v[108:111]
    ds_read_b64_tr_b16 v[190:191], v11 offset:9216
    v_mfma_f32_16x16x32_bf16 v[124:127], v[44:47], v[204:207], v[124:127]
    s_waitcnt lgkmcnt(0)
    v_mfma_f32_16x16x32_bf16 v[128:131], v[176:179], v[176:179], v[128:131]
    v_mfma_f32_16x16x32_bf16 v[64:67], v[48:51], v[176:179], v[64:67]
    v_mfma_f32_16x16x32_bf16 v[80:83], v[52:55], v[176:179], v[80:83]
    s_waitcnt vmcnt(8)
    s_barrier
    v_mfma_f32_16x16x32_bf16 v[96:99], v[56:59], v[208:211], v[96:99]
    ds_read_b64_tr_b16 v[192:193], v8 offset:16384
    v_mfma_f32_16x16x32_bf16 v[112:115], v[60:63], v[208:211], v[112:115]
    ds_read_b64_tr_b16 v[194:195], v8 offset:17408
    v_mfma_f32_16x16x32_bf16 v[68:71], v[48:51], v[180:183], v[68:71]
    ds_read_b128 v[32:35], v7 offset:32768
    v_mfma_f32_16x16x32_bf16 v[84:87], v[52:55], v[180:183], v[84:87]
    ds_read_b128 v[36:39], v7 offset:33792
    v_mfma_f32_16x16x32_bf16 v[100:103], v[56:59], v[212:215], v[100:103]
    ds_read_b128 v[40:43], v7 offset:34816
    v_mfma_f32_16x16x32_bf16 v[116:119], v[60:63], v[212:215], v[116:119]
    ds_read_b128 v[44:47], v7 offset:35840
    v_mfma_f32_16x16x32_bf16 v[72:75], v[48:51], v[184:187], v[72:75]
    v_mfma_f32_16x16x32_bf16 v[88:91], v[52:55], v[184:187], v[88:91]
    ds_read_b64_tr_b16 v[196:197], v9 offset:16384
    s_mov_b64 exec, 15
    global_load_dword v18, v17, s[22:23] offset:2048
    s_mov_b64 exec, -1
    v_mfma_f32_16x16x32_bf16 v[104:107], v[56:59], v[216:219], v[104:107]
    ds_read_b64_tr_b16 v[198:199], v9 offset:17408
    v_mfma_f32_16x16x32_bf16 v[120:123], v[60:63], v[216:219], v[120:123]
    ds_read_b64_tr_b16 v[200:201], v10 offset:16384
    v_mfma_f32_16x16x32_bf16 v[76:79], v[48:51], v[188:191], v[76:79]
    ds_read_b64_tr_b16 v[202:203], v10 offset:17408
    v_mfma_f32_16x16x32_bf16 v[92:95], v[52:55], v[188:191], v[92:95]
    ds_read_b64_tr_b16 v[204:205], v11 offset:16384
    v_mfma_f32_16x16x32_bf16 v[108:111], v[56:59], v[220:223], v[108:111]
    ds_read_b64_tr_b16 v[206:207], v11 offset:17408
    v_mfma_f32_16x16x32_bf16 v[124:127], v[60:63], v[220:223], v[124:127]
    s_waitcnt lgkmcnt(0)
    v_mfma_f32_16x16x32_bf16 v[128:131], v[192:195], v[192:195], v[128:131]
    v_mfma_f32_16x16x32_bf16 v[64:67], v[32:35], v[192:195], v[64:67]
    v_mfma_f32_16x16x32_bf16 v[80:83], v[36:39], v[192:195], v[80:83]
    s_waitcnt vmcnt(4)
    s_barrier
    v_mfma_f32_16x16x32_bf16 v[96:99], v[40:43], v[224:227], v[96:99]
    ds_read_b64_tr_b16 v[208:209], v8 offset:24576
    v_mfma_f32_16x16x32_bf16 v[112:115], v[44:47], v[224:227], v[112:115]
    ds_read_b64_tr_b16 v[210:211], v8 offset:25600
    v_mfma_f32_16x16x32_bf16 v[68:71], v[32:35], v[196:199], v[68:71]
    ds_read_b128 v[48:51], v7 offset:49152
    v_mfma_f32_16x16x32_bf16 v[84:87], v[36:39], v[196:199], v[84:87]
    ds_read_b128 v[52:55], v7 offset:50176
    v_mfma_f32_16x16x32_bf16 v[100:103], v[40:43], v[228:231], v[100:103]
    ds_read_b128 v[56:59], v7 offset:51200
    v_mfma_f32_16x16x32_bf16 v[116:119], v[44:47], v[228:231], v[116:119]
    ds_read_b128 v[60:63], v7 offset:52224
    v_mfma_f32_16x16x32_bf16 v[72:75], v[32:35], v[200:203], v[72:75]
    v_mfma_f32_16x16x32_bf16 v[88:91], v[36:39], v[200:203], v[88:91]
    ds_read_b64_tr_b16 v[212:213], v9 offset:24576
    s_mov_b64 exec, 15
    global_load_dword v18, v17, s[22:23] offset:2560
    s_mov_b64 exec, -1
    v_mfma_f32_16x16x32_bf16 v[104:107], v[40:43], v[232:235], v[104:107]
    ds_read_b64_tr_b16 v[214:215], v9 offset:25600
    v_mfma_f32_16x16x32_bf16 v[120:123], v[44:47], v[232:235], v[120:123]
    ds_read_b64_tr_b16 v[216:217], v10 offset:24576
    v_mfma_f32_16x16x32_bf16 v[76:79], v[32:35], v[204:207], v[76:79]
    ds_read_b64_tr_b16 v[218:219], v10 offset:25600
    v_mfma_f32_16x16x32_bf16 v[92:95], v[36:39], v[204:207], v[92:95]
    ds_read_b64_tr_b16 v[220:221], v11 offset:24576
    v_mfma_f32_16x16x32_bf16 v[108:111], v[40:43], v[236:239], v[108:111]
    ds_read_b64_tr_b16 v[222:223], v11 offset:25600
    v_mfma_f32_16x16x32_bf16 v[124:127], v[44:47], v[236:239], v[124:127]
    s_waitcnt lgkmcnt(0)
    v_and_b32 v211, v13, v211
    s_nop 1
    v_mfma_f32_16x16x32_bf16 v[128:131], v[208:211], v[208:211], v[128:131]
    v_mfma_f32_16x16x32_bf16 v[64:67], v[48:51], v[208:211], v[64:67]
    v_mfma_f32_16x16x32_bf16 v[80:83], v[52:55], v[208:211], v[80:83]
    v_mfma_f32_16x16x32_bf16 v[96:99], v[56:59], v[240:243], v[96:99]
    v_mfma_f32_16x16x32_bf16 v[112:115], v[60:63], v[240:243], v[112:115]
    v_mfma_f32_16x16x32_bf16 v[68:71], v[48:51], v[212:215], v[68:71]
    s_nop 2
    v_cndmask_b32_e64 v14, v128, v129, s[48:49]
    v_cndmask_b32_e64 v14, v14, v130, s[50:51]
    v_cndmask_b32_e64 v14, v14, v131, s[52:53]
    ds_write_b32 v12, v14
    v_mfma_f32_16x16x32_bf16 v[84:87], v[52:55], v[212:215], v[84:87]
    s_waitcnt vmcnt(4) lgkmcnt(0)
    s_barrier
    ds_read_b32 v24, v19
    v_xor_b32 v14, 64, v19
    ds_read_b32 v26, v14
    v_xor_b32 v14, 128, v19
    ds_read_b32 v28, v14
    v_xor_b32 v14, 192, v19
    ds_read_b32 v30, v14
    ds_read_b128 v[40:43], v16 offset:0
    ds_read_b128 v[44:47], v16 offset:1024
    v_mov_b32 v20, 0x3b000000
    v_mov_b32 v21, 0x3727c5ac
    v_mfma_f32_16x16x32_bf16 v[100:103], v[56:59], v[244:247], v[100:103]
    v_mfma_f32_16x16x32_bf16 v[116:119], v[60:63], v[244:247], v[116:119]
    v_mfma_f32_16x16x32_bf16 v[72:75], v[48:51], v[216:219], v[72:75]
    v_mfma_f32_16x16x32_bf16 v[88:91], v[52:55], v[216:219], v[88:91]
    v_mfma_f32_16x16x32_bf16 v[104:107], v[56:59], v[248:251], v[104:107]
    v_mfma_f32_16x16x32_bf16 v[120:123], v[60:63], v[248:251], v[120:123]
    s_waitcnt lgkmcnt(2)
    v_fma_f32 v24, v24, v20, v21
    v_fma_f32 v26, v26, v20, v21
    v_fma_f32 v28, v28, v20, v21
    v_fma_f32 v30, v30, v20, v21
    v_mfma_f32_16x16x32_bf16 v[76:79], v[48:51], v[220:223], v[76:79]
    v_rsq_f32 v25, v24
    v_rsq_f32 v27, v26
    v_rsq_f32 v29, v28
    v_rsq_f32 v31, v30
    v_mfma_f32_16x16x32_bf16 v[92:95], v[52:55], v[220:223], v[92:95]
    v_mfma_f32_16x16x32_bf16 v[108:111], v[56:59], v[252:255], v[108:111]
    v_mul_f32 v25, 0xbfb8aa3b, v25
    v_mul_f32 v27, 0xbfb8aa3b, v27
    v_mul_f32 v29, 0xbfb8aa3b, v29
    v_mul_f32 v31, 0xbfb8aa3b, v31
    v_mfma_f32_16x16x32_bf16 v[124:127], v[60:63], v[252:255], v[124:127]
    s_cmp_ge_u32 s27, 14
    s_cbranch_scc1 glu_x3
    s_waitcnt lgkmcnt(0)
    ds_read_b128 v[56:59], v16 offset:8192
    ds_read_b128 v[60:63], v16 offset:9216
    v_mfma_f32_16x16x32_bf16 v[96:99], v[40:43], v[160:163], v[96:99]
    v_mul_f32 v32, v64, v25
    v_mul_f32 v48, v68, v27
    v_mul_f32 v33, v65, v25
    v_mul_f32 v49, v69, v27
    v_mfma_f32_16x16x32_bf16 v[112:115], v[44:47], v[160:163], v[112:115]
    v_mul_f32 v34, v66, v25
    v_mul_f32 v50, v70, v27
    v_mul_f32 v35, v67, v25
    v_mfma_f32_16x16x32_bf16 v[100:103], v[40:43], v[164:167], v[100:103]
    v_mul_f32 v51, v71, v27
    v_exp_f32 v32, v32
    v_exp_f32 v48, v48
    v_mfma_f32_16x16x32_bf16 v[116:119], v[44:47], v[164:167], v[116:119]
    v_exp_f32 v33, v33
    v_exp_f32 v49, v49
    v_exp_f32 v34, v34
    v_mfma_f32_16x16x32_bf16 v[104:107], v[40:43], v[168:171], v[104:107]
    v_exp_f32 v50, v50
    v_exp_f32 v35, v35
    v_exp_f32 v51, v51
    v_mul_f32 v36, v64, v80
    v_mfma_f32_16x16x32_bf16 v[120:123], v[44:47], v[168:171], v[120:123]
    v_mul_f32 v52, v68, v84
    v_mul_f32 v37, v65, v81
    v_mul_f32 v53, v69, v85
    v_mfma_f32_16x16x32_bf16 v[108:111], v[40:43], v[172:175], v[108:111]
    v_mul_f32 v38, v66, v82
    v_mul_f32 v54, v70, v86
    v_mul_f32 v39, v67, v83
    v_mfma_f32_16x16x32_bf16 v[124:127], v[44:47], v[172:175], v[124:127]
    v_mul_f32 v55, v71, v87
    v_fma_f32 v32, v32, v24, v24
    v_fma_f32 v48, v48, v26, v26
    s_waitcnt lgkmcnt(0)
    ds_read_b128 v[40:43], v16 offset:16384
    ds_read_b128 v[44:47], v16 offset:17408
    v_mfma_f32_16x16x32_bf16 v[96:99], v[56:59], v[176:179], v[96:99]
    v_fma_f32 v33, v33, v24, v24
    v_fma_f32 v49, v49, v26, v26
    v_fma_f32 v34, v34, v24, v24
    v_fma_f32 v50, v50, v26, v26
    v_mfma_f32_16x16x32_bf16 v[112:115], v[60:63], v[176:179], v[112:115]
    v_fma_f32 v35, v35, v24, v24
    v_fma_f32 v51, v51, v26, v26
    v_rcp_f32 v32, v32
    v_mfma_f32_16x16x32_bf16 v[100:103], v[56:59], v[180:183], v[100:103]
    v_rcp_f32 v48, v48
    v_rcp_f32 v33, v33
    v_rcp_f32 v49, v49
    v_mfma_f32_16x16x32_bf16 v[116:119], v[60:63], v[180:183], v[116:119]
    v_rcp_f32 v34, v34
    v_rcp_f32 v50, v50
    v_rcp_f32 v35, v35
    v_mfma_f32_16x16x32_bf16 v[104:107], v[56:59], v[184:187], v[104:107]
    v_rcp_f32 v51, v51
    v_mul_f32 v36, v36, v32
    v_mul_f32 v52, v52, v48
    v_mul_f32 v37, v37, v33
    v_mfma_f32_16x16x32_bf16 v[120:123], v[60:63], v[184:187], v[120:123]
    v_mul_f32 v53, v53, v49
    v_mul_f32 v38, v38, v34
    v_mul_f32 v54, v54, v50
    v_mfma_f32_16x16x32_bf16 v[108:111], v[56:59], v[188:191], v[108:111]
    v_mul_f32 v39, v39, v35
    v_mul_f32 v55, v55, v51
    v_cvt_pk_bf16_f32 v132, v36, v37
    v_mfma_f32_16x16x32_bf16 v[124:127], v[60:63], v[188:191], v[124:127]
    v_cvt_pk_bf16_f32 v136, v52, v53
    v_cvt_pk_bf16_f32 v133, v38, v39
    v_cvt_pk_bf16_f32 v137, v54, v55
    s_waitcnt lgkmcnt(0)
    ds_read_b128 v[56:59], v16 offset:24576
    ds_read_b128 v[60:63], v16 offset:25600
    v_mfma_f32_16x16x32_bf16 v[96:99], v[40:43], v[192:195], v[96:99]
    v_mul_f32 v32, v72, v29
    v_mul_f32 v48, v76, v31
    v_mul_f32 v33, v73, v29
    v_mul_f32 v49, v77, v31
    v_mfma_f32_16x16x32_bf16 v[112:115], v[44:47], v[192:195], v[112:115]
    v_mul_f32 v34, v74, v29
    v_mul_f32 v50, v78, v31
    v_mul_f32 v35, v75, v29
    v_mfma_f32_16x16x32_bf16 v[100:103], v[40:43], v[196:199], v[100:103]
    v_mul_f32 v51, v79, v31
    v_exp_f32 v32, v32
    v_exp_f32 v48, v48
    v_mfma_f32_16x16x32_bf16 v[116:119], v[44:47], v[196:199], v[116:119]
    v_exp_f32 v33, v33
    v_exp_f32 v49, v49
    v_exp_f32 v34, v34
    v_mfma_f32_16x16x32_bf16 v[104:107], v[40:43], v[200:203], v[104:107]
    v_exp_f32 v50, v50
    v_exp_f32 v35, v35
    v_exp_f32 v51, v51
    v_mul_f32 v36, v72, v88
    v_mfma_f32_16x16x32_bf16 v[120:123], v[44:47], v[200:203], v[120:123]
    v_mul_f32 v52, v76, v92
    v_mul_f32 v37, v73, v89
    v_mul_f32 v53, v77, v93
    v_mfma_f32_16x16x32_bf16 v[108:111], v[40:43], v[204:207], v[108:111]
    v_mul_f32 v38, v74, v90
    v_mul_f32 v54, v78, v94
    v_mul_f32 v39, v75, v91
    v_mfma_f32_16x16x32_bf16 v[124:127], v[44:47], v[204:207], v[124:127]
    v_mul_f32 v55, v79, v95
    v_fma_f32 v32, v32, v28, v28
    v_fma_f32 v48, v48, v30, v30
    s_waitcnt lgkmcnt(0)
    v_mfma_f32_16x16x32_bf16 v[96:99], v[56:59], v[208:211], v[96:99]
    v_fma_f32 v33, v33, v28, v28
    v_fma_f32 v49, v49, v30, v30
    v_fma_f32 v34, v34, v28, v28
    v_fma_f32 v50, v50, v30, v30
    v_mfma_f32_16x16x32_bf16 v[112:115], v[60:63], v[208:211], v[112:115]
    v_fma_f32 v35, v35, v28, v28
    v_fma_f32 v51, v51, v30, v30
    v_rcp_f32 v32, v32
    v_mfma_f32_16x16x32_bf16 v[100:103], v[56:59], v[212:215], v[100:103]
    v_rcp_f32 v48, v48
    v_rcp_f32 v33, v33
    v_rcp_f32 v49, v49
    v_mfma_f32_16x16x32_bf16 v[116:119], v[60:63], v[212:215], v[116:119]
    v_rcp_f32 v34, v34
    v_rcp_f32 v50, v50
    v_rcp_f32 v35, v35
    v_mfma_f32_16x16x32_bf16 v[104:107], v[56:59], v[216:219], v[104:107]
    v_rcp_f32 v51, v51
    v_mul_f32 v36, v36, v32
    v_mul_f32 v52, v52, v48
    v_mul_f32 v37, v37, v33
    v_mfma_f32_16x16x32_bf16 v[120:123], v[60:63], v[216:219], v[120:123]
    v_mul_f32 v53, v53, v49
    v_mul_f32 v38, v38, v34
    v_mul_f32 v54, v54, v50
    v_mfma_f32_16x16x32_bf16 v[108:111], v[56:59], v[220:223], v[108:111]
    v_mul_f32 v39, v39, v35
    v_mul_f32 v55, v55, v51
    v_cvt_pk_bf16_f32 v140, v36, v37
    v_mfma_f32_16x16x32_bf16 v[124:127], v[60:63], v[220:223], v[124:127]
    v_cvt_pk_bf16_f32 v144, v52, v53
    v_cvt_pk_bf16_f32 v141, v38, v39
    v_cvt_pk_bf16_f32 v145, v54, v55
    v_pk_mul_f32 v[160:161], v[96:97], v[24:25] op_sel:[0,1] op_sel_hi:[1,1]
    v_pk_mul_f32 v[162:163], v[98:99], v[24:25] op_sel:[0,1] op_sel_hi:[1,1]
    v_pk_mul_f32 v[164:165], v[100:101], v[26:27] op_sel:[0,1] op_sel_hi:[1,1]
    v_pk_mul_f32 v[166:167], v[102:103], v[26:27] op_sel:[0,1] op_sel_hi:[1,1]
    v_exp_f32 v160, v160
    v_exp_f32 v161, v161
    v_exp_f32 v162, v162
    v_exp_f32 v163, v163
    v_exp_f32 v164, v164
    v_exp_f32 v165, v165
    v_exp_f32 v166, v166
    v_exp_f32 v167, v167
    v_pk_mul_f32 v[168:169], v[96:97], v[112:113]
    v_pk_mul_f32 v[170:171], v[98:99], v[114:115]
    v_pk_mul_f32 v[172:173], v[100:101], v[116:117]
    v_pk_mul_f32 v[174:175], v[102:103], v[118:119]
    v_pk_fma_f32 v[160:161], v[160:161], v[24:25], v[24:25] op_sel_hi:[1,0,0]
    v_pk_fma_f32 v[162:163], v[162:163], v[24:25], v[24:25] op_sel_hi:[1,0,0]
    v_pk_fma_f32 v[164:165], v[164:165], v[26:27], v[26:27] op_sel_hi:[1,0,0]
    v_pk_fma_f32 v[166:167], v[166:167], v[26:27], v[26:27] op_sel_hi:[1,0,0]
    v_rcp_f32 v160, v160
    v_rcp_f32 v161, v161
    v_rcp_f32 v162, v162
    v_rcp_f32 v163, v163
    v_rcp_f32 v164, v164
    v_rcp_f32 v165, v165
    v_rcp_f32 v166, v166
    v_rcp_f32 v167, v167
    v_pk_mul_f32 v[168:169], v[168:169], v[160:161]
    v_pk_mul_f32 v[170:171], v[170:171], v[162:163]
    v_pk_mul_f32 v[172:173], v[172:173], v[164:165]
    v_pk_mul_f32 v[174:175], v[174:175], v[166:167]
    v_cvt_pk_bf16_f32 v134, v168, v169
    v_cvt_pk_bf16_f32 v135, v170, v171
    v_cvt_pk_bf16_f32 v138, v172, v173
    v_cvt_pk_bf16_f32 v139, v174, v175
    v_add_u32 v14, s40, v6
    global_store_dwordx4 v14, v[132:135], s[22:23] sc1
    v_add_u32 v14, s41, v6
    global_store_dwordx4 v14, v[136:139], s[22:23] sc1
    v_pk_mul_f32 v[176:177], v[104:105], v[28:29] op_sel:[0,1] op_sel_hi:[1,1]
    v_pk_mul_f32 v[178:179], v[106:107], v[28:29] op_sel:[0,1] op_sel_hi:[1,1]
    v_pk_mul_f32 v[180:181], v[108:109], v[30:31] op_sel:[0,1] op_sel_hi:[1,1]
    v_pk_mul_f32 v[182:183], v[110:111], v[30:31] op_sel:[0,1] op_sel_hi:[1,1]
    v_exp_f32 v176, v176
    v_exp_f32 v177, v177
    v_exp_f32 v178, v178
    v_exp_f32 v179, v179
    v_exp_f32 v180, v180
    v_exp_f32 v181, v181
    v_exp_f32 v182, v182
    v_exp_f32 v183, v183
    v_pk_mul_f32 v[184:185], v[104:105], v[120:121]
    v_pk_mul_f32 v[186:187], v[106:107], v[122:123]
    v_pk_mul_f32 v[188:189], v[108:109], v[124:125]
    v_pk_mul_f32 v[190:191], v[110:111], v[126:127]
    v_pk_fma_f32 v[176:177], v[176:177], v[28:29], v[28:29] op_sel_hi:[1,0,0]
    v_pk_fma_f32 v[178:179], v[178:179], v[28:29], v[28:29] op_sel_hi:[1,0,0]
    v_pk_fma_f32 v[180:181], v[180:181], v[30:31], v[30:31] op_sel_hi:[1,0,0]
    v_pk_fma_f32 v[182:183], v[182:183], v[30:31], v[30:31] op_sel_hi:[1,0,0]
    v_rcp_f32 v176, v176
    v_rcp_f32 v177, v177
    v_rcp_f32 v178, v178
    v_rcp_f32 v179, v179
    v_rcp_f32 v180, v180
    v_rcp_f32 v181, v181
    v_rcp_f32 v182, v182
    v_rcp_f32 v183, v183
    v_pk_mul_f32 v[184:185], v[184:185], v[176:177]
    v_pk_mul_f32 v[186:187], v[186:187], v[178:179]
    v_pk_mul_f32 v[188:189], v[188:189], v[180:181]
    v_pk_mul_f32 v[190:191], v[190:191], v[182:183]
    v_cvt_pk_bf16_f32 v142, v184, v185
    v_cvt_pk_bf16_f32 v143, v186, v187
    v_cvt_pk_bf16_f32 v146, v188, v189
    v_cvt_pk_bf16_f32 v147, v190, v191
    v_add_u32 v14, s42, v6
    global_store_dwordx4 v14, v[140:143], s[22:23] sc1
    v_add_u32 v14, s43, v6
    global_store_dwordx4 v14, v[144:147], s[22:23] sc1
    s_branch glu_fin
glu_x3:
    s_lshl_b32 s37, s26, 3
    s_lshl_b32 s38, s24, 2
    s_add_u32 s37, s37, s38
    s_add_u32 s37, s37, s25
    s_sub_u32 s38, s27, 14
    s_lshl_b32 s38, s38, 3
    s_lshl_b32 s39, s25, 1
    s_add_u32 s38, s38, s39
    s_lshl_b32 s38, s38, 10
    s_add_u32 s38, s38, 23068672
    s_xor_b32 s40, s37, 0
    s_lshl_b32 s40, s40, 14
    s_add_u32 s40, s40, s38
    s_xor_b32 s41, s37, 1
    s_lshl_b32 s41, s41, 14
    s_add_u32 s41, s41, s38
    s_xor_b32 s42, s37, 2
    s_lshl_b32 s42, s42, 14
    s_add_u32 s42, s42, s38
    s_xor_b32 s43, s37, 3
    s_lshl_b32 s43, s43, 14
    s_add_u32 s43, s43, s38
    s_waitcnt lgkmcnt(0)
    ds_read_b128 v[56:59], v16 offset:8192
    ds_read_b128 v[60:63], v16 offset:9216
    v_mfma_f32_16x16x32_bf16 v[96:99], v[40:43], v[160:163], v[96:99]
    v_cvt_pk_bf16_f32 v132, v64, v65
    v_mfma_f32_16x16x32_bf16 v[112:115], v[44:47], v[160:163], v[112:115]
    v_cvt_pk_bf16_f32 v133, v66, v67
    v_mfma_f32_16x16x32_bf16 v[100:103], v[40:43], v[164:167], v[100:103]
    v_cvt_pk_bf16_f32 v134, v80, v81
    v_mfma_f32_16x16x32_bf16 v[116:119], v[44:47], v[164:167], v[116:119]
    v_mfma_f32_16x16x32_bf16 v[104:107], v[40:43], v[168:171], v[104:107]
    v_cvt_pk_bf16_f32 v135, v82, v83
    v_mfma_f32_16x16x32_bf16 v[120:123], v[44:47], v[168:171], v[120:123]
    v_add_u32 v14, s40, v6
    v_mfma_f32_16x16x32_bf16 v[108:111], v[40:43], v[172:175], v[108:111]
    global_store_dwordx4 v14, v[132:135], s[22:23] offset:0 sc1
    v_mfma_f32_16x16x32_bf16 v[124:127], v[44:47], v[172:175], v[124:127]
    s_waitcnt lgkmcnt(0)
    ds_read_b128 v[40:43], v16 offset:16384
    ds_read_b128 v[44:47], v16 offset:17408
    v_mfma_f32_16x16x32_bf16 v[96:99], v[56:59], v[176:179], v[96:99]
    v_cvt_pk_bf16_f32 v140, v68, v69
    v_mfma_f32_16x16x32_bf16 v[112:115], v[60:63], v[176:179], v[112:115]
    v_cvt_pk_bf16_f32 v141, v70, v71
    v_mfma_f32_16x16x32_bf16 v[100:103], v[56:59], v[180:183], v[100:103]
    v_cvt_pk_bf16_f32 v142, v84, v85
    v_mfma_f32_16x16x32_bf16 v[116:119], v[60:63], v[180:183], v[116:119]
    v_mfma_f32_16x16x32_bf16 v[104:107], v[56:59], v[184:187], v[104:107]
    v_cvt_pk_bf16_f32 v143, v86, v87
    v_mfma_f32_16x16x32_bf16 v[120:123], v[60:63], v[184:187], v[120:123]
    v_add_u32 v14, s41, v6
    v_mfma_f32_16x16x32_bf16 v[108:111], v[56:59], v[188:191], v[108:111]
    global_store_dwordx4 v14, v[140:143], s[22:23] offset:0 sc1
    v_mfma_f32_16x16x32_bf16 v[124:127], v[60:63], v[188:191], v[124:127]
    s_waitcnt lgkmcnt(0)
    ds_read_b128 v[56:59], v16 offset:24576
    ds_read_b128 v[60:63], v16 offset:25600
    v_mfma_f32_16x16x32_bf16 v[96:99], v[40:43], v[192:195], v[96:99]
    v_cvt_pk_bf16_f32 v132, v72, v73
    v_mfma_f32_16x16x32_bf16 v[112:115], v[44:47], v[192:195], v[112:115]
    v_cvt_pk_bf16_f32 v133, v74, v75
    v_mfma_f32_16x16x32_bf16 v[100:103], v[40:43], v[196:199], v[100:103]
    v_cvt_pk_bf16_f32 v134, v88, v89
    v_mfma_f32_16x16x32_bf16 v[116:119], v[44:47], v[196:199], v[116:119]
    v_mfma_f32_16x16x32_bf16 v[104:107], v[40:43], v[200:203], v[104:107]
    v_cvt_pk_bf16_f32 v135, v90, v91
    v_mfma_f32_16x16x32_bf16 v[120:123], v[44:47], v[200:203], v[120:123]
    v_add_u32 v14, s42, v6
    v_mfma_f32_16x16x32_bf16 v[108:111], v[40:43], v[204:207], v[108:111]
    global_store_dwordx4 v14, v[132:135], s[22:23] offset:0 sc1
    v_mfma_f32_16x16x32_bf16 v[124:127], v[44:47], v[204:207], v[124:127]
    s_waitcnt lgkmcnt(0)
    v_mfma_f32_16x16x32_bf16 v[96:99], v[56:59], v[208:211], v[96:99]
    v_cvt_pk_bf16_f32 v140, v76, v77
    v_mfma_f32_16x16x32_bf16 v[112:115], v[60:63], v[208:211], v[112:115]
    v_cvt_pk_bf16_f32 v141, v78, v79
    v_mfma_f32_16x16x32_bf16 v[100:103], v[56:59], v[212:215], v[100:103]
    v_cvt_pk_bf16_f32 v142, v92, v93
    v_mfma_f32_16x16x32_bf16 v[116:119], v[60:63], v[212:215], v[116:119]
    v_mfma_f32_16x16x32_bf16 v[104:107], v[56:59], v[216:219], v[104:107]
    v_cvt_pk_bf16_f32 v143, v94, v95
    v_mfma_f32_16x16x32_bf16 v[120:123], v[60:63], v[216:219], v[120:123]
    v_add_u32 v14, s43, v6
    v_mfma_f32_16x16x32_bf16 v[108:111], v[56:59], v[220:223], v[108:111]
    global_store_dwordx4 v14, v[140:143], s[22:23] offset:0 sc1
    v_mfma_f32_16x16x32_bf16 v[124:127], v[60:63], v[220:223], v[124:127]
    v_cvt_pk_bf16_f32 v136, v96, v97
    v_cvt_pk_bf16_f32 v137, v98, v99
    v_cvt_pk_bf16_f32 v138, v112, v113
    v_cvt_pk_bf16_f32 v139, v114, v115
    v_add_u32 v14, s40, v6
    global_store_dwordx4 v14, v[136:139], s[22:23] offset:1024 sc1
    v_cvt_pk_bf16_f32 v144, v100, v101
    v_cvt_pk_bf16_f32 v145, v102, v103
    v_cvt_pk_bf16_f32 v146, v116, v117
    v_cvt_pk_bf16_f32 v147, v118, v119
    v_add_u32 v14, s41, v6
    global_store_dwordx4 v14, v[144:147], s[22:23] offset:1024 sc1
    v_cvt_pk_bf16_f32 v136, v104, v105
    v_cvt_pk_bf16_f32 v137, v106, v107
    v_cvt_pk_bf16_f32 v138, v120, v121
    v_cvt_pk_bf16_f32 v139, v122, v123
    v_add_u32 v14, s42, v6
    global_store_dwordx4 v14, v[136:139], s[22:23] offset:1024 sc1
    v_cvt_pk_bf16_f32 v144, v108, v109
    v_cvt_pk_bf16_f32 v145, v110, v111
    v_cvt_pk_bf16_f32 v146, v124, v125
    v_cvt_pk_bf16_f32 v147, v126, v127
    v_add_u32 v14, s43, v6
    global_store_dwordx4 v14, v[144:147], s[22:23] offset:1024 sc1
    s_branch glu_fin
glu_skip:
    s_and_b32 s37, s2, 1
    s_bfe_u32 s38, s2, 0x30003
    s_lshl_b32 s38, s38, 1
    s_or_b32 s37, s37, s38
    s_bfe_u32 s38, s2, 0x10006
    s_lshl_b32 s38, s38, 4
    s_or_b32 s32, s37, s38
    s_cmp_ge_u32 s32, 12
    s_cbranch_scc1 glu_skip2
    v_lshrrev_b32 v21, 3, v2
    v_and_b32 v22, 7, v2
    v_and_b32 v23, 6, v21
    v_xor_b32 v23, v23, v22
    v_lshlrev_b32 v23, 4, v23
    v_lshl_add_u32 v24, v21, 10, v23
    s_lshl_b32 s37, s32, 3
    s_add_u32 s37, s37, s3
    s_lshl_b32 s37, s37, 13
    s_add_u32 s28, s16, s37
    s_addc_u32 s29, s17, 0
    s_add_u32 m0, s34, 0
    s_nop 0
    global_load_lds_dwordx4 v24, s[28:29]
    s_add_u32 s28, s28, 128
    s_addc_u32 s29, s29, 0
    s_add_u32 m0, s34, 8192
    s_nop 0
    global_load_lds_dwordx4 v24, s[28:29]
    s_add_u32 s28, s28, 128
    s_addc_u32 s29, s29, 0
    s_add_u32 m0, s34, 16384
    s_nop 0
    global_load_lds_dwordx4 v24, s[28:29]
    s_add_u32 s28, s28, 128
    s_addc_u32 s29, s29, 0
    s_add_u32 m0, s34, 24576
    s_nop 0
    global_load_lds_dwordx4 v24, s[28:29]
    s_add_u32 s28, s28, 128
    s_addc_u32 s29, s29, 0
    s_add_u32 m0, s34, 32768
    s_nop 0
    global_load_lds_dwordx4 v24, s[28:29]
    s_add_u32 s28, s28, 128
    s_addc_u32 s29, s29, 0
    s_add_u32 m0, s34, 40960
    s_nop 0
    global_load_lds_dwordx4 v24, s[28:29]
    s_add_u32 s28, s28, 128
    s_addc_u32 s29, s29, 0
    s_add_u32 m0, s34, 49152
    s_nop 0
    global_load_lds_dwordx4 v24, s[28:29]
    s_add_u32 s28, s28, 128
    s_addc_u32 s29, s29, 0
    s_add_u32 m0, s34, 57344
    s_nop 0
    global_load_lds_dwordx4 v24, s[28:29]
    s_lshr_b32 s37, s3, 1
    s_lshl_b32 s37, s37, 13
    s_and_b32 s38, s3, 1
    s_lshl_b32 s38, s38, 2
    v_bfe_u32 v21, v2, 2, 2
    v_and_b32 v22, 3, v2
    v_lshl_add_u32 v23, v3, 2, v21
    v_and_b32 v21, 6, v23
    v_lshlrev_b32 v23, 7, v23
    v_lshrrev_b32 v25, 1, v22
    v_or_b32 v25, s38, v25
    v_xor_b32 v25, v25, v21
    v_lshl_add_u32 v23, v25, 4, v23
    v_and_b32 v22, 1, v22
    v_lshl_add_u32 v23, v22, 3, v23
    v_add_u32 v23, s37, v23
    v_xor_b32 v22, 32, v23
    s_mul_i32 s37, s3, 114688
    s_lshl_b32 s38, s32, 11
    s_add_u32 s37, s37, s38
    s_add_u32 s37, s37, 18874368
    v_lshlrev_b32 v26, 4, v2
    v_add_u32 v27, 57344, v26
    s_add_u32 s30, s22, s37
    s_addc_u32 s31, s23, 0
    s_mov_b64 exec, 15
    global_load_dword v18, v17, s[22:23] offset:-4096
    s_mov_b64 exec, -1
    s_mov_b64 exec, 15
    global_load_dword v18, v17, s[22:23] offset:-3584
    s_mov_b64 exec, -1
    s_mov_b64 exec, 15
    global_load_dword v18, v17, s[22:23] offset:-3072
    s_mov_b64 exec, -1
    s_mov_b64 exec, 15
    global_load_dword v18, v17, s[22:23] offset:-2560
    s_mov_b64 exec, -1
    s_mov_b64 exec, 15
    global_load_dword v18, v17, s[22:23] offset:-2048
    s_mov_b64 exec, -1
    s_mov_b64 exec, 15
    global_load_dword v18, v17, s[22:23] offset:-1536
    s_mov_b64 exec, -1
    s_mov_b64 exec, 15
    global_load_dword v18, v17, s[22:23] offset:-1024
    s_mov_b64 exec, -1
    s_mov_b64 exec, 15
    global_load_dword v18, v17, s[22:23] offset:-512
    s_mov_b64 exec, -1
    s_mov_b64 exec, 15
    global_load_dword v18, v17, s[22:23] offset:0
    s_mov_b64 exec, -1
    s_mov_b64 exec, 15
    global_load_dword v18, v17, s[22:23] offset:512
    s_mov_b64 exec, -1
    s_mov_b64 exec, 15
    global_load_dword v18, v17, s[22:23] offset:1024
    s_mov_b64 exec, -1
    s_mov_b64 exec, 15
    global_load_dword v18, v17, s[22:23] offset:1536
    s_mov_b64 exec, -1
    s_mov_b64 exec, 15
    global_load_dword v18, v17, s[22:23] offset:2048
    s_mov_b64 exec, -1
    s_mov_b64 exec, 15
    global_load_dword v18, v17, s[22:23] offset:2560
    s_mov_b64 exec, -1
    s_waitcnt vmcnt(0)
    s_barrier
    ds_read_b64_tr_b16 v[64:65], v23 offset:0
    ds_read_b64_tr_b16 v[66:67], v23 offset:2048
    ds_read_b64_tr_b16 v[68:69], v23 offset:4096
    ds_read_b64_tr_b16 v[70:71], v23 offset:6144
    ds_read_b64_tr_b16 v[72:73], v22 offset:0
    ds_read_b64_tr_b16 v[74:75], v22 offset:2048
    ds_read_b64_tr_b16 v[76:77], v22 offset:4096
    ds_read_b64_tr_b16 v[78:79], v22 offset:6144
    ds_read_b64_tr_b16 v[80:81], v23 offset:32768
    ds_read_b64_tr_b16 v[82:83], v23 offset:34816
    ds_read_b64_tr_b16 v[84:85], v23 offset:36864
    ds_read_b64_tr_b16 v[86:87], v23 offset:38912
    ds_read_b64_tr_b16 v[88:89], v22 offset:32768
    ds_read_b64_tr_b16 v[90:91], v22 offset:34816
    ds_read_b64_tr_b16 v[92:93], v22 offset:36864
    ds_read_b64_tr_b16 v[94:95], v22 offset:38912
    s_waitcnt lgkmcnt(8)
    global_store_dwordx4 v26, v[64:67], s[30:31] offset:0 sc1
    global_store_dwordx4 v26, v[68:71], s[30:31] offset:1024 sc1
    global_store_dwordx4 v27, v[72:75], s[30:31] offset:0 sc1
    global_store_dwordx4 v27, v[76:79], s[30:31] offset:1024 sc1
    s_add_u32 s30, s30, 917504
    s_addc_u32 s31, s31, 0
    s_waitcnt lgkmcnt(0)
    global_store_dwordx4 v26, v[80:83], s[30:31] offset:0 sc1
    global_store_dwordx4 v26, v[84:87], s[30:31] offset:1024 sc1
    global_store_dwordx4 v27, v[88:91], s[30:31] offset:0 sc1
    global_store_dwordx4 v27, v[92:95], s[30:31] offset:1024 sc1
    s_branch glu_fin
glu_skip2:
    s_mov_b64 exec, 15
    global_load_dword v18, v17, s[22:23] offset:-4096
    s_mov_b64 exec, -1
    s_waitcnt vmcnt(0)
    s_mov_b64 exec, 15
    global_load_dword v18, v17, s[22:23] offset:-3584
    s_mov_b64 exec, -1
    s_waitcnt vmcnt(0)
    s_mov_b64 exec, 15
    global_load_dword v18, v17, s[22:23] offset:-3072
    s_mov_b64 exec, -1
    s_waitcnt vmcnt(0)
    s_mov_b64 exec, 15
    global_load_dword v18, v17, s[22:23] offset:-2560
    s_mov_b64 exec, -1
    s_waitcnt vmcnt(0)
    s_mov_b64 exec, 15
    global_load_dword v18, v17, s[22:23] offset:-2048
    s_mov_b64 exec, -1
    s_waitcnt vmcnt(0)
    s_mov_b64 exec, 15
    global_load_dword v18, v17, s[22:23] offset:-1536
    s_mov_b64 exec, -1
    s_waitcnt vmcnt(0)
    s_mov_b64 exec, 15
    global_load_dword v18, v17, s[22:23] offset:-1024
    s_mov_b64 exec, -1
    s_waitcnt vmcnt(0)
    s_mov_b64 exec, 15
    global_load_dword v18, v17, s[22:23] offset:-512
    s_mov_b64 exec, -1
    s_waitcnt vmcnt(0)
    s_mov_b64 exec, 15
    global_load_dword v18, v17, s[22:23] offset:0
    s_mov_b64 exec, -1
    s_waitcnt vmcnt(0)
    s_mov_b64 exec, 15
    global_load_dword v18, v17, s[22:23] offset:512
    s_mov_b64 exec, -1
    s_waitcnt vmcnt(0)
    s_mov_b64 exec, 15
    global_load_dword v18, v17, s[22:23] offset:1024
    s_mov_b64 exec, -1
    s_waitcnt vmcnt(0)
    s_mov_b64 exec, 15
    global_load_dword v18, v17, s[22:23] offset:1536
    s_mov_b64 exec, -1
    s_waitcnt vmcnt(0)
    s_mov_b64 exec, 15
    global_load_dword v18, v17, s[22:23] offset:2048
    s_mov_b64 exec, -1
    s_waitcnt vmcnt(0)
    s_mov_b64 exec, 15
    global_load_dword v18, v17, s[22:23] offset:2560
    s_mov_b64 exec, -1
    s_waitcnt vmcnt(0)
glu_fin:
    s_lshl_b32 s37, s2, 5
    s_add_u32 s37, s37, 29360128
    v_lshl_add_u32 v14, v0, 2, s37
    v_mov_b32 v15, 0
    v_cmp_gt_u32 vcc, 8, v0
    s_and_saveexec_b64 s[44:45], vcc
    s_cbranch_execz glu_end
    global_store_dword v14, v15, s[22:23] sc1
glu_end:
glu_end2:
    s_endpgm
.globl glu1_kernel
.p2align 8
.type glu1_kernel,@function
glu1_kernel:
    s_mov_b32 s60, 1
    s_branch glu_body
.globl down0_kernel
.p2align 8
.type down0_kernel,@function
down0_kernel:
    s_cmp_ge_u32 s2, 256
    s_cbranch_scc1 down0_end2
    s_load_dwordx16 s[4:19], s[0:1], 0
    s_load_dwordx4 s[20:23], s[0:1], 64
    s_cmp_lt_u32 s2, 8
    s_cbranch_scc0 down0_nopf
    s_getpc_b64 s[62:63]
down0_pc:
    s_add_u32 s62, s62, fft0_kernel-512-down0_pc
    s_addc_u32 s63, s63, -1
    v_lshlrev_b32 v16, 7, v0
    v_min_u32 v16, fft1_kernel+64-(fft0_kernel-512)-4, v16
    global_load_dword v16, v16, s[62:63]
down0_nopf:
    v_lshrrev_b32 v1, 6, v0
    v_and_b32 v2, 63, v0
    v_readfirstlane_b32 s3, v1
    v_bfe_u32 v3, v0, 4, 2
    v_and_b32 v4, 15, v0
    s_and_b32 s26, s2, 7
    s_lshl_b32 s26, s26, 2
    s_lshr_b32 s27, s2, 6
    s_add_u32 s24, s26, s27
    s_bfe_u32 s25, s2, 0x30003
    s_mul_i32 s26, s3, 14336
    s_add_u32 s26, s26, 4096
    v_lshl_add_u32 v5, v2, 4, s26
    v_add_u32 v6, 8192, v5
    s_mul_i32 s26, s24, 229376
    s_add_u32 s26, s26, 9437184
    s_mul_i32 s27, s25, 229376
    s_add_u32 s27, s27, 16777216
    s_lshl_b32 s28, s25, 2
    s_add_u32 s28, s28, s3
    s_lshl_b32 s28, s28, 16
    s_lshl_b32 s46, s24, 7
    s_add_u32 s28, s28, s46
    v_lshlrev_b32 v7, 12, v4
    v_lshl_add_u32 v7, v3, 4, v7
    v_add_u32 v7, s28, v7
    s_waitcnt lgkmcnt(0)
    s_add_u32 s30, s22, s26
    s_addc_u32 s31, s23, 0
    s_add_u32 s46, s22, 2097152
    s_addc_u32 s47, s23, 0
    global_load_dwordx4 v[16:19], v7, s[46:47]
    global_load_dwordx4 v[20:23], v7, s[46:47] offset:64
    s_add_u32 s32, s30, 57344
    s_addc_u32 s33, s31, 0
    s_add_u32 s34, s32, 57344
    s_addc_u32 s35, s33, 0
    s_add_u32 s36, s34, 57344
    s_addc_u32 s37, s35, 0
    s_xor_b32 s28, s3, 0
    s_mul_i32 s28, s28, 57344
    s_add_u32 s28, s28, s27
    s_add_u32 s38, s22, s28
    s_addc_u32 s39, s23, 0
    s_xor_b32 s28, s3, 1
    s_mul_i32 s28, s28, 57344
    s_add_u32 s28, s28, s27
    s_add_u32 s40, s22, s28
    s_addc_u32 s41, s23, 0
    s_xor_b32 s28, s3, 2
    s_mul_i32 s28, s28, 57344
    s_add_u32 s28, s28, s27
    s_add_u32 s42, s22, s28
    s_addc_u32 s43, s23, 0
    s_xor_b32 s28, s3, 3
    s_mul_i32 s28, s28, 57344
    s_add_u32 s28, s28, s27
    s_add_u32 s44, s22, s28
    s_addc_u32 s45, s23, 0
    global_load_dwordx4 a[16:19], v5, s[38:39] offset:-4096
    global_load_dwordx4 a[0:3], v5, s[30:31] offset:-4096
    global_load_dwordx4 a[4:7], v5, s[32:33] offset:-4096
    global_load_dwordx4 a[8:11], v5, s[34:35] offset:-4096
    global_load_dwordx4 a[12:15], v5, s[36:37] offset:-4096
    global_load_dwordx4 a[20:23], v5, s[40:41] offset:-4096
    global_load_dwordx4 a[24:27], v5, s[42:43] offset:-4096
    global_load_dwordx4 a[28:31], v5, s[44:45] offset:-4096
    global_load_dwordx4 a[48:51], v5, s[38:39] offset:-3072
    global_load_dwordx4 a[32:35], v5, s[30:31] offset:-3072
    global_load_dwordx4 a[36:39], v5, s[32:33] offset:-3072
    global_load_dwordx4 a[40:43], v5, s[34:35] offset:-3072
    global_load_dwordx4 a[44:47], v5, s[36:37] offset:-3072
    global_load_dwordx4 a[52:55], v5, s[40:41] offset:-3072
    global_load_dwordx4 a[56:59], v5, s[42:43] offset:-3072
    global_load_dwordx4 a[60:63], v5, s[44:45] offset:-3072
    global_load_dwordx4 a[80:83], v5, s[38:39] offset:-2048
    global_load_dwordx4 a[64:67], v5, s[30:31] offset:-2048
    global_load_dwordx4 a[68:71], v5, s[32:33] offset:-2048
    global_load_dwordx4 a[72:75], v5, s[34:35] offset:-2048
    global_load_dwordx4 a[76:79], v5, s[36:37] offset:-2048
    global_load_dwordx4 a[84:87], v5, s[40:41] offset:-2048
    global_load_dwordx4 a[88:91], v5, s[42:43] offset:-2048
    global_load_dwordx4 a[92:95], v5, s[44:45] offset:-2048
    global_load_dwordx4 a[112:115], v5, s[38:39] offset:-1024
    global_load_dwordx4 a[96:99], v5, s[30:31] offset:-1024
    global_load_dwordx4 a[100:103], v5, s[32:33] offset:-1024
    global_load_dwordx4 a[104:107], v5, s[34:35] offset:-1024
    global_load_dwordx4 a[108:111], v5, s[36:37] offset:-1024
    global_load_dwordx4 a[116:119], v5, s[40:41] offset:-1024
    global_load_dwordx4 a[120:123], v5, s[42:43] offset:-1024
    global_load_dwordx4 a[124:127], v5, s[44:45] offset:-1024
    s_xor_b32 s28, s3, 1
    s_mul_i32 s28, s28, 3
    s_add_u32 s28, s28, 0
    s_lshl_b32 s28, s28, 12
    v_lshl_add_u32 v8, v2, 4, s28
    s_xor_b32 s28, s3, 2
    s_mul_i32 s28, s28, 3
    s_add_u32 s28, s28, 1
    s_lshl_b32 s28, s28, 12
    v_lshl_add_u32 v9, v2, 4, s28
    s_xor_b32 s28, s3, 3
    s_mul_i32 s28, s28, 3
    s_add_u32 s28, s28, 2
    s_lshl_b32 s28, s28, 12
    v_lshl_add_u32 v10, v2, 4, s28
    s_mul_i32 s28, s3, 12288
    v_lshl_add_u32 v11, v2, 4, s28
    s_waitcnt vmcnt(24)
    v_mfma_f32_16x16x32_bf16 v[64:67], a[0:3], a[16:19], 0
    v_mfma_f32_16x16x32_bf16 v[68:71], a[4:7], a[16:19], 0
    global_load_dwordx4 a[144:147], v5, s[38:39] offset:0
    v_mfma_f32_16x16x32_bf16 v[72:75], a[8:11], a[16:19], 0
    v_mfma_f32_16x16x32_bf16 v[76:79], a[12:15], a[16:19], 0
    global_load_dwordx4 a[128:131], v5, s[30:31] offset:0
    v_mfma_f32_16x16x32_bf16 v[80:83], a[0:3], a[20:23], 0
    v_mfma_f32_16x16x32_bf16 v[84:87], a[4:7], a[20:23], 0
    global_load_dwordx4 a[132:135], v5, s[32:33] offset:0
    v_mfma_f32_16x16x32_bf16 v[88:91], a[8:11], a[20:23], 0
    v_mfma_f32_16x16x32_bf16 v[92:95], a[12:15], a[20:23], 0
    global_load_dwordx4 a[136:139], v5, s[34:35] offset:0
    v_mfma_f32_16x16x32_bf16 v[96:99], a[0:3], a[24:27], 0
    v_mfma_f32_16x16x32_bf16 v[100:103], a[4:7], a[24:27], 0
    global_load_dwordx4 a[140:143], v5, s[36:37] offset:0
    v_mfma_f32_16x16x32_bf16 v[104:107], a[8:11], a[24:27], 0
    v_mfma_f32_16x16x32_bf16 v[108:111], a[12:15], a[24:27], 0
    global_load_dwordx4 a[148:151], v5, s[40:41] offset:0
    v_mfma_f32_16x16x32_bf16 v[112:115], a[0:3], a[28:31], 0
    v_mfma_f32_16x16x32_bf16 v[116:119], a[4:7], a[28:31], 0
    global_load_dwordx4 a[152:155], v5, s[42:43] offset:0
    v_mfma_f32_16x16x32_bf16 v[120:123], a[8:11], a[28:31], 0
    v_mfma_f32_16x16x32_bf16 v[124:127], a[12:15], a[28:31], 0
    global_load_dwordx4 a[156:159], v5, s[44:45] offset:0
    s_waitcnt vmcnt(24)
    v_mfma_f32_16x16x32_bf16 v[64:67], a[32:35], a[48:51], v[64:67]
    v_mfma_f32_16x16x32_bf16 v[68:71], a[36:39], a[48:51], v[68:71]
    global_load_dwordx4 a[176:179], v5, s[38:39] offset:1024
    v_mfma_f32_16x16x32_bf16 v[72:75], a[40:43], a[48:51], v[72:75]
    v_mfma_f32_16x16x32_bf16 v[76:79], a[44:47], a[48:51], v[76:79]
    global_load_dwordx4 a[160:163], v5, s[30:31] offset:1024
    v_mfma_f32_16x16x32_bf16 v[80:83], a[32:35], a[52:55], v[80:83]
    v_mfma_f32_16x16x32_bf16 v[84:87], a[36:39], a[52:55], v[84:87]
    global_load_dwordx4 a[164:167], v5, s[32:33] offset:1024
    v_mfma_f32_16x16x32_bf16 v[88:91], a[40:43], a[52:55], v[88:91]
    v_mfma_f32_16x16x32_bf16 v[92:95], a[44:47], a[52:55], v[92:95]
    global_load_dwordx4 a[168:171], v5, s[34:35] offset:1024
    v_mfma_f32_16x16x32_bf16 v[96:99], a[32:35], a[56:59], v[96:99]
    v_mfma_f32_16x16x32_bf16 v[100:103], a[36:39], a[56:59], v[100:103]
    global_load_dwordx4 a[172:175], v5, s[36:37] offset:1024
    v_mfma_f32_16x16x32_bf16 v[104:107], a[40:43], a[56:59], v[104:107]
    v_mfma_f32_16x16x32_bf16 v[108:111], a[44:47], a[56:59], v[108:111]
    global_load_dwordx4 a[180:183], v5, s[40:41] offset:1024
    v_mfma_f32_16x16x32_bf16 v[112:115], a[32:35], a[60:63], v[112:115]
    v_mfma_f32_16x16x32_bf16 v[116:119], a[36:39], a[60:63], v[116:119]
    global_load_dwordx4 a[184:187], v5, s[42:43] offset:1024
    v_mfma_f32_16x16x32_bf16 v[120:123], a[40:43], a[60:63], v[120:123]
    v_mfma_f32_16x16x32_bf16 v[124:127], a[44:47], a[60:63], v[124:127]
    global_load_dwordx4 a[188:191], v5, s[44:45] offset:1024
    s_waitcnt vmcnt(24)
    v_mfma_f32_16x16x32_bf16 v[64:67], a[64:67], a[80:83], v[64:67]
    v_mfma_f32_16x16x32_bf16 v[68:71], a[68:71], a[80:83], v[68:71]
    global_load_dwordx4 a[192:195], v5, s[30:31] offset:2048
    v_mfma_f32_16x16x32_bf16 v[72:75], a[72:75], a[80:83], v[72:75]
    v_mfma_f32_16x16x32_bf16 v[76:79], a[76:79], a[80:83], v[76:79]
    global_load_dwordx4 a[196:199], v5, s[32:33] offset:2048
    v_mfma_f32_16x16x32_bf16 v[80:83], a[64:67], a[84:87], v[80:83]
    v_mfma_f32_16x16x32_bf16 v[84:87], a[68:71], a[84:87], v[84:87]
    global_load_dwordx4 a[200:203], v5, s[34:35] offset:2048
    v_mfma_f32_16x16x32_bf16 v[88:91], a[72:75], a[84:87], v[88:91]
    v_mfma_f32_16x16x32_bf16 v[92:95], a[76:79], a[84:87], v[92:95]
    global_load_dwordx4 a[204:207], v5, s[36:37] offset:2048
    v_mfma_f32_16x16x32_bf16 v[96:99], a[64:67], a[88:91], v[96:99]
    v_mfma_f32_16x16x32_bf16 v[100:103], a[68:71], a[88:91], v[100:103]
    global_load_dwordx4 a[212:215], v5, s[40:41] offset:2048
    v_mfma_f32_16x16x32_bf16 v[104:107], a[72:75], a[88:91], v[104:107]
    v_mfma_f32_16x16x32_bf16 v[108:111], a[76:79], a[88:91], v[108:111]
    global_load_dwordx4 a[216:219], v5, s[42:43] offset:2048
    v_mfma_f32_16x16x32_bf16 v[112:115], a[64:67], a[92:95], v[112:115]
    v_mfma_f32_16x16x32_bf16 v[116:119], a[68:71], a[92:95], v[116:119]
    global_load_dwordx4 a[220:223], v5, s[44:45] offset:2048
    v_mfma_f32_16x16x32_bf16 v[120:123], a[72:75], a[92:95], v[120:123]
    v_mfma_f32_16x16x32_bf16 v[124:127], a[76:79], a[92:95], v[124:127]
    s_waitcnt vmcnt(23)
    v_mfma_f32_16x16x32_bf16 v[64:67], a[96:99], a[112:115], v[64:67]
    v_mfma_f32_16x16x32_bf16 v[68:71], a[100:103], a[112:115], v[68:71]
    global_load_dwordx4 a[224:227], v5, s[30:31] offset:3072
    v_mfma_f32_16x16x32_bf16 v[72:75], a[104:107], a[112:115], v[72:75]
    v_mfma_f32_16x16x32_bf16 v[76:79], a[108:111], a[112:115], v[76:79]
    global_load_dwordx4 a[228:231], v5, s[32:33] offset:3072
    v_mfma_f32_16x16x32_bf16 v[80:83], a[96:99], a[116:119], v[80:83]
    v_mfma_f32_16x16x32_bf16 v[84:87], a[100:103], a[116:119], v[84:87]
    global_load_dwordx4 a[232:235], v5, s[34:35] offset:3072
    v_mfma_f32_16x16x32_bf16 v[88:91], a[104:107], a[116:119], v[88:91]
    v_mfma_f32_16x16x32_bf16 v[92:95], a[108:111], a[116:119], v[92:95]
    global_load_dwordx4 a[236:239], v5, s[36:37] offset:3072
    v_mfma_f32_16x16x32_bf16 v[96:99], a[96:99], a[120:123], v[96:99]
    v_mfma_f32_16x16x32_bf16 v[100:103], a[100:103], a[120:123], v[100:103]
    global_load_dwordx4 a[244:247], v5, s[40:41] offset:3072
    v_mfma_f32_16x16x32_bf16 v[104:107], a[104:107], a[120:123], v[104:107]
    v_mfma_f32_16x16x32_bf16 v[108:111], a[108:111], a[120:123], v[108:111]
    global_load_dwordx4 a[248:251], v5, s[42:43] offset:3072
    v_mfma_f32_16x16x32_bf16 v[112:115], a[96:99], a[124:127], v[112:115]
    v_mfma_f32_16x16x32_bf16 v[116:119], a[100:103], a[124:127], v[116:119]
    global_load_dwordx4 a[252:255], v5, s[44:45] offset:3072
    v_mfma_f32_16x16x32_bf16 v[120:123], a[104:107], a[124:127], v[120:123]
    v_mfma_f32_16x16x32_bf16 v[124:127], a[108:111], a[124:127], v[124:127]
    s_waitcnt vmcnt(22)
    v_mfma_f32_16x16x32_bf16 v[64:67], a[128:131], a[144:147], v[64:67]
    v_mfma_f32_16x16x32_bf16 v[68:71], a[132:135], a[144:147], v[68:71]
    global_load_dwordx4 a[0:3], v6, s[30:31] offset:-4096
    v_mfma_f32_16x16x32_bf16 v[72:75], a[136:139], a[144:147], v[72:75]
    v_mfma_f32_16x16x32_bf16 v[76:79], a[140:143], a[144:147], v[76:79]
    global_load_dwordx4 a[4:7], v6, s[32:33] offset:-4096
    v_mfma_f32_16x16x32_bf16 v[80:83], a[128:131], a[148:151], v[80:83]
    v_mfma_f32_16x16x32_bf16 v[84:87], a[132:135], a[148:151], v[84:87]
    global_load_dwordx4 a[8:11], v6, s[34:35] offset:-4096
    v_mfma_f32_16x16x32_bf16 v[88:91], a[136:139], a[148:151], v[88:91]
    v_mfma_f32_16x16x32_bf16 v[92:95], a[140:143], a[148:151], v[92:95]
    global_load_dwordx4 a[12:15], v6, s[36:37] offset:-4096
    v_mfma_f32_16x16x32_bf16 v[96:99], a[128:131], a[152:155], v[96:99]
    v_mfma_f32_16x16x32_bf16 v[100:103], a[132:135], a[152:155], v[100:103]
    global_load_dwordx4 a[20:23], v6, s[40:41] offset:-4096
    v_mfma_f32_16x16x32_bf16 v[104:107], a[136:139], a[152:155], v[104:107]
    v_mfma_f32_16x16x32_bf16 v[108:111], a[140:143], a[152:155], v[108:111]
    global_load_dwordx4 a[24:27], v6, s[42:43] offset:-4096
    v_mfma_f32_16x16x32_bf16 v[112:115], a[128:131], a[156:159], v[112:115]
    v_mfma_f32_16x16x32_bf16 v[116:119], a[132:135], a[156:159], v[116:119]
    global_load_dwordx4 a[28:31], v6, s[44:45] offset:-4096
    v_mfma_f32_16x16x32_bf16 v[120:123], a[136:139], a[156:159], v[120:123]
    v_mfma_f32_16x16x32_bf16 v[124:127], a[140:143], a[156:159], v[124:127]
    s_waitcnt vmcnt(21)
    v_mfma_f32_16x16x32_bf16 v[64:67], a[160:163], a[176:179], v[64:67]
    v_mfma_f32_16x16x32_bf16 v[68:71], a[164:167], a[176:179], v[68:71]
    global_load_dwordx4 a[32:35], v6, s[30:31] offset:-3072
    v_mfma_f32_16x16x32_bf16 v[72:75], a[168:171], a[176:179], v[72:75]
    v_mfma_f32_16x16x32_bf16 v[76:79], a[172:175], a[176:179], v[76:79]
    global_load_dwordx4 a[36:39], v6, s[32:33] offset:-3072
    v_mfma_f32_16x16x32_bf16 v[80:83], a[160:163], a[180:183], v[80:83]
    v_mfma_f32_16x16x32_bf16 v[84:87], a[164:167], a[180:183], v[84:87]
    global_load_dwordx4 a[40:43], v6, s[34:35] offset:-3072
    v_mfma_f32_16x16x32_bf16 v[88:91], a[168:171], a[180:183], v[88:91]
    v_mfma_f32_16x16x32_bf16 v[92:95], a[172:175], a[180:183], v[92:95]
    global_load_dwordx4 a[44:47], v6, s[36:37] offset:-3072
    v_mfma_f32_16x16x32_bf16 v[96:99], a[160:163], a[184:187], v[96:99]
    v_mfma_f32_16x16x32_bf16 v[100:103], a[164:167], a[184:187], v[100:103]
    global_load_dwordx4 a[52:55], v6, s[40:41] offset:-3072
    v_mfma_f32_16x16x32_bf16 v[104:107], a[168:171], a[184:187], v[104:107]
    v_mfma_f32_16x16x32_bf16 v[108:111], a[172:175], a[184:187], v[108:111]
    global_load_dwordx4 a[56:59], v6, s[42:43] offset:-3072
    v_mfma_f32_16x16x32_bf16 v[112:115], a[160:163], a[188:191], v[112:115]
    v_mfma_f32_16x16x32_bf16 v[116:119], a[164:167], a[188:191], v[116:119]
    global_load_dwordx4 a[60:63], v6, s[44:45] offset:-3072
    v_mfma_f32_16x16x32_bf16 v[120:123], a[168:171], a[188:191], v[120:123]
    v_mfma_f32_16x16x32_bf16 v[124:127], a[172:175], a[188:191], v[124:127]
    s_waitcnt vmcnt(21)
    v_mfma_f32_16x16x32_bf16 v[80:83], a[192:195], a[212:215], v[80:83]
    global_load_dwordx4 a[64:67], v6, s[30:31] offset:-2048
    v_mfma_f32_16x16x32_bf16 v[84:87], a[196:199], a[212:215], v[84:87]
    global_load_dwordx4 a[68:71], v6, s[32:33] offset:-2048
    v_mfma_f32_16x16x32_bf16 v[88:91], a[200:203], a[212:215], v[88:91]
    global_load_dwordx4 a[72:75], v6, s[34:35] offset:-2048
    v_mfma_f32_16x16x32_bf16 v[92:95], a[204:207], a[212:215], v[92:95]
    global_load_dwordx4 a[76:79], v6, s[36:37] offset:-2048
    v_mfma_f32_16x16x32_bf16 v[96:99], a[192:195], a[216:219], v[96:99]
    global_load_dwordx4 a[84:87], v6, s[40:41] offset:-2048
    v_mfma_f32_16x16x32_bf16 v[100:103], a[196:199], a[216:219], v[100:103]
    global_load_dwordx4 a[88:91], v6, s[42:43] offset:-2048
    v_mfma_f32_16x16x32_bf16 v[104:107], a[200:203], a[216:219], v[104:107]
    global_load_dwordx4 a[92:95], v6, s[44:45] offset:-2048
    v_mfma_f32_16x16x32_bf16 v[108:111], a[204:207], a[216:219], v[108:111]
    v_mfma_f32_16x16x32_bf16 v[112:115], a[192:195], a[220:223], v[112:115]
    v_mfma_f32_16x16x32_bf16 v[116:119], a[196:199], a[220:223], v[116:119]
    v_mfma_f32_16x16x32_bf16 v[120:123], a[200:203], a[220:223], v[120:123]
    v_mfma_f32_16x16x32_bf16 v[124:127], a[204:207], a[220:223], v[124:127]
    s_waitcnt vmcnt(21)
    v_mfma_f32_16x16x32_bf16 v[80:83], a[224:227], a[244:247], v[80:83]
    global_load_dwordx4 a[96:99], v6, s[30:31] offset:-1024
    v_mfma_f32_16x16x32_bf16 v[84:87], a[228:231], a[244:247], v[84:87]
    global_load_dwordx4 a[100:103], v6, s[32:33] offset:-1024
    v_mfma_f32_16x16x32_bf16 v[88:91], a[232:235], a[244:247], v[88:91]
    global_load_dwordx4 a[104:107], v6, s[34:35] offset:-1024
    v_mfma_f32_16x16x32_bf16 v[92:95], a[236:239], a[244:247], v[92:95]
    global_load_dwordx4 a[108:111], v6, s[36:37] offset:-1024
    v_mfma_f32_16x16x32_bf16 v[96:99], a[224:227], a[248:251], v[96:99]
    global_load_dwordx4 a[116:119], v6, s[40:41] offset:-1024
    v_mfma_f32_16x16x32_bf16 v[100:103], a[228:231], a[248:251], v[100:103]
    global_load_dwordx4 a[120:123], v6, s[42:43] offset:-1024
    v_mfma_f32_16x16x32_bf16 v[104:107], a[232:235], a[248:251], v[104:107]
    global_load_dwordx4 a[124:127], v6, s[44:45] offset:-1024
    v_mfma_f32_16x16x32_bf16 v[108:111], a[236:239], a[248:251], v[108:111]
    v_mfma_f32_16x16x32_bf16 v[112:115], a[224:227], a[252:255], v[112:115]
    v_mfma_f32_16x16x32_bf16 v[116:119], a[228:231], a[252:255], v[116:119]
    v_mfma_f32_16x16x32_bf16 v[120:123], a[232:235], a[252:255], v[120:123]
    v_mfma_f32_16x16x32_bf16 v[124:127], a[236:239], a[252:255], v[124:127]
    s_waitcnt vmcnt(21)
    v_mfma_f32_16x16x32_bf16 v[80:83], a[0:3], a[20:23], v[80:83]
    global_load_dwordx4 a[128:131], v6, s[30:31] offset:0
    v_mfma_f32_16x16x32_bf16 v[84:87], a[4:7], a[20:23], v[84:87]
    global_load_dwordx4 a[132:135], v6, s[32:33] offset:0
    v_mfma_f32_16x16x32_bf16 v[88:91], a[8:11], a[20:23], v[88:91]
    global_load_dwordx4 a[136:139], v6, s[34:35] offset:0
    v_mfma_f32_16x16x32_bf16 v[92:95], a[12:15], a[20:23], v[92:95]
    global_load_dwordx4 a[140:143], v6, s[36:37] offset:0
    v_mfma_f32_16x16x32_bf16 v[96:99], a[0:3], a[24:27], v[96:99]
    global_load_dwordx4 a[148:151], v6, s[40:41] offset:0
    v_mfma_f32_16x16x32_bf16 v[100:103], a[4:7], a[24:27], v[100:103]
    global_load_dwordx4 a[152:155], v6, s[42:43] offset:0
    v_mfma_f32_16x16x32_bf16 v[104:107], a[8:11], a[24:27], v[104:107]
    global_load_dwordx4 a[156:159], v6, s[44:45] offset:0
    v_mfma_f32_16x16x32_bf16 v[108:111], a[12:15], a[24:27], v[108:111]
    v_mfma_f32_16x16x32_bf16 v[112:115], a[0:3], a[28:31], v[112:115]
    v_mfma_f32_16x16x32_bf16 v[116:119], a[4:7], a[28:31], v[116:119]
    v_mfma_f32_16x16x32_bf16 v[120:123], a[8:11], a[28:31], v[120:123]
    v_mfma_f32_16x16x32_bf16 v[124:127], a[12:15], a[28:31], v[124:127]
    s_waitcnt vmcnt(21)
    v_mfma_f32_16x16x32_bf16 v[80:83], a[32:35], a[52:55], v[80:83]
    global_load_dwordx4 a[160:163], v6, s[30:31] offset:1024
    v_mfma_f32_16x16x32_bf16 v[84:87], a[36:39], a[52:55], v[84:87]
    global_load_dwordx4 a[164:167], v6, s[32:33] offset:1024
    v_mfma_f32_16x16x32_bf16 v[88:91], a[40:43], a[52:55], v[88:91]
    global_load_dwordx4 a[168:171], v6, s[34:35] offset:1024
    v_mfma_f32_16x16x32_bf16 v[92:95], a[44:47], a[52:55], v[92:95]
    global_load_dwordx4 a[172:175], v6, s[36:37] offset:1024
    v_mfma_f32_16x16x32_bf16 v[96:99], a[32:35], a[56:59], v[96:99]
    global_load_dwordx4 a[180:183], v6, s[40:41] offset:1024
    v_mfma_f32_16x16x32_bf16 v[100:103], a[36:39], a[56:59], v[100:103]
    global_load_dwordx4 a[184:187], v6, s[42:43] offset:1024
    v_mfma_f32_16x16x32_bf16 v[104:107], a[40:43], a[56:59], v[104:107]
    global_load_dwordx4 a[188:191], v6, s[44:45] offset:1024
    v_mfma_f32_16x16x32_bf16 v[108:111], a[44:47], a[56:59], v[108:111]
    v_mfma_f32_16x16x32_bf16 v[112:115], a[32:35], a[60:63], v[112:115]
    v_mfma_f32_16x16x32_bf16 v[116:119], a[36:39], a[60:63], v[116:119]
    v_mfma_f32_16x16x32_bf16 v[120:123], a[40:43], a[60:63], v[120:123]
    v_mfma_f32_16x16x32_bf16 v[124:127], a[44:47], a[60:63], v[124:127]
    s_waitcnt vmcnt(21)
    v_mfma_f32_16x16x32_bf16 v[80:83], a[64:67], a[84:87], v[80:83]
    v_mfma_f32_16x16x32_bf16 v[84:87], a[68:71], a[84:87], v[84:87]
    global_load_dwordx4 a[208:211], v5, s[38:39] offset:2048
    v_mfma_f32_16x16x32_bf16 v[88:91], a[72:75], a[84:87], v[88:91]
    v_mfma_f32_16x16x32_bf16 v[92:95], a[76:79], a[84:87], v[92:95]
    global_load_dwordx4 a[240:243], v5, s[38:39] offset:3072
    v_mfma_f32_16x16x32_bf16 v[96:99], a[64:67], a[88:91], v[96:99]
    v_mfma_f32_16x16x32_bf16 v[100:103], a[68:71], a[88:91], v[100:103]
    global_load_dwordx4 a[16:19], v6, s[38:39] offset:-4096
    v_mfma_f32_16x16x32_bf16 v[104:107], a[72:75], a[88:91], v[104:107]
    v_mfma_f32_16x16x32_bf16 v[108:111], a[76:79], a[88:91], v[108:111]
    v_mfma_f32_16x16x32_bf16 v[112:115], a[64:67], a[92:95], v[112:115]
    v_mfma_f32_16x16x32_bf16 v[116:119], a[68:71], a[92:95], v[116:119]
    v_mfma_f32_16x16x32_bf16 v[120:123], a[72:75], a[92:95], v[120:123]
    v_mfma_f32_16x16x32_bf16 v[124:127], a[76:79], a[92:95], v[124:127]
    s_waitcnt vmcnt(17)
    v_mfma_f32_16x16x32_bf16 v[80:83], a[96:99], a[116:119], v[80:83]
    v_mfma_f32_16x16x32_bf16 v[84:87], a[100:103], a[116:119], v[84:87]
    global_load_dwordx4 a[48:51], v6, s[38:39] offset:-3072
    v_mfma_f32_16x16x32_bf16 v[88:91], a[104:107], a[116:119], v[88:91]
    v_mfma_f32_16x16x32_bf16 v[92:95], a[108:111], a[116:119], v[92:95]
    global_load_dwordx4 a[80:83], v6, s[38:39] offset:-2048
    v_mfma_f32_16x16x32_bf16 v[96:99], a[96:99], a[120:123], v[96:99]
    v_mfma_f32_16x16x32_bf16 v[100:103], a[100:103], a[120:123], v[100:103]
    global_load_dwordx4 a[112:115], v6, s[38:39] offset:-1024
    v_mfma_f32_16x16x32_bf16 v[104:107], a[104:107], a[120:123], v[104:107]
    v_mfma_f32_16x16x32_bf16 v[108:111], a[108:111], a[120:123], v[108:111]
    v_mfma_f32_16x16x32_bf16 v[112:115], a[96:99], a[124:127], v[112:115]
    v_mfma_f32_16x16x32_bf16 v[116:119], a[100:103], a[124:127], v[116:119]
    v_mfma_f32_16x16x32_bf16 v[120:123], a[104:107], a[124:127], v[120:123]
    v_mfma_f32_16x16x32_bf16 v[124:127], a[108:111], a[124:127], v[124:127]
    s_waitcnt vmcnt(13)
    v_mfma_f32_16x16x32_bf16 v[80:83], a[128:131], a[148:151], v[80:83]
    v_mfma_f32_16x16x32_bf16 v[84:87], a[132:135], a[148:151], v[84:87]
    global_load_dwordx4 a[144:147], v6, s[38:39] offset:0
    v_mfma_f32_16x16x32_bf16 v[88:91], a[136:139], a[148:151], v[88:91]
    v_mfma_f32_16x16x32_bf16 v[92:95], a[140:143], a[148:151], v[92:95]
    global_load_dwordx4 a[176:179], v6, s[38:39] offset:1024
    v_mfma_f32_16x16x32_bf16 v[96:99], a[128:131], a[152:155], v[96:99]
    v_mfma_f32_16x16x32_bf16 v[100:103], a[132:135], a[152:155], v[100:103]
    v_mfma_f32_16x16x32_bf16 v[104:107], a[136:139], a[152:155], v[104:107]
    v_mfma_f32_16x16x32_bf16 v[108:111], a[140:143], a[152:155], v[108:111]
    v_mfma_f32_16x16x32_bf16 v[112:115], a[128:131], a[156:159], v[112:115]
    v_mfma_f32_16x16x32_bf16 v[116:119], a[132:135], a[156:159], v[116:119]
    v_mfma_f32_16x16x32_bf16 v[120:123], a[136:139], a[156:159], v[120:123]
    v_mfma_f32_16x16x32_bf16 v[124:127], a[140:143], a[156:159], v[124:127]
    s_waitcnt vmcnt(8)
    v_mfma_f32_16x16x32_bf16 v[80:83], a[160:163], a[180:183], v[80:83]
    v_mfma_f32_16x16x32_bf16 v[84:87], a[164:167], a[180:183], v[84:87]
    v_mfma_f32_16x16x32_bf16 v[88:91], a[168:171], a[180:183], v[88:91]
    v_mfma_f32_16x16x32_bf16 v[92:95], a[172:175], a[180:183], v[92:95]
    v_mfma_f32_16x16x32_bf16 v[96:99], a[160:163], a[184:187], v[96:99]
    v_mfma_f32_16x16x32_bf16 v[100:103], a[164:167], a[184:187], v[100:103]
    v_mfma_f32_16x16x32_bf16 v[104:107], a[168:171], a[184:187], v[104:107]
    v_mfma_f32_16x16x32_bf16 v[108:111], a[172:175], a[184:187], v[108:111]
    v_mfma_f32_16x16x32_bf16 v[112:115], a[160:163], a[188:191], v[112:115]
    v_mfma_f32_16x16x32_bf16 v[116:119], a[164:167], a[188:191], v[116:119]
    v_mfma_f32_16x16x32_bf16 v[120:123], a[168:171], a[188:191], v[120:123]
    v_mfma_f32_16x16x32_bf16 v[124:127], a[172:175], a[188:191], v[124:127]
    s_waitcnt vmcnt(7)
    v_mfma_f32_16x16x32_bf16 v[64:67], a[192:195], a[208:211], v[64:67]
    v_mfma_f32_16x16x32_bf16 v[68:71], a[196:199], a[208:211], v[68:71]
    v_mfma_f32_16x16x32_bf16 v[72:75], a[200:203], a[208:211], v[72:75]
    v_mfma_f32_16x16x32_bf16 v[76:79], a[204:207], a[208:211], v[76:79]
    ds_write_b128 v8, v[80:83] offset:0
    ds_write_b128 v8, v[84:87] offset:1024
    ds_write_b128 v8, v[88:91] offset:2048
    ds_write_b128 v8, v[92:95] offset:3072
    s_waitcnt vmcnt(6)
    v_mfma_f32_16x16x32_bf16 v[64:67], a[224:227], a[240:243], v[64:67]
    v_mfma_f32_16x16x32_bf16 v[68:71], a[228:231], a[240:243], v[68:71]
    v_mfma_f32_16x16x32_bf16 v[72:75], a[232:235], a[240:243], v[72:75]
    v_mfma_f32_16x16x32_bf16 v[76:79], a[236:239], a[240:243], v[76:79]
    ds_write_b128 v9, v[96:99] offset:0
    ds_write_b128 v9, v[100:103] offset:1024
    ds_write_b128 v9, v[104:107] offset:2048
    ds_write_b128 v9, v[108:111] offset:3072
    s_waitcnt vmcnt(5)
    v_mfma_f32_16x16x32_bf16 v[64:67], a[0:3], a[16:19], v[64:67]
    v_mfma_f32_16x16x32_bf16 v[68:71], a[4:7], a[16:19], v[68:71]
    v_mfma_f32_16x16x32_bf16 v[72:75], a[8:11], a[16:19], v[72:75]
    v_mfma_f32_16x16x32_bf16 v[76:79], a[12:15], a[16:19], v[76:79]
    ds_write_b128 v10, v[112:115] offset:0
    ds_write_b128 v10, v[116:119] offset:1024
    ds_write_b128 v10, v[120:123] offset:2048
    ds_write_b128 v10, v[124:127] offset:3072
    s_waitcnt vmcnt(4)
    v_mfma_f32_16x16x32_bf16 v[64:67], a[32:35], a[48:51], v[64:67]
    v_lshlrev_b32 v32, 16, v16
    v_and_b32 v33, 0xffff0000, v16
    v_mfma_f32_16x16x32_bf16 v[68:71], a[36:39], a[48:51], v[68:71]
    v_lshlrev_b32 v34, 16, v17
    v_and_b32 v35, 0xffff0000, v17
    v_mfma_f32_16x16x32_bf16 v[72:75], a[40:43], a[48:51], v[72:75]
    v_lshlrev_b32 v36, 16, v18
    v_and_b32 v37, 0xffff0000, v18
    v_mfma_f32_16x16x32_bf16 v[76:79], a[44:47], a[48:51], v[76:79]
    v_lshlrev_b32 v38, 16, v19
    v_and_b32 v39, 0xffff0000, v19
    v_lshlrev_b32 v40, 16, v20
    v_and_b32 v41, 0xffff0000, v20
    v_lshlrev_b32 v42, 16, v21
    v_and_b32 v43, 0xffff0000, v21
    v_lshlrev_b32 v44, 16, v22
    v_and_b32 v45, 0xffff0000, v22
    v_lshlrev_b32 v46, 16, v23
    v_and_b32 v47, 0xffff0000, v23
    s_waitcnt lgkmcnt(0)
    s_barrier
    ds_read_b128 v[128:131], v11 offset:0
    ds_read_b128 v[132:135], v11 offset:1024
    ds_read_b128 v[136:139], v11 offset:2048
    ds_read_b128 v[140:143], v11 offset:3072
    ds_read_b128 v[144:147], v11 offset:4096
    ds_read_b128 v[148:151], v11 offset:5120
    ds_read_b128 v[152:155], v11 offset:6144
    ds_read_b128 v[156:159], v11 offset:7168
    ds_read_b128 v[160:163], v11 offset:8192
    ds_read_b128 v[164:167], v11 offset:9216
    ds_read_b128 v[168:171], v11 offset:10240
    ds_read_b128 v[172:175], v11 offset:11264
    s_waitcnt vmcnt(3)
    v_mfma_f32_16x16x32_bf16 v[64:67], a[64:67], a[80:83], v[64:67]
    s_waitcnt lgkmcnt(4)
    v_add_f32 v128, v128, v144
    v_add_f32 v129, v129, v145
    v_mfma_f32_16x16x32_bf16 v[68:71], a[68:71], a[80:83], v[68:71]
    v_add_f32 v130, v130, v146
    v_add_f32 v131, v131, v147
    v_mfma_f32_16x16x32_bf16 v[72:75], a[72:75], a[80:83], v[72:75]
    v_add_f32 v132, v132, v148
    v_add_f32 v133, v133, v149
    v_mfma_f32_16x16x32_bf16 v[76:79], a[76:79], a[80:83], v[76:79]
    v_add_f32 v134, v134, v150
    v_add_f32 v135, v135, v151
    s_waitcnt vmcnt(2)
    v_mfma_f32_16x16x32_bf16 v[64:67], a[96:99], a[112:115], v[64:67]
    v_add_f32 v136, v136, v152
    v_add_f32 v137, v137, v153
    v_mfma_f32_16x16x32_bf16 v[68:71], a[100:103], a[112:115], v[68:71]
    v_add_f32 v138, v138, v154
    v_add_f32 v139, v139, v155
    v_mfma_f32_16x16x32_bf16 v[72:75], a[104:107], a[112:115], v[72:75]
    v_add_f32 v140, v140, v156
    v_add_f32 v141, v141, v157
    v_mfma_f32_16x16x32_bf16 v[76:79], a[108:111], a[112:115], v[76:79]
    v_add_f32 v142, v142, v158
    v_add_f32 v143, v143, v159
    s_waitcnt vmcnt(1)
    v_mfma_f32_16x16x32_bf16 v[64:67], a[128:131], a[144:147], v[64:67]
    s_waitcnt lgkmcnt(0)
    v_add_f32 v128, v128, v160
    v_add_f32 v129, v129, v161
    v_mfma_f32_16x16x32_bf16 v[68:71], a[132:135], a[144:147], v[68:71]
    v_add_f32 v130, v130, v162
    v_add_f32 v131, v131, v163
    v_mfma_f32_16x16x32_bf16 v[72:75], a[136:139], a[144:147], v[72:75]
    v_add_f32 v132, v132, v164
    v_add_f32 v133, v133, v165
    v_mfma_f32_16x16x32_bf16 v[76:79], a[140:143], a[144:147], v[76:79]
    v_add_f32 v134, v134, v166
    v_add_f32 v135, v135, v167
    s_waitcnt vmcnt(0)
    v_mfma_f32_16x16x32_bf16 v[64:67], a[160:163], a[176:179], v[64:67]
    v_add_f32 v136, v136, v168
    v_add_f32 v137, v137, v169
    v_mfma_f32_16x16x32_bf16 v[68:71], a[164:167], a[176:179], v[68:71]
    v_add_f32 v138, v138, v170
    v_add_f32 v139, v139, v171
    v_mfma_f32_16x16x32_bf16 v[72:75], a[168:171], a[176:179], v[72:75]
    v_add_f32 v140, v140, v172
    v_add_f32 v141, v141, v173
    v_mfma_f32_16x16x32_bf16 v[76:79], a[172:175], a[176:179], v[76:79]
    v_add_f32 v142, v142, v174
    v_add_f32 v143, v143, v175
    v_add_f32 v64, v64, v128
    v_add_f32 v65, v65, v129
    v_add_f32 v66, v66, v130
    v_add_f32 v67, v67, v131
    v_add_f32 v68, v68, v132
    v_add_f32 v69, v69, v133
    v_add_f32 v70, v70, v134
    v_add_f32 v71, v71, v135
    v_add_f32 v72, v72, v136
    v_add_f32 v73, v73, v137
    v_add_f32 v74, v74, v138
    v_add_f32 v75, v75, v139
    v_add_f32 v76, v76, v140
    v_add_f32 v77, v77, v141
    v_add_f32 v78, v78, v142
    v_add_f32 v79, v79, v143
    v_permlane32_swap_b32 v64, v68
    v_permlane32_swap_b32 v72, v76
    v_permlane32_swap_b32 v65, v69
    v_permlane32_swap_b32 v73, v77
    v_permlane32_swap_b32 v66, v70
    v_permlane32_swap_b32 v74, v78
    v_permlane32_swap_b32 v67, v71
    v_permlane32_swap_b32 v75, v79
    v_permlane16_swap_b32 v64, v68
    v_permlane16_swap_b32 v72, v76
    v_permlane16_swap_b32 v65, v69
    v_permlane16_swap_b32 v73, v77
    v_permlane16_swap_b32 v66, v70
    v_permlane16_swap_b32 v74, v78
    v_permlane16_swap_b32 v67, v71
    v_permlane16_swap_b32 v75, v79
    v_add_f32 v64, v64, v32
    v_add_f32 v65, v65, v33
    v_add_f32 v66, v66, v34
    v_add_f32 v67, v67, v35
    v_add_f32 v68, v68, v36
    v_add_f32 v69, v69, v37
    v_add_f32 v70, v70, v38
    v_add_f32 v71, v71, v39
    v_add_f32 v72, v72, v40
    v_add_f32 v73, v73, v41
    v_add_f32 v74, v74, v42
    v_add_f32 v75, v75, v43
    v_add_f32 v76, v76, v44
    v_add_f32 v77, v77, v45
    v_add_f32 v78, v78, v46
    v_add_f32 v79, v79, v47
    v_cvt_pk_bf16_f32 v48, v64, v65
    v_cvt_pk_bf16_f32 v49, v66, v67
    v_cvt_pk_bf16_f32 v50, v68, v69
    v_cvt_pk_bf16_f32 v51, v70, v71
    v_cvt_pk_bf16_f32 v52, v72, v73
    v_cvt_pk_bf16_f32 v53, v74, v75
    v_cvt_pk_bf16_f32 v54, v76, v77
    v_cvt_pk_bf16_f32 v55, v78, v79
    s_add_u32 s48, s22, 25165824
    s_addc_u32 s49, s23, 0
    global_store_dwordx4 v7, v[48:51], s[48:49] sc1
    global_store_dwordx4 v7, v[52:55], s[48:49] offset:64 sc1
    v_mul_f32 v96, v64, v64
    v_mul_f32 v97, v65, v65
    v_mul_f32 v98, v66, v66
    v_mul_f32 v99, v67, v67
    v_mul_f32 v100, v68, v68
    v_mul_f32 v101, v69, v69
    v_mul_f32 v102, v70, v70
    v_mul_f32 v103, v71, v71
    v_mul_f32 v104, v72, v72
    v_mul_f32 v105, v73, v73
    v_mul_f32 v106, v74, v74
    v_mul_f32 v107, v75, v75
    v_mul_f32 v108, v76, v76
    v_mul_f32 v109, v77, v77
    v_mul_f32 v110, v78, v78
    v_mul_f32 v111, v79, v79
    s_lshl_b32 s26, s25, 2
    s_add_u32 s26, s26, s3
    s_cmp_eq_u32 s26, 31
    s_cbranch_scc0 down0_nomask
    v_cmp_eq_u32 vcc, 15, v4
    s_nop 1
    v_cndmask_b32_e64 v96, v96, 0, vcc
    v_cndmask_b32_e64 v97, v97, 0, vcc
    v_cndmask_b32_e64 v98, v98, 0, vcc
    v_cndmask_b32_e64 v99, v99, 0, vcc
    v_cndmask_b32_e64 v100, v100, 0, vcc
    v_cndmask_b32_e64 v101, v101, 0, vcc
    v_cndmask_b32_e64 v102, v102, 0, vcc
    v_cndmask_b32_e64 v103, v103, 0, vcc
    v_cndmask_b32_e64 v104, v104, 0, vcc
    v_cndmask_b32_e64 v105, v105, 0, vcc
    v_cndmask_b32_e64 v106, v106, 0, vcc
    v_cndmask_b32_e64 v107, v107, 0, vcc
    v_cndmask_b32_e64 v108, v108, 0, vcc
    v_cndmask_b32_e64 v109, v109, 0, vcc
    v_cndmask_b32_e64 v110, v110, 0, vcc
    v_cndmask_b32_e64 v111, v111, 0, vcc
down0_nomask:
    v_add_f32_dpp v96, v96, v96 row_mirror row_mask:0xf bank_mask:0x3
    v_add_f32_dpp v97, v97, v97 row_mirror row_mask:0xf bank_mask:0x3
    v_add_f32_dpp v98, v98, v98 row_mirror row_mask:0xf bank_mask:0x3
    v_add_f32_dpp v99, v99, v99 row_mirror row_mask:0xf bank_mask:0x3
    v_add_f32_dpp v100, v100, v100 row_mirror row_mask:0xf bank_mask:0x3
    v_add_f32_dpp v101, v101, v101 row_mirror row_mask:0xf bank_mask:0x3
    v_add_f32_dpp v102, v102, v102 row_mirror row_mask:0xf bank_mask:0x3
    v_add_f32_dpp v103, v103, v103 row_mirror row_mask:0xf bank_mask:0x3
    v_add_f32_dpp v96, v104, v104 row_mirror row_mask:0xf bank_mask:0xc
    v_add_f32_dpp v97, v105, v105 row_mirror row_mask:0xf bank_mask:0xc
    v_add_f32_dpp v98, v106, v106 row_mirror row_mask:0xf bank_mask:0xc
    v_add_f32_dpp v99, v107, v107 row_mirror row_mask:0xf bank_mask:0xc
    v_add_f32_dpp v100, v108, v108 row_mirror row_mask:0xf bank_mask:0xc
    v_add_f32_dpp v101, v109, v109 row_mirror row_mask:0xf bank_mask:0xc
    v_add_f32_dpp v102, v110, v110 row_mirror row_mask:0xf bank_mask:0xc
    v_add_f32_dpp v103, v111, v111 row_mirror row_mask:0xf bank_mask:0xc
    v_add_f32_dpp v96, v96, v96 row_half_mirror row_mask:0xf bank_mask:0x5
    v_add_f32_dpp v97, v97, v97 row_half_mirror row_mask:0xf bank_mask:0x5
    v_add_f32_dpp v98, v98, v98 row_half_mirror row_mask:0xf bank_mask:0x5
    v_add_f32_dpp v99, v99, v99 row_half_mirror row_mask:0xf bank_mask:0x5
    v_add_f32_dpp v96, v100, v100 row_half_mirror row_mask:0xf bank_mask:0xa
    v_add_f32_dpp v97, v101, v101 row_half_mirror row_mask:0xf bank_mask:0xa
    v_add_f32_dpp v98, v102, v102 row_half_mirror row_mask:0xf bank_mask:0xa
    v_add_f32_dpp v99, v103, v103 row_half_mirror row_mask:0xf bank_mask:0xa
    v_add_f32_dpp v96, v96, v96 quad_perm:[2,3,0,1] row_mask:0xf bank_mask:0xf
    v_add_f32_dpp v97, v97, v97 quad_perm:[2,3,0,1] row_mask:0xf bank_mask:0xf
    v_add_f32_dpp v98, v98, v98 quad_perm:[2,3,0,1] row_mask:0xf bank_mask:0xf
    v_add_f32_dpp v99, v99, v99 quad_perm:[2,3,0,1] row_mask:0xf bank_mask:0xf
    v_add_f32_dpp v96, v96, v96 quad_perm:[1,0,3,2] row_mask:0xf bank_mask:0xf
    v_add_f32_dpp v97, v97, v97 quad_perm:[1,0,3,2] row_mask:0xf bank_mask:0xf
    v_add_f32_dpp v98, v98, v98 quad_perm:[1,0,3,2] row_mask:0xf bank_mask:0xf
    v_add_f32_dpp v99, v99, v99 quad_perm:[1,0,3,2] row_mask:0xf bank_mask:0xf
    v_and_b32 v12, 1, v0
    v_cmp_eq_u32 vcc, 1, v12
    s_nop 1
    v_cndmask_b32 v96, v96, v97, vcc
    v_cndmask_b32 v98, v98, v99, vcc
    v_and_b32 v12, 2, v0
    v_cmp_eq_u32 vcc, 2, v12
    s_nop 1
    v_cndmask_b32 v96, v96, v98, vcc
    v_lshlrev_b32 v12, 2, v0
    ds_write_b32 v12, v96 offset:49152
    s_waitcnt lgkmcnt(0)
    s_barrier
    s_cmp_eq_u32 s3, 0
    s_cbranch_scc0 down0_end
    ds_read_b32 v100, v12 offset:49152
    ds_read_b32 v101, v12 offset:49408
    ds_read_b32 v102, v12 offset:49664
    ds_read_b32 v103, v12 offset:49920
    s_lshl_b32 s26, s24, 8
    s_add_u32 s26, s26, 29360128
    v_bfe_u32 v13, v0, 3, 1
    v_lshlrev_b32 v13, 5, v13
    v_lshl_add_u32 v13, v3, 3, v13
    v_and_b32 v12, 7, v0
    v_add_u32 v12, v12, v13
    v_lshlrev_b32 v12, 2, v12
    v_add_u32 v12, s26, v12
    s_waitcnt lgkmcnt(0)
    v_add_f32 v100, v100, v101
    v_add_f32 v102, v102, v103
    v_add_f32 v100, v100, v102
    global_atomic_add_f32 v12, v100, s[22:23]
down0_end:
down0_end2:
    s_endpgm
.globl down1_kernel
.p2align 8
.type down1_kernel,@function
down1_kernel:
    s_cmp_ge_u32 s2, 256
    s_cbranch_scc1 down1_end2
    s_load_dwordx16 s[4:19], s[0:1], 0
    s_load_dwordx4 s[20:23], s[0:1], 64
    v_lshrrev_b32 v1, 6, v0
    v_and_b32 v2, 63, v0
    v_readfirstlane_b32 s3, v1
    v_bfe_u32 v3, v0, 4, 2
    v_and_b32 v4, 15, v0
    s_and_b32 s26, s2, 7
    s_lshl_b32 s26, s26, 2
    s_lshr_b32 s27, s2, 6
    s_add_u32 s24, s26, s27
    s_bfe_u32 s25, s2, 0x30003
    s_mul_i32 s26, s3, 14336
    s_add_u32 s26, s26, 4096
    v_lshl_add_u32 v5, v2, 4, s26
    v_add_u32 v6, 8192, v5
    s_mul_i32 s26, s24, 229376
    s_add_u32 s26, s26, 34603008
    s_mul_i32 s27, s25, 229376
    s_add_u32 s27, s27, 18874368
    s_lshl_b32 s28, s24, 2
    s_add_u32 s28, s28, s3
    s_lshl_b32 s28, s28, 14
    s_lshl_b32 s46, s25, 11
    s_add_u32 s28, s28, s46
    v_lshl_add_u32 v7, v2, 4, s28
    s_waitcnt lgkmcnt(0)
    s_add_u32 s30, s22, s27
    s_addc_u32 s31, s23, 0
    s_add_u32 s46, s22, 23068672
    s_addc_u32 s47, s23, 0
    global_load_dwordx4 v[16:19], v7, s[46:47]
    global_load_dwordx4 v[20:23], v7, s[46:47] offset:1024
    s_add_u32 s32, s30, 57344
    s_addc_u32 s33, s31, 0
    s_add_u32 s34, s32, 57344
    s_addc_u32 s35, s33, 0
    s_add_u32 s36, s34, 57344
    s_addc_u32 s37, s35, 0
    s_xor_b32 s28, s3, 0
    s_mul_i32 s28, s28, 57344
    s_add_u32 s28, s28, s26
    s_add_u32 s38, s22, s28
    s_addc_u32 s39, s23, 0
    s_xor_b32 s28, s3, 1
    s_mul_i32 s28, s28, 57344
    s_add_u32 s28, s28, s26
    s_add_u32 s40, s22, s28
    s_addc_u32 s41, s23, 0
    s_xor_b32 s28, s3, 2
    s_mul_i32 s28, s28, 57344
    s_add_u32 s28, s28, s26
    s_add_u32 s42, s22, s28
    s_addc_u32 s43, s23, 0
    s_xor_b32 s28, s3, 3
    s_mul_i32 s28, s28, 57344
    s_add_u32 s28, s28, s26
    s_add_u32 s44, s22, s28
    s_addc_u32 s45, s23, 0
    global_load_dwordx4 a[16:19], v5, s[38:39] offset:-4096
    global_load_dwordx4 a[0:3], v5, s[30:31] offset:-4096
    global_load_dwordx4 a[4:7], v5, s[32:33] offset:-4096
    global_load_dwordx4 a[8:11], v5, s[34:35] offset:-4096
    global_load_dwordx4 a[12:15], v5, s[36:37] offset:-4096
    global_load_dwordx4 a[20:23], v5, s[40:41] offset:-4096
    global_load_dwordx4 a[24:27], v5, s[42:43] offset:-4096
    global_load_dwordx4 a[28:31], v5, s[44:45] offset:-4096
    global_load_dwordx4 a[48:51], v5, s[38:39] offset:-3072
    global_load_dwordx4 a[32:35], v5, s[30:31] offset:-3072
    global_load_dwordx4 a[36:39], v5, s[32:33] offset:-3072
    global_load_dwordx4 a[40:43], v5, s[34:35] offset:-3072
    global_load_dwordx4 a[44:47], v5, s[36:37] offset:-3072
    global_load_dwordx4 a[52:55], v5, s[40:41] offset:-3072
    global_load_dwordx4 a[56:59], v5, s[42:43] offset:-3072
    global_load_dwordx4 a[60:63], v5, s[44:45] offset:-3072
    global_load_dwordx4 a[80:83], v5, s[38:39] offset:-2048
    global_load_dwordx4 a[64:67], v5, s[30:31] offset:-2048
    global_load_dwordx4 a[68:71], v5, s[32:33] offset:-2048
    global_load_dwordx4 a[72:75], v5, s[34:35] offset:-2048
    global_load_dwordx4 a[76:79], v5, s[36:37] offset:-2048
    global_load_dwordx4 a[84:87], v5, s[40:41] offset:-2048
    global_load_dwordx4 a[88:91], v5, s[42:43] offset:-2048
    global_load_dwordx4 a[92:95], v5, s[44:45] offset:-2048
    global_load_dwordx4 a[112:115], v5, s[38:39] offset:-1024
    global_load_dwordx4 a[96:99], v5, s[30:31] offset:-1024
    global_load_dwordx4 a[100:103], v5, s[32:33] offset:-1024
    global_load_dwordx4 a[104:107], v5, s[34:35] offset:-1024
    global_load_dwordx4 a[108:111], v5, s[36:37] offset:-1024
    global_load_dwordx4 a[116:119], v5, s[40:41] offset:-1024
    global_load_dwordx4 a[120:123], v5, s[42:43] offset:-1024
    global_load_dwordx4 a[124:127], v5, s[44:45] offset:-1024
    s_xor_b32 s28, s3, 1
    s_mul_i32 s28, s28, 3
    s_add_u32 s28, s28, 0
    s_lshl_b32 s28, s28, 12
    v_lshl_add_u32 v8, v2, 4, s28
    s_xor_b32 s28, s3, 2
    s_mul_i32 s28, s28, 3
    s_add_u32 s28, s28, 1
    s_lshl_b32 s28, s28, 12
    v_lshl_add_u32 v9, v2, 4, s28
    s_xor_b32 s28, s3, 3
    s_mul_i32 s28, s28, 3
    s_add_u32 s28, s28, 2
    s_lshl_b32 s28, s28, 12
    v_lshl_add_u32 v10, v2, 4, s28
    s_mul_i32 s28, s3, 12288
    v_lshl_add_u32 v11, v2, 4, s28
    s_bfe_u32 s28, s24, 0x30001
    s_lshl_b32 s28, s28, 8
    s_lshl_b32 s26, s3, 1
    s_add_u32 s28, s28, s26
    s_and_b32 s26, s24, 1
    s_lshl_b32 s26, s26, 3
    s_add_u32 s28, s28, s26
    s_lshr_b32 s26, s24, 4
    s_lshl_b32 s26, s26, 4
    s_add_u32 s28, s28, s26
    s_lshl_b32 s28, s28, 10
    s_lshl_b32 s26, s25, 7
    s_add_u32 s28, s28, s26
    v_and_b32 v12, 7, v4
    v_lshlrev_b32 v12, 15, v12
    v_lshrrev_b32 v13, 3, v4
    v_lshl_add_u32 v12, v13, 10, v12
    v_lshl_add_u32 v12, v3, 4, v12
    v_add_u32 v12, s28, v12
    s_waitcnt vmcnt(24)
    v_mfma_f32_16x16x32_bf16 v[64:67], a[0:3], a[16:19], 0
    v_mfma_f32_16x16x32_bf16 v[68:71], a[4:7], a[16:19], 0
    global_load_dwordx4 a[144:147], v5, s[38:39] offset:0
    v_mfma_f32_16x16x32_bf16 v[72:75], a[8:11], a[16:19], 0
    v_mfma_f32_16x16x32_bf16 v[76:79], a[12:15], a[16:19], 0
    global_load_dwordx4 a[128:131], v5, s[30:31] offset:0
    v_mfma_f32_16x16x32_bf16 v[80:83], a[0:3], a[20:23], 0
    v_mfma_f32_16x16x32_bf16 v[84:87], a[4:7], a[20:23], 0
    global_load_dwordx4 a[132:135], v5, s[32:33] offset:0
    v_mfma_f32_16x16x32_bf16 v[88:91], a[8:11], a[20:23], 0
    v_mfma_f32_16x16x32_bf16 v[92:95], a[12:15], a[20:23], 0
    global_load_dwordx4 a[136:139], v5, s[34:35] offset:0
    v_mfma_f32_16x16x32_bf16 v[96:99], a[0:3], a[24:27], 0
    v_mfma_f32_16x16x32_bf16 v[100:103], a[4:7], a[24:27], 0
    global_load_dwordx4 a[140:143], v5, s[36:37] offset:0
    v_mfma_f32_16x16x32_bf16 v[104:107], a[8:11], a[24:27], 0
    v_mfma_f32_16x16x32_bf16 v[108:111], a[12:15], a[24:27], 0
    global_load_dwordx4 a[148:151], v5, s[40:41] offset:0
    v_mfma_f32_16x16x32_bf16 v[112:115], a[0:3], a[28:31], 0
    v_mfma_f32_16x16x32_bf16 v[116:119], a[4:7], a[28:31], 0
    global_load_dwordx4 a[152:155], v5, s[42:43] offset:0
    v_mfma_f32_16x16x32_bf16 v[120:123], a[8:11], a[28:31], 0
    v_mfma_f32_16x16x32_bf16 v[124:127], a[12:15], a[28:31], 0
    global_load_dwordx4 a[156:159], v5, s[44:45] offset:0
    s_waitcnt vmcnt(24)
    v_mfma_f32_16x16x32_bf16 v[64:67], a[32:35], a[48:51], v[64:67]
    v_mfma_f32_16x16x32_bf16 v[68:71], a[36:39], a[48:51], v[68:71]
    global_load_dwordx4 a[176:179], v5, s[38:39] offset:1024
    v_mfma_f32_16x16x32_bf16 v[72:75], a[40:43], a[48:51], v[72:75]
    v_mfma_f32_16x16x32_bf16 v[76:79], a[44:47], a[48:51], v[76:79]
    global_load_dwordx4 a[160:163], v5, s[30:31] offset:1024
    v_mfma_f32_16x16x32_bf16 v[80:83], a[32:35], a[52:55], v[80:83]
    v_mfma_f32_16x16x32_bf16 v[84:87], a[36:39], a[52:55], v[84:87]
    global_load_dwordx4 a[164:167], v5, s[32:33] offset:1024
    v_mfma_f32_16x16x32_bf16 v[88:91], a[40:43], a[52:55], v[88:91]
    v_mfma_f32_16x16x32_bf16 v[92:95], a[44:47], a[52:55], v[92:95]
    global_load_dwordx4 a[168:171], v5, s[34:35] offset:1024
    v_mfma_f32_16x16x32_bf16 v[96:99], a[32:35], a[56:59], v[96:99]
    v_mfma_f32_16x16x32_bf16 v[100:103], a[36:39], a[56:59], v[100:103]
    global_load_dwordx4 a[172:175], v5, s[36:37] offset:1024
    v_mfma_f32_16x16x32_bf16 v[104:107], a[40:43], a[56:59], v[104:107]
    v_mfma_f32_16x16x32_bf16 v[108:111], a[44:47], a[56:59], v[108:111]
    global_load_dwordx4 a[180:183], v5, s[40:41] offset:1024
    v_mfma_f32_16x16x32_bf16 v[112:115], a[32:35], a[60:63], v[112:115]
    v_mfma_f32_16x16x32_bf16 v[116:119], a[36:39], a[60:63], v[116:119]
    global_load_dwordx4 a[184:187], v5, s[42:43] offset:1024
    v_mfma_f32_16x16x32_bf16 v[120:123], a[40:43], a[60:63], v[120:123]
    v_mfma_f32_16x16x32_bf16 v[124:127], a[44:47], a[60:63], v[124:127]
    global_load_dwordx4 a[188:191], v5, s[44:45] offset:1024
    s_waitcnt vmcnt(24)
    v_mfma_f32_16x16x32_bf16 v[64:67], a[64:67], a[80:83], v[64:67]
    v_mfma_f32_16x16x32_bf16 v[68:71], a[68:71], a[80:83], v[68:71]
    global_load_dwordx4 a[192:195], v5, s[30:31] offset:2048
    v_mfma_f32_16x16x32_bf16 v[72:75], a[72:75], a[80:83], v[72:75]
    v_mfma_f32_16x16x32_bf16 v[76:79], a[76:79], a[80:83], v[76:79]
    global_load_dwordx4 a[196:199], v5, s[32:33] offset:2048
    v_mfma_f32_16x16x32_bf16 v[80:83], a[64:67], a[84:87], v[80:83]
    v_mfma_f32_16x16x32_bf16 v[84:87], a[68:71], a[84:87], v[84:87]
    global_load_dwordx4 a[200:203], v5, s[34:35] offset:2048
    v_mfma_f32_16x16x32_bf16 v[88:91], a[72:75], a[84:87], v[88:91]
    v_mfma_f32_16x16x32_bf16 v[92:95], a[76:79], a[84:87], v[92:95]
    global_load_dwordx4 a[204:207], v5, s[36:37] offset:2048
    v_mfma_f32_16x16x32_bf16 v[96:99], a[64:67], a[88:91], v[96:99]
    v_mfma_f32_16x16x32_bf16 v[100:103], a[68:71], a[88:91], v[100:103]
    global_load_dwordx4 a[212:215], v5, s[40:41] offset:2048
    v_mfma_f32_16x16x32_bf16 v[104:107], a[72:75], a[88:91], v[104:107]
    v_mfma_f32_16x16x32_bf16 v[108:111], a[76:79], a[88:91], v[108:111]
    global_load_dwordx4 a[216:219], v5, s[42:43] offset:2048
    v_mfma_f32_16x16x32_bf16 v[112:115], a[64:67], a[92:95], v[112:115]
    v_mfma_f32_16x16x32_bf16 v[116:119], a[68:71], a[92:95], v[116:119]
    global_load_dwordx4 a[220:223], v5, s[44:45] offset:2048
    v_mfma_f32_16x16x32_bf16 v[120:123], a[72:75], a[92:95], v[120:123]
    v_mfma_f32_16x16x32_bf16 v[124:127], a[76:79], a[92:95], v[124:127]
    s_waitcnt vmcnt(23)
    v_mfma_f32_16x16x32_bf16 v[64:67], a[96:99], a[112:115], v[64:67]
    v_mfma_f32_16x16x32_bf16 v[68:71], a[100:103], a[112:115], v[68:71]
    global_load_dwordx4 a[224:227], v5, s[30:31] offset:3072
    v_mfma_f32_16x16x32_bf16 v[72:75], a[104:107], a[112:115], v[72:75]
    v_mfma_f32_16x16x32_bf16 v[76:79], a[108:111], a[112:115], v[76:79]
    global_load_dwordx4 a[228:231], v5, s[32:33] offset:3072
    v_mfma_f32_16x16x32_bf16 v[80:83], a[96:99], a[116:119], v[80:83]
    v_mfma_f32_16x16x32_bf16 v[84:87], a[100:103], a[116:119], v[84:87]
    global_load_dwordx4 a[232:235], v5, s[34:35] offset:3072
    v_mfma_f32_16x16x32_bf16 v[88:91], a[104:107], a[116:119], v[88:91]
    v_mfma_f32_16x16x32_bf16 v[92:95], a[108:111], a[116:119], v[92:95]
    global_load_dwordx4 a[236:239], v5, s[36:37] offset:3072
    v_mfma_f32_16x16x32_bf16 v[96:99], a[96:99], a[120:123], v[96:99]
    v_mfma_f32_16x16x32_bf16 v[100:103], a[100:103], a[120:123], v[100:103]
    global_load_dwordx4 a[244:247], v5, s[40:41] offset:3072
    v_mfma_f32_16x16x32_bf16 v[104:107], a[104:107], a[120:123], v[104:107]
    v_mfma_f32_16x16x32_bf16 v[108:111], a[108:111], a[120:123], v[108:111]
    global_load_dwordx4 a[248:251], v5, s[42:43] offset:3072
    v_mfma_f32_16x16x32_bf16 v[112:115], a[96:99], a[124:127], v[112:115]
    v_mfma_f32_16x16x32_bf16 v[116:119], a[100:103], a[124:127], v[116:119]
    global_load_dwordx4 a[252:255], v5, s[44:45] offset:3072
    v_mfma_f32_16x16x32_bf16 v[120:123], a[104:107], a[124:127], v[120:123]
    v_mfma_f32_16x16x32_bf16 v[124:127], a[108:111], a[124:127], v[124:127]
    s_waitcnt vmcnt(22)
    v_mfma_f32_16x16x32_bf16 v[64:67], a[128:131], a[144:147], v[64:67]
    v_mfma_f32_16x16x32_bf16 v[68:71], a[132:135], a[144:147], v[68:71]
    global_load_dwordx4 a[0:3], v6, s[30:31] offset:-4096
    v_mfma_f32_16x16x32_bf16 v[72:75], a[136:139], a[144:147], v[72:75]
    v_mfma_f32_16x16x32_bf16 v[76:79], a[140:143], a[144:147], v[76:79]
    global_load_dwordx4 a[4:7], v6, s[32:33] offset:-4096
    v_mfma_f32_16x16x32_bf16 v[80:83], a[128:131], a[148:151], v[80:83]
    v_mfma_f32_16x16x32_bf16 v[84:87], a[132:135], a[148:151], v[84:87]
    global_load_dwordx4 a[8:11], v6, s[34:35] offset:-4096
    v_mfma_f32_16x16x32_bf16 v[88:91], a[136:139], a[148:151], v[88:91]
    v_mfma_f32_16x16x32_bf16 v[92:95], a[140:143], a[148:151], v[92:95]
    global_load_dwordx4 a[12:15], v6, s[36:37] offset:-4096
    v_mfma_f32_16x16x32_bf16 v[96:99], a[128:131], a[152:155], v[96:99]
    v_mfma_f32_16x16x32_bf16 v[100:103], a[132:135], a[152:155], v[100:103]
    global_load_dwordx4 a[20:23], v6, s[40:41] offset:-4096
    v_mfma_f32_16x16x32_bf16 v[104:107], a[136:139], a[152:155], v[104:107]
    v_mfma_f32_16x16x32_bf16 v[108:111], a[140:143], a[152:155], v[108:111]
    global_load_dwordx4 a[24:27], v6, s[42:43] offset:-4096
    v_mfma_f32_16x16x32_bf16 v[112:115], a[128:131], a[156:159], v[112:115]
    v_mfma_f32_16x16x32_bf16 v[116:119], a[132:135], a[156:159], v[116:119]
    global_load_dwordx4 a[28:31], v6, s[44:45] offset:-4096
    v_mfma_f32_16x16x32_bf16 v[120:123], a[136:139], a[156:159], v[120:123]
    v_mfma_f32_16x16x32_bf16 v[124:127], a[140:143], a[156:159], v[124:127]
    s_waitcnt vmcnt(21)
    v_mfma_f32_16x16x32_bf16 v[64:67], a[160:163], a[176:179], v[64:67]
    v_mfma_f32_16x16x32_bf16 v[68:71], a[164:167], a[176:179], v[68:71]
    global_load_dwordx4 a[32:35], v6, s[30:31] offset:-3072
    v_mfma_f32_16x16x32_bf16 v[72:75], a[168:171], a[176:179], v[72:75]
    v_mfma_f32_16x16x32_bf16 v[76:79], a[172:175], a[176:179], v[76:79]
    global_load_dwordx4 a[36:39], v6, s[32:33] offset:-3072
    v_mfma_f32_16x16x32_bf16 v[80:83], a[160:163], a[180:183], v[80:83]
    v_mfma_f32_16x16x32_bf16 v[84:87], a[164:167], a[180:183], v[84:87]
    global_load_dwordx4 a[40:43], v6, s[34:35] offset:-3072
    v_mfma_f32_16x16x32_bf16 v[88:91], a[168:171], a[180:183], v[88:91]
    v_mfma_f32_16x16x32_bf16 v[92:95], a[172:175], a[180:183], v[92:95]
    global_load_dwordx4 a[44:47], v6, s[36:37] offset:-3072
    v_mfma_f32_16x16x32_bf16 v[96:99], a[160:163], a[184:187], v[96:99]
    v_mfma_f32_16x16x32_bf16 v[100:103], a[164:167], a[184:187], v[100:103]
    global_load_dwordx4 a[52:55], v6, s[40:41] offset:-3072
    v_mfma_f32_16x16x32_bf16 v[104:107], a[168:171], a[184:187], v[104:107]
    v_mfma_f32_16x16x32_bf16 v[108:111], a[172:175], a[184:187], v[108:111]
    global_load_dwordx4 a[56:59], v6, s[42:43] offset:-3072
    v_mfma_f32_16x16x32_bf16 v[112:115], a[160:163], a[188:191], v[112:115]
    v_mfma_f32_16x16x32_bf16 v[116:119], a[164:167], a[188:191], v[116:119]
    global_load_dwordx4 a[60:63], v6, s[44:45] offset:-3072
    v_mfma_f32_16x16x32_bf16 v[120:123], a[168:171], a[188:191], v[120:123]
    v_mfma_f32_16x16x32_bf16 v[124:127], a[172:175], a[188:191], v[124:127]
    s_waitcnt vmcnt(21)
    v_mfma_f32_16x16x32_bf16 v[80:83], a[192:195], a[212:215], v[80:83]
    global_load_dwordx4 a[64:67], v6, s[30:31] offset:-2048
    v_mfma_f32_16x16x32_bf16 v[84:87], a[196:199], a[212:215], v[84:87]
    global_load_dwordx4 a[68:71], v6, s[32:33] offset:-2048
    v_mfma_f32_16x16x32_bf16 v[88:91], a[200:203], a[212:215], v[88:91]
    global_load_dwordx4 a[72:75], v6, s[34:35] offset:-2048
    v_mfma_f32_16x16x32_bf16 v[92:95], a[204:207], a[212:215], v[92:95]
    global_load_dwordx4 a[76:79], v6, s[36:37] offset:-2048
    v_mfma_f32_16x16x32_bf16 v[96:99], a[192:195], a[216:219], v[96:99]
    global_load_dwordx4 a[84:87], v6, s[40:41] offset:-2048
    v_mfma_f32_16x16x32_bf16 v[100:103], a[196:199], a[216:219], v[100:103]
    global_load_dwordx4 a[88:91], v6, s[42:43] offset:-2048
    v_mfma_f32_16x16x32_bf16 v[104:107], a[200:203], a[216:219], v[104:107]
    global_load_dwordx4 a[92:95], v6, s[44:45] offset:-2048
    v_mfma_f32_16x16x32_bf16 v[108:111], a[204:207], a[216:219], v[108:111]
    v_mfma_f32_16x16x32_bf16 v[112:115], a[192:195], a[220:223], v[112:115]
    v_mfma_f32_16x16x32_bf16 v[116:119], a[196:199], a[220:223], v[116:119]
    v_mfma_f32_16x16x32_bf16 v[120:123], a[200:203], a[220:223], v[120:123]
    v_mfma_f32_16x16x32_bf16 v[124:127], a[204:207], a[220:223], v[124:127]
    s_waitcnt vmcnt(21)
    v_mfma_f32_16x16x32_bf16 v[80:83], a[224:227], a[244:247], v[80:83]
    global_load_dwordx4 a[96:99], v6, s[30:31] offset:-1024
    v_mfma_f32_16x16x32_bf16 v[84:87], a[228:231], a[244:247], v[84:87]
    global_load_dwordx4 a[100:103], v6, s[32:33] offset:-1024
    v_mfma_f32_16x16x32_bf16 v[88:91], a[232:235], a[244:247], v[88:91]
    global_load_dwordx4 a[104:107], v6, s[34:35] offset:-1024
    v_mfma_f32_16x16x32_bf16 v[92:95], a[236:239], a[244:247], v[92:95]
    global_load_dwordx4 a[108:111], v6, s[36:37] offset:-1024
    v_mfma_f32_16x16x32_bf16 v[96:99], a[224:227], a[248:251], v[96:99]
    global_load_dwordx4 a[116:119], v6, s[40:41] offset:-1024
    v_mfma_f32_16x16x32_bf16 v[100:103], a[228:231], a[248:251], v[100:103]
    global_load_dwordx4 a[120:123], v6, s[42:43] offset:-1024
    v_mfma_f32_16x16x32_bf16 v[104:107], a[232:235], a[248:251], v[104:107]
    global_load_dwordx4 a[124:127], v6, s[44:45] offset:-1024
    v_mfma_f32_16x16x32_bf16 v[108:111], a[236:239], a[248:251], v[108:111]
    v_mfma_f32_16x16x32_bf16 v[112:115], a[224:227], a[252:255], v[112:115]
    v_mfma_f32_16x16x32_bf16 v[116:119], a[228:231], a[252:255], v[116:119]
    v_mfma_f32_16x16x32_bf16 v[120:123], a[232:235], a[252:255], v[120:123]
    v_mfma_f32_16x16x32_bf16 v[124:127], a[236:239], a[252:255], v[124:127]
    s_waitcnt vmcnt(21)
    v_mfma_f32_16x16x32_bf16 v[80:83], a[0:3], a[20:23], v[80:83]
    global_load_dwordx4 a[128:131], v6, s[30:31] offset:0
    v_mfma_f32_16x16x32_bf16 v[84:87], a[4:7], a[20:23], v[84:87]
    global_load_dwordx4 a[132:135], v6, s[32:33] offset:0
    v_mfma_f32_16x16x32_bf16 v[88:91], a[8:11], a[20:23], v[88:91]
    global_load_dwordx4 a[136:139], v6, s[34:35] offset:0
    v_mfma_f32_16x16x32_bf16 v[92:95], a[12:15], a[20:23], v[92:95]
    global_load_dwordx4 a[140:143], v6, s[36:37] offset:0
    v_mfma_f32_16x16x32_bf16 v[96:99], a[0:3], a[24:27], v[96:99]
    global_load_dwordx4 a[148:151], v6, s[40:41] offset:0
    v_mfma_f32_16x16x32_bf16 v[100:103], a[4:7], a[24:27], v[100:103]
    global_load_dwordx4 a[152:155], v6, s[42:43] offset:0
    v_mfma_f32_16x16x32_bf16 v[104:107], a[8:11], a[24:27], v[104:107]
    global_load_dwordx4 a[156:159], v6, s[44:45] offset:0
    v_mfma_f32_16x16x32_bf16 v[108:111], a[12:15], a[24:27], v[108:111]
    v_mfma_f32_16x16x32_bf16 v[112:115], a[0:3], a[28:31], v[112:115]
    v_mfma_f32_16x16x32_bf16 v[116:119], a[4:7], a[28:31], v[116:119]
    v_mfma_f32_16x16x32_bf16 v[120:123], a[8:11], a[28:31], v[120:123]
    v_mfma_f32_16x16x32_bf16 v[124:127], a[12:15], a[28:31], v[124:127]
    s_waitcnt vmcnt(21)
    v_mfma_f32_16x16x32_bf16 v[80:83], a[32:35], a[52:55], v[80:83]
    global_load_dwordx4 a[160:163], v6, s[30:31] offset:1024
    v_mfma_f32_16x16x32_bf16 v[84:87], a[36:39], a[52:55], v[84:87]
    global_load_dwordx4 a[164:167], v6, s[32:33] offset:1024
    v_mfma_f32_16x16x32_bf16 v[88:91], a[40:43], a[52:55], v[88:91]
    global_load_dwordx4 a[168:171], v6, s[34:35] offset:1024
    v_mfma_f32_16x16x32_bf16 v[92:95], a[44:47], a[52:55], v[92:95]
    global_load_dwordx4 a[172:175], v6, s[36:37] offset:1024
    v_mfma_f32_16x16x32_bf16 v[96:99], a[32:35], a[56:59], v[96:99]
    global_load_dwordx4 a[180:183], v6, s[40:41] offset:1024
    v_mfma_f32_16x16x32_bf16 v[100:103], a[36:39], a[56:59], v[100:103]
    global_load_dwordx4 a[184:187], v6, s[42:43] offset:1024
    v_mfma_f32_16x16x32_bf16 v[104:107], a[40:43], a[56:59], v[104:107]
    global_load_dwordx4 a[188:191], v6, s[44:45] offset:1024
    v_mfma_f32_16x16x32_bf16 v[108:111], a[44:47], a[56:59], v[108:111]
    v_mfma_f32_16x16x32_bf16 v[112:115], a[32:35], a[60:63], v[112:115]
    v_mfma_f32_16x16x32_bf16 v[116:119], a[36:39], a[60:63], v[116:119]
    v_mfma_f32_16x16x32_bf16 v[120:123], a[40:43], a[60:63], v[120:123]
    v_mfma_f32_16x16x32_bf16 v[124:127], a[44:47], a[60:63], v[124:127]
    s_waitcnt vmcnt(21)
    v_mfma_f32_16x16x32_bf16 v[80:83], a[64:67], a[84:87], v[80:83]
    v_mfma_f32_16x16x32_bf16 v[84:87], a[68:71], a[84:87], v[84:87]
    global_load_dwordx4 a[208:211], v5, s[38:39] offset:2048
    v_mfma_f32_16x16x32_bf16 v[88:91], a[72:75], a[84:87], v[88:91]
    v_mfma_f32_16x16x32_bf16 v[92:95], a[76:79], a[84:87], v[92:95]
    global_load_dwordx4 a[240:243], v5, s[38:39] offset:3072
    v_mfma_f32_16x16x32_bf16 v[96:99], a[64:67], a[88:91], v[96:99]
    v_mfma_f32_16x16x32_bf16 v[100:103], a[68:71], a[88:91], v[100:103]
    global_load_dwordx4 a[16:19], v6, s[38:39] offset:-4096
    v_mfma_f32_16x16x32_bf16 v[104:107], a[72:75], a[88:91], v[104:107]
    v_mfma_f32_16x16x32_bf16 v[108:111], a[76:79], a[88:91], v[108:111]
    v_mfma_f32_16x16x32_bf16 v[112:115], a[64:67], a[92:95], v[112:115]
    v_mfma_f32_16x16x32_bf16 v[116:119], a[68:71], a[92:95], v[116:119]
    v_mfma_f32_16x16x32_bf16 v[120:123], a[72:75], a[92:95], v[120:123]
    v_mfma_f32_16x16x32_bf16 v[124:127], a[76:79], a[92:95], v[124:127]
    s_waitcnt vmcnt(17)
    v_mfma_f32_16x16x32_bf16 v[80:83], a[96:99], a[116:119], v[80:83]
    v_mfma_f32_16x16x32_bf16 v[84:87], a[100:103], a[116:119], v[84:87]
    global_load_dwordx4 a[48:51], v6, s[38:39] offset:-3072
    v_mfma_f32_16x16x32_bf16 v[88:91], a[104:107], a[116:119], v[88:91]
    v_mfma_f32_16x16x32_bf16 v[92:95], a[108:111], a[116:119], v[92:95]
    global_load_dwordx4 a[80:83], v6, s[38:39] offset:-2048
    v_mfma_f32_16x16x32_bf16 v[96:99], a[96:99], a[120:123], v[96:99]
    v_mfma_f32_16x16x32_bf16 v[100:103], a[100:103], a[120:123], v[100:103]
    global_load_dwordx4 a[112:115], v6, s[38:39] offset:-1024
    v_mfma_f32_16x16x32_bf16 v[104:107], a[104:107], a[120:123], v[104:107]
    v_mfma_f32_16x16x32_bf16 v[108:111], a[108:111], a[120:123], v[108:111]
    v_mfma_f32_16x16x32_bf16 v[112:115], a[96:99], a[124:127], v[112:115]
    v_mfma_f32_16x16x32_bf16 v[116:119], a[100:103], a[124:127], v[116:119]
    v_mfma_f32_16x16x32_bf16 v[120:123], a[104:107], a[124:127], v[120:123]
    v_mfma_f32_16x16x32_bf16 v[124:127], a[108:111], a[124:127], v[124:127]
    s_waitcnt vmcnt(13)
    v_mfma_f32_16x16x32_bf16 v[80:83], a[128:131], a[148:151], v[80:83]
    v_mfma_f32_16x16x32_bf16 v[84:87], a[132:135], a[148:151], v[84:87]
    global_load_dwordx4 a[144:147], v6, s[38:39] offset:0
    v_mfma_f32_16x16x32_bf16 v[88:91], a[136:139], a[148:151], v[88:91]
    v_mfma_f32_16x16x32_bf16 v[92:95], a[140:143], a[148:151], v[92:95]
    global_load_dwordx4 a[176:179], v6, s[38:39] offset:1024
    v_mfma_f32_16x16x32_bf16 v[96:99], a[128:131], a[152:155], v[96:99]
    v_mfma_f32_16x16x32_bf16 v[100:103], a[132:135], a[152:155], v[100:103]
    v_mfma_f32_16x16x32_bf16 v[104:107], a[136:139], a[152:155], v[104:107]
    v_mfma_f32_16x16x32_bf16 v[108:111], a[140:143], a[152:155], v[108:111]
    v_mfma_f32_16x16x32_bf16 v[112:115], a[128:131], a[156:159], v[112:115]
    v_mfma_f32_16x16x32_bf16 v[116:119], a[132:135], a[156:159], v[116:119]
    v_mfma_f32_16x16x32_bf16 v[120:123], a[136:139], a[156:159], v[120:123]
    v_mfma_f32_16x16x32_bf16 v[124:127], a[140:143], a[156:159], v[124:127]
    s_waitcnt vmcnt(8)
    v_mfma_f32_16x16x32_bf16 v[80:83], a[160:163], a[180:183], v[80:83]
    v_mfma_f32_16x16x32_bf16 v[84:87], a[164:167], a[180:183], v[84:87]
    v_mfma_f32_16x16x32_bf16 v[88:91], a[168:171], a[180:183], v[88:91]
    v_mfma_f32_16x16x32_bf16 v[92:95], a[172:175], a[180:183], v[92:95]
    v_mfma_f32_16x16x32_bf16 v[96:99], a[160:163], a[184:187], v[96:99]
    v_mfma_f32_16x16x32_bf16 v[100:103], a[164:167], a[184:187], v[100:103]
    v_mfma_f32_16x16x32_bf16 v[104:107], a[168:171], a[184:187], v[104:107]
    v_mfma_f32_16x16x32_bf16 v[108:111], a[172:175], a[184:187], v[108:111]
    v_mfma_f32_16x16x32_bf16 v[112:115], a[160:163], a[188:191], v[112:115]
    v_mfma_f32_16x16x32_bf16 v[116:119], a[164:167], a[188:191], v[116:119]
    v_mfma_f32_16x16x32_bf16 v[120:123], a[168:171], a[188:191], v[120:123]
    v_mfma_f32_16x16x32_bf16 v[124:127], a[172:175], a[188:191], v[124:127]
    s_waitcnt vmcnt(7)
    v_mfma_f32_16x16x32_bf16 v[64:67], a[192:195], a[208:211], v[64:67]
    v_mfma_f32_16x16x32_bf16 v[68:71], a[196:199], a[208:211], v[68:71]
    v_mfma_f32_16x16x32_bf16 v[72:75], a[200:203], a[208:211], v[72:75]
    v_mfma_f32_16x16x32_bf16 v[76:79], a[204:207], a[208:211], v[76:79]
    ds_write_b128 v8, v[80:83] offset:0
    ds_write_b128 v8, v[84:87] offset:1024
    ds_write_b128 v8, v[88:91] offset:2048
    ds_write_b128 v8, v[92:95] offset:3072
    s_waitcnt vmcnt(6)
    v_mfma_f32_16x16x32_bf16 v[64:67], a[224:227], a[240:243], v[64:67]
    v_mfma_f32_16x16x32_bf16 v[68:71], a[228:231], a[240:243], v[68:71]
    v_mfma_f32_16x16x32_bf16 v[72:75], a[232:235], a[240:243], v[72:75]
    v_mfma_f32_16x16x32_bf16 v[76:79], a[236:239], a[240:243], v[76:79]
    ds_write_b128 v9, v[96:99] offset:0
    ds_write_b128 v9, v[100:103] offset:1024
    ds_write_b128 v9, v[104:107] offset:2048
    ds_write_b128 v9, v[108:111] offset:3072
    s_waitcnt vmcnt(5)
    v_mfma_f32_16x16x32_bf16 v[64:67], a[0:3], a[16:19], v[64:67]
    v_mfma_f32_16x16x32_bf16 v[68:71], a[4:7], a[16:19], v[68:71]
    v_mfma_f32_16x16x32_bf16 v[72:75], a[8:11], a[16:19], v[72:75]
    v_mfma_f32_16x16x32_bf16 v[76:79], a[12:15], a[16:19], v[76:79]
    ds_write_b128 v10, v[112:115] offset:0
    ds_write_b128 v10, v[116:119] offset:1024
    ds_write_b128 v10, v[120:123] offset:2048
    ds_write_b128 v10, v[124:127] offset:3072
    s_waitcnt vmcnt(4)
    v_mfma_f32_16x16x32_bf16 v[64:67], a[32:35], a[48:51], v[64:67]
    v_lshlrev_b32 v32, 16, v16
    v_and_b32 v33, 0xffff0000, v16
    v_mfma_f32_16x16x32_bf16 v[68:71], a[36:39], a[48:51], v[68:71]
    v_lshlrev_b32 v34, 16, v17
    v_and_b32 v35, 0xffff0000, v17
    v_mfma_f32_16x16x32_bf16 v[72:75], a[40:43], a[48:51], v[72:75]
    v_lshlrev_b32 v36, 16, v18
    v_and_b32 v37, 0xffff0000, v18
    v_mfma_f32_16x16x32_bf16 v[76:79], a[44:47], a[48:51], v[76:79]
    v_lshlrev_b32 v38, 16, v19
    v_and_b32 v39, 0xffff0000, v19
    v_lshlrev_b32 v40, 16, v20
    v_and_b32 v41, 0xffff0000, v20
    v_lshlrev_b32 v42, 16, v21
    v_and_b32 v43, 0xffff0000, v21
    v_lshlrev_b32 v44, 16, v22
    v_and_b32 v45, 0xffff0000, v22
    v_lshlrev_b32 v46, 16, v23
    v_and_b32 v47, 0xffff0000, v23
    s_waitcnt lgkmcnt(0)
    s_barrier
    ds_read_b128 v[128:131], v11 offset:0
    ds_read_b128 v[132:135], v11 offset:1024
    ds_read_b128 v[136:139], v11 offset:2048
    ds_read_b128 v[140:143], v11 offset:3072
    ds_read_b128 v[144:147], v11 offset:4096
    ds_read_b128 v[148:151], v11 offset:5120
    ds_read_b128 v[152:155], v11 offset:6144
    ds_read_b128 v[156:159], v11 offset:7168
    ds_read_b128 v[160:163], v11 offset:8192
    ds_read_b128 v[164:167], v11 offset:9216
    ds_read_b128 v[168:171], v11 offset:10240
    ds_read_b128 v[172:175], v11 offset:11264
    s_waitcnt vmcnt(3)
    v_mfma_f32_16x16x32_bf16 v[64:67], a[64:67], a[80:83], v[64:67]
    s_waitcnt lgkmcnt(8)
    v_add_f32 v128, v128, v32
    v_add_f32 v129, v129, v33
    v_add_f32 v130, v130, v34
    v_mfma_f32_16x16x32_bf16 v[68:71], a[68:71], a[80:83], v[68:71]
    v_add_f32 v131, v131, v35
    v_add_f32 v132, v132, v36
    v_add_f32 v133, v133, v37
    v_mfma_f32_16x16x32_bf16 v[72:75], a[72:75], a[80:83], v[72:75]
    v_add_f32 v134, v134, v38
    v_add_f32 v135, v135, v39
    v_add_f32 v136, v136, v40
    v_mfma_f32_16x16x32_bf16 v[76:79], a[76:79], a[80:83], v[76:79]
    v_add_f32 v137, v137, v41
    v_add_f32 v138, v138, v42
    v_add_f32 v139, v139, v43
    s_waitcnt vmcnt(2)
    v_mfma_f32_16x16x32_bf16 v[64:67], a[96:99], a[112:115], v[64:67]
    v_add_f32 v140, v140, v44
    v_add_f32 v141, v141, v45
    v_add_f32 v142, v142, v46
    v_mfma_f32_16x16x32_bf16 v[68:71], a[100:103], a[112:115], v[68:71]
    v_add_f32 v143, v143, v47
    s_waitcnt lgkmcnt(4)
    v_add_f32 v128, v128, v144
    v_add_f32 v129, v129, v145
    v_mfma_f32_16x16x32_bf16 v[72:75], a[104:107], a[112:115], v[72:75]
    v_add_f32 v130, v130, v146
    v_add_f32 v131, v131, v147
    v_add_f32 v132, v132, v148
    v_mfma_f32_16x16x32_bf16 v[76:79], a[108:111], a[112:115], v[76:79]
    v_add_f32 v133, v133, v149
    v_add_f32 v134, v134, v150
    v_add_f32 v135, v135, v151
    s_waitcnt vmcnt(1)
    v_mfma_f32_16x16x32_bf16 v[64:67], a[128:131], a[144:147], v[64:67]
    v_add_f32 v136, v136, v152
    v_add_f32 v137, v137, v153
    v_add_f32 v138, v138, v154
    v_mfma_f32_16x16x32_bf16 v[68:71], a[132:135], a[144:147], v[68:71]
    v_add_f32 v139, v139, v155
    v_add_f32 v140, v140, v156
    v_add_f32 v141, v141, v157
    v_mfma_f32_16x16x32_bf16 v[72:75], a[136:139], a[144:147], v[72:75]
    v_add_f32 v142, v142, v158
    v_add_f32 v143, v143, v159
    s_waitcnt lgkmcnt(0)
    v_add_f32 v128, v128, v160
    v_mfma_f32_16x16x32_bf16 v[76:79], a[140:143], a[144:147], v[76:79]
    v_add_f32 v129, v129, v161
    v_add_f32 v130, v130, v162
    v_add_f32 v131, v131, v163
    s_waitcnt vmcnt(0)
    v_mfma_f32_16x16x32_bf16 v[64:67], a[160:163], a[176:179], v[64:67]
    v_add_f32 v132, v132, v164
    v_add_f32 v133, v133, v165
    v_add_f32 v134, v134, v166
    v_mfma_f32_16x16x32_bf16 v[68:71], a[164:167], a[176:179], v[68:71]
    v_add_f32 v135, v135, v167
    v_add_f32 v136, v136, v168
    v_add_f32 v137, v137, v169
    v_mfma_f32_16x16x32_bf16 v[72:75], a[168:171], a[176:179], v[72:75]
    v_add_f32 v138, v138, v170
    v_add_f32 v139, v139, v171
    v_add_f32 v140, v140, v172
    v_mfma_f32_16x16x32_bf16 v[76:79], a[172:175], a[176:179], v[76:79]
    v_add_f32 v141, v141, v173
    v_add_f32 v142, v142, v174
    v_add_f32 v143, v143, v175
    v_add_f32 v64, v64, v128
    v_add_f32 v65, v65, v129
    v_add_f32 v66, v66, v130
    v_add_f32 v67, v67, v131
    v_add_f32 v68, v68, v132
    v_add_f32 v69, v69, v133
    v_add_f32 v70, v70, v134
    v_add_f32 v71, v71, v135
    v_add_f32 v72, v72, v136
    v_add_f32 v73, v73, v137
    v_add_f32 v74, v74, v138
    v_add_f32 v75, v75, v139
    v_add_f32 v76, v76, v140
    v_add_f32 v77, v77, v141
    v_add_f32 v78, v78, v142
    v_add_f32 v79, v79, v143
    v_permlane32_swap_b32 v64, v68
    v_permlane32_swap_b32 v72, v76
    v_permlane32_swap_b32 v65, v69
    v_permlane32_swap_b32 v73, v77
    v_permlane32_swap_b32 v66, v70
    v_permlane32_swap_b32 v74, v78
    v_permlane32_swap_b32 v67, v71
    v_permlane32_swap_b32 v75, v79
    v_permlane16_swap_b32 v64, v68
    v_permlane16_swap_b32 v72, v76
    v_permlane16_swap_b32 v65, v69
    v_permlane16_swap_b32 v73, v77
    v_permlane16_swap_b32 v66, v70
    v_permlane16_swap_b32 v74, v78
    v_permlane16_swap_b32 v67, v71
    v_permlane16_swap_b32 v75, v79
    v_cvt_pk_bf16_f32 v48, v64, v65
    v_cvt_pk_bf16_f32 v49, v66, v67
    v_cvt_pk_bf16_f32 v50, v68, v69
    v_cvt_pk_bf16_f32 v51, v70, v71
    v_cvt_pk_bf16_f32 v52, v72, v73
    v_cvt_pk_bf16_f32 v53, v74, v75
    v_cvt_pk_bf16_f32 v54, v76, v77
    v_cvt_pk_bf16_f32 v55, v78, v79
    global_store_dwordx4 v12, v[48:51], s[18:19] sc1
    global_store_dwordx4 v12, v[52:55], s[18:19] offset:64 sc1
down1_end:
down1_end2:
    s_endpgm
text_end:
.section .rodata,"a"
.p2align 6
.amdhsa_kernel k1_kernel
  .amdhsa_next_free_vgpr 240
  .amdhsa_next_free_sgpr 64
  .amdhsa_accum_offset 240
  .amdhsa_group_segment_fixed_size 0
  .amdhsa_kernarg_size 80
  .amdhsa_user_sgpr_count 2
  .amdhsa_user_sgpr_kernarg_segment_ptr 1
  .amdhsa_system_sgpr_workgroup_id_x 1
.end_amdhsa_kernel
.p2align 6
.amdhsa_kernel fft0_kernel
  .amdhsa_next_free_vgpr 256
  .amdhsa_next_free_sgpr 64
  .amdhsa_accum_offset 256
  .amdhsa_group_segment_fixed_size 0
  .amdhsa_kernarg_size 80
  .amdhsa_user_sgpr_count 2
  .amdhsa_user_sgpr_kernarg_segment_ptr 1
  .amdhsa_system_sgpr_workgroup_id_x 1
.end_amdhsa_kernel
.p2align 6
.amdhsa_kernel fft1_kernel
  .amdhsa_next_free_vgpr 256
  .amdhsa_next_free_sgpr 64
  .amdhsa_accum_offset 256
  .amdhsa_group_segment_fixed_size 0
  .amdhsa_kernarg_size 80
  .amdhsa_user_sgpr_count 2
  .amdhsa_user_sgpr_kernarg_segment_ptr 1
  .amdhsa_system_sgpr_workgroup_id_x 1
.end_amdhsa_kernel
.p2align 6
.amdhsa_kernel glu0_kernel
  .amdhsa_next_free_vgpr 256
  .amdhsa_next_free_sgpr 64
  .amdhsa_accum_offset 256
  .amdhsa_group_segment_fixed_size 0
  .amdhsa_kernarg_size 80
  .amdhsa_user_sgpr_count 2
  .amdhsa_user_sgpr_kernarg_segment_ptr 1
  .amdhsa_system_sgpr_workgroup_id_x 1
.end_amdhsa_kernel
.p2align 6
.amdhsa_kernel glu1_kernel
  .amdhsa_next_free_vgpr 256
  .amdhsa_next_free_sgpr 64
  .amdhsa_accum_offset 256
  .amdhsa_group_segment_fixed_size 0
  .amdhsa_kernarg_size 80
  .amdhsa_user_sgpr_count 2
  .amdhsa_user_sgpr_kernarg_segment_ptr 1
  .amdhsa_system_sgpr_workgroup_id_x 1
.end_amdhsa_kernel
.p2align 6
.amdhsa_kernel down0_kernel
  .amdhsa_next_free_vgpr 432
  .amdhsa_next_free_sgpr 64
  .amdhsa_accum_offset 176
  .amdhsa_group_segment_fixed_size 0
  .amdhsa_kernarg_size 80
  .amdhsa_user_sgpr_count 2
  .amdhsa_user_sgpr_kernarg_segment_ptr 1
  .amdhsa_system_sgpr_workgroup_id_x 1
.end_amdhsa_kernel
.p2align 6
.amdhsa_kernel down1_kernel
  .amdhsa_next_free_vgpr 432
  .amdhsa_next_free_sgpr 64
  .amdhsa_accum_offset 176
  .amdhsa_group_segment_fixed_size 0
  .amdhsa_kernarg_size 80
  .amdhsa_user_sgpr_count 2
  .amdhsa_user_sgpr_kernarg_segment_ptr 1
  .amdhsa_system_sgpr_workgroup_id_x 1
.end_amdhsa_kernel
```
